```python
import torch

def _softmax(x, axis=-1):
    return torch.softmax(x, dim=axis)

def _gelu(x):
    return torch.nn.functional.gelu(x, approximate='tanh')

def _silu(x):
    return torch.nn.functional.silu(x)

def _sigmoid(x):
    return torch.sigmoid(x)

def _layernorm(x, axis=-1, eps=1e-05):
    m = x.mean(dim=axis, keepdim=True)
    v = x.var(dim=axis, keepdim=True, unbiased=False)
    return (x - m) / torch.sqrt(v + eps)

def _scatter_add(tgt, idx, src, axis=0):
    return tgt.clone().index_add_(axis, idx, src)

def _segment_sum(src, seg, n):
    out = torch.zeros((n,) + src.shape[1:], dtype=src.dtype)
    return out.index_add_(0, seg, src)

def _pad(x, pw):
    flat = tuple((v for pair in reversed(pw) for v in pair))
    return torch.nn.functional.pad(x, flat)
kernel_name = 'adaLN_cond__sliding_block_cached__dense_activation_gelu__prompt'

def setup_inputs():

    _w = lambda a: (lambda t: t.to(torch.bfloat16) if t.is_floating_point() else t)(torch.as_tensor(a))

    def _A_setup():
        B, Sq, D = (1, 2048, 512)
        Hq, Hkv, Sk, Dh = (32, 32, 2048, 128)
        assert Hq % Hkv == 0, (Hq, Hkv)
        return {'x': _w((lambda *s: torch.randn(*s, dtype=torch.bfloat16) * 0.1)(B, Sq, D)), 'k_cache': _w((lambda *s: torch.randn(*s, dtype=torch.bfloat16) * 0.8)(B, Hkv, Sk, Dh)), 'v_cache': _w((lambda *s: torch.randn(*s, dtype=torch.bfloat16) * 3.2)(B, Hkv, Sk, Dh)), 'wq': _w((lambda *s: torch.randn(*s, dtype=torch.bfloat16) * 0.8)(D, Hq * Dh) * D ** (-0.5)), 'wo': _w((lambda *s: torch.randn(*s, dtype=torch.bfloat16) * 3.2)(Hq * Dh, D) * (Hq * Dh) ** (-0.5))}
    _A_in = _A_setup()

    def _B_setup():
        B, S, D, F = (1, 2048, 512, 1376)
        return {'x': _w((lambda *s: torch.randn(*s, dtype=torch.bfloat16) * 0.1)(B, S, D)), 'w1': _w((lambda *s: torch.randn(*s, dtype=torch.bfloat16) * 3.2)(D, F) * D ** (-0.5)), 'b1': _w((lambda *s: torch.randn(*s, dtype=torch.bfloat16) * 3.2)(F) * 0.01), 'w2': _w((lambda *s: torch.randn(*s, dtype=torch.bfloat16) * 3.2)(F, D) * F ** (-0.5)), 'b2': _w((lambda *s: torch.randn(*s, dtype=torch.bfloat16) * 3.2)(D) * 0.01)}
    _B_in = _B_setup()
    return {'A_x': _A_in['x'], 'A_k_cache': _A_in['k_cache'], 'A_v_cache': _A_in['v_cache'], 'A_wq': _A_in['wq'], 'A_wo': _A_in['wo'], 'B_x': _B_in['x'], 'B_w1': _B_in['w1'], 'B_b1': _B_in['b1'], 'B_w2': _B_in['w2'], 'B_b2': _B_in['b2'], 'c': _w((lambda *s: torch.randn(*s, dtype=torch.bfloat16) * 0.1)(1, 512) * 8.0), 'w_mod': _w((lambda *s: torch.randn(*s, dtype=torch.bfloat16) * 0.1)(512, 6 * 512) * 512 ** (-0.5) * 8.0)}

def reference(A_x, A_k_cache, A_v_cache, A_wq, A_wo, B_x, B_w1, B_b1, B_w2, B_b2, c, w_mod):

    def _A_ref(x, k_cache, v_cache, wq, wo):
        B, Sq, D = x.shape
        Hq, Dh = (32, 128)
        Hkv, Sk = (k_cache.shape[1], k_cache.shape[2])
        W = min(4096, max(256, Sk // 4))
        rep = Hq // Hkv
        q = (lambda x, *d: x.permute(*d))((x @ wq).reshape(B, Sq, Hq, Dh), 0, 2, 1, 3)
        k = (lambda x, n, axis: torch.repeat_interleave(x, n, dim=axis))(k_cache[:, :, Sk - W:, :], rep, axis=1)
        v = (lambda x, n, axis: torch.repeat_interleave(x, n, dim=axis))(v_cache[:, :, Sk - W:, :], rep, axis=1)
        scores = torch.einsum('bhqd,bhkd->bhqk', q, k) * Dh ** (-0.5)
        p = _softmax(scores, axis=-1)
        o = torch.einsum('bhqk,bhkd->bhqd', p, v)
        return (lambda x, *d: x.permute(*d))(o, 0, 2, 1, 3).reshape(B, Sq, Hq * Dh) @ wo

    def _B_ref(x, w1, b1, w2, b2):
        h = torch.einsum('bsd,df->bsf', x, w1) + b1
        h = _gelu(h)
        return torch.einsum('bsf,fd->bsd', h, w2) + b2
    x = A_x
    mod = (_silu(c) @ w_mod).reshape(c.shape[0], 6, 1, -1)
    sa, ca, ga, sb, cb, gb = (mod[:, 0].clone(), mod[:, 1].clone(), mod[:, 2].clone(), mod[:, 3].clone(), mod[:, 4].clone(), mod[:, 5].clone())
    h = _layernorm(x, axis=-1) * (1 + ca) + sa
    x = x + ga * _A_ref(h, A_k_cache, A_v_cache, A_wq, A_wo)
    h = _layernorm(x, axis=-1) * (1 + cb) + sb
    x = x + gb * _B_ref(h, B_w1, B_b1, B_w2, B_b2)
    return x
```

```asm
; @launch grid=(256,1,1) block=(256,1,1) lds=163840
.amdgcn_target "amdgcn-amd-amdhsa--gfx950"
.text
.globl adaLN_cond__sliding_block_cached__dense_activation_gelu__prompt_kernel
.p2align 8
.type adaLN_cond__sliding_block_cached__dense_activation_gelu__prompt_kernel,@function
adaLN_cond__sliding_block_cached__dense_activation_gelu__prompt_kernel:
    s_cmp_ge_u32 s2, 256
    s_cbranch_scc1 L_end
    s_load_dwordx16 s[4:19], s[0:1], 0
    s_load_dwordx8 s[20:27], s[0:1], 64
    s_load_dwordx4 s[28:31], s[0:1], 96
    s_load_dwordx2 s[32:33], s[0:1], 112
    v_lshrrev_b32 v1, 6, v0
    s_and_b32 s35, s2, 1
    v_readfirstlane_b32 s34, v1
    s_lshl_b32 s35, s35, 2
    s_lshr_b32 s64, s2, 6
    s_add_u32 s35, s35, s64
    s_bfe_u32 s36, s2, 0x20001
    s_bfe_u32 s37, s2, 0x30003
    s_lshl_b32 s38, s36, 3
    s_add_u32 s38, s38, s37
    s_and_b32 s70, s35, 3
    s_lshr_b32 s74, s38, 4
    s_mul_i32 s68, s74, 1572864
    s_and_b32 s75, s38, 15
    s_lshl_b32 s75, s75, 7
    s_add_u32 s68, s68, s75
    s_lshl_b32 s73, s35, 5
    s_add_u32 s73, s73, s38
    s_lshl_b32 s76, s73, 13
    v_and_b32 v4, 7, v0
    v_lshrrev_b32 v5, 3, v0
    v_lshlrev_b32 v1, 4, v4
    s_mov_b32 s75, 49152
    v_mad_u32_u24 v1, v5, s75, v1
    v_add_u32 v12, 6144, v1
    v_lshlrev_b32 v2, 4, v5
    v_lshl_add_u32 v2, v4, 10, v2
    v_lshlrev_b32 v3, 2, v0
    s_lshl_b32 s69, s38, 2
    s_add_u32 s69, s69, s34
    s_waitcnt lgkmcnt(0)
    s_add_u32 s40, s32, 65536
    s_addc_u32 s41, s33, 0
    s_mov_b32 s42, 38731776
    s_mov_b32 s43, 0x20000
    s_mov_b32 s48, s24
    s_mov_b32 s49, s25
    s_mov_b32 s50, 1024
    s_mov_b32 s51, 0x20000
    s_lshl_b32 s72, s35, 13
    s_cmp_lt_u32 s69, 3
    s_cbranch_scc0 L_nozero
    v_mov_b32 v8, 0
    v_mov_b32 v9, 0
    v_mov_b32 v10, 0
    v_mov_b32 v11, 0
    s_lshl_b32 s75, s69, 12
    s_add_u32 s75, s75, 61440
    s_cmp_eq_u32 s69, 0
    s_cselect_b32 s75, 0, s75
    s_cselect_b32 s77, 8, 7
    s_add_u32 s75, s75, s72
    v_and_b32 v6, 7, v5
    v_lshlrev_b32 v6, s77, v6
    v_lshl_add_u32 v6, v4, 4, v6
    s_lshl_b32 s77, 8, s77
    buffer_store_dwordx4 v[8:11], v6, s[40:43], s75 offen sc1
    s_add_u32 s75, s75, s77
    buffer_store_dwordx4 v[8:11], v6, s[40:43], s75 offen sc1
    s_add_u32 s75, s75, s77
    buffer_store_dwordx4 v[8:11], v6, s[40:43], s75 offen sc1
    s_add_u32 s75, s75, s77
    buffer_store_dwordx4 v[8:11], v6, s[40:43], s75 offen sc1
    s_add_u32 s75, s75, s77
L_nozero:
    buffer_load_dword v6, v3, s[48:51], 0 offen
    s_mov_b32 s52, s26
    s_mov_b32 s53, s27
    s_mov_b32 s54, 3145728
    s_mov_b32 s55, 0x20000
    s_mov_b32 s44, s4
    s_mov_b32 s45, s5
    s_mov_b32 s46, 2097152
    s_mov_b32 s47, 0x20000
    s_add_u32 s75, s70, 0
    s_and_b32 s75, s75, 3
    s_mul_i32 s75, s75, 12288
    s_add_u32 s75, s75, s68
    buffer_load_dwordx4 v[16:19], v1, s[52:55], s75 offen
    buffer_load_dwordx4 v[20:23], v12, s[52:55], s75 offen
    buffer_load_dwordx4 v[48:51], v2, s[44:47], s76 offen offset:0
    buffer_load_dwordx4 v[52:55], v2, s[44:47], s76 offen offset:512
    s_add_u32 s75, s70, 1
    s_and_b32 s75, s75, 3
    s_mul_i32 s75, s75, 12288
    s_add_u32 s75, s75, s68
    buffer_load_dwordx4 v[24:27], v1, s[52:55], s75 offen
    buffer_load_dwordx4 v[28:31], v12, s[52:55], s75 offen
    s_add_u32 s75, s70, 2
    s_and_b32 s75, s75, 3
    s_mul_i32 s75, s75, 12288
    s_add_u32 s75, s75, s68
    buffer_load_dwordx4 v[32:35], v1, s[52:55], s75 offen
    buffer_load_dwordx4 v[36:39], v12, s[52:55], s75 offen
    s_add_u32 s75, s70, 3
    s_and_b32 s75, s75, 3
    s_mul_i32 s75, s75, 12288
    s_add_u32 s75, s75, s68
    buffer_load_dwordx4 v[40:43], v1, s[52:55], s75 offen
    buffer_load_dwordx4 v[44:47], v12, s[52:55], s75 offen
    s_mov_b32 s48, s30
    s_mov_b32 s49, s31
    s_mov_b32 s50, 256
    s_mov_b32 s51, 0x20000
    s_lshl_b32 s15, s35, 5
    s_cmp_lt_u32 s69, 4
    s_cbranch_scc0 L_notell
    v_mov_b32 v7, 3
    s_waitcnt vmcnt(11)
    s_barrier
    s_cmp_eq_u32 s69, 3
    s_cbranch_scc0 L_notell
    s_mov_b64 exec, 1
    buffer_store_dword v7, off, s[48:51], s15 sc1
    s_mov_b64 exec, -1
L_notell:
    v_lshrrev_b32 v200, 6, v0
    v_and_b32 v201, 63, v0
    v_bfe_u32 v202, v201, 2, 2
    v_lshrrev_b32 v203, 4, v201
    v_and_b32 v204, 3, v201
    v_lshlrev_b32 v205, 6, v203
    v_lshl_add_u32 v205, v204, 4, v205
    v_lshl_add_u32 v245, v202, 8, v205
    v_lshl_add_u32 v245, v200, 12, v245
    v_lshl_add_u32 v246, v202, 13, v205
    v_lshl_add_u32 v246, v200, 17, v246
    v_lshlrev_b32 v254, 4, v201
    v_lshl_add_u32 v247, v200, 16, v254
    v_add_u32 v248, 0x8000, v247
    v_bfe_u32 v205, v201, 2, 3
    v_mul_u32_u24 v205, 1040, v205
    v_lshl_add_u32 v205, v204, 6, v205
    v_lshrrev_b32 v206, 5, v201
    v_lshl_add_u32 v243, v206, 4, v205
    v_and_b32 v203, 1, v203
    v_lshlrev_b32 v207, 5, v203
    v_lshl_add_u32 v207, v202, 6, v207
    v_and_b32 v208, 1, v201
    v_lshl_add_u32 v207, v208, 4, v207
    v_bfe_u32 v208, v201, 1, 1
    v_lshl_add_u32 v207, v208, 3, v207
    v_lshl_add_u32 v242, v206, 11, v207
    v_add_u32 v242, 133120, v242
    v_lshl_add_u32 v244, v206, 10, v207
    v_add_u32 v244, 16640, v244
    v_lshl_add_u32 v205, v206, 2, v202
    v_lshlrev_b32 v205, 10, v205
    v_lshl_add_u32 v205, v203, 6, v205
    v_lshl_add_u32 v255, v204, 4, v205
    v_mov_b32 v240, v243
    v_mov_b32 v241, v244
    v_mov_b32 v249, 0
    v_mov_b32 v250, 0
    s_lshl_b32 s39, s34, 12
    s_add_u32 s39, s39, 16640
    s_mul_i32 s3, s34, 4160
    s_lshl_b32 s78, s35, 1
    s_lshr_b32 s79, s35, 2
    s_add_u32 s78, s78, s79
    s_and_b32 s78, s78, 7
    s_lshl_b32 s79, s38, 8
    v_xor_b32 v251, 32, v246
    v_lshrrev_b32 v208, 4, v201
    v_and_b32 v205, 15, v201
    v_lshlrev_b32 v205, 4, v205
    v_lshl_add_u32 v205, v208, 9, v205
    v_lshl_add_u32 v247, v200, 16, v205
    v_add_u32 v248, 0x8000, v247
    v_lshlrev_b32 v205, 11, v208
    v_lshl_add_u32 v205, v202, 6, v205
    v_lshl_add_u32 v205, v203, 5, v205
    v_lshl_add_u32 v205, v204, 3, v205
    v_add_u32 v242, 133120, v205
    v_xor_b32 v252, 32, v242
    v_lshrrev_b32 v205, 1, v202
    v_xor_b32 v205, v205, v202
    v_mul_u32_u24 v205, 1040, v205
    v_lshl_add_u32 v205, v204, 6, v205
    v_lshl_add_u32 v205, v203, 5, v205
    v_lshl_add_u32 v243, v206, 4, v205
    v_mov_b32 v240, v243
    v_xor_b32 v208, v208, v206
    v_lshlrev_b32 v205, 10, v208
    v_and_b32 v208, 1, v208
    v_lshl_add_u32 v205, v208, 5, v205
    v_lshl_add_u32 v205, v202, 6, v205
    v_lshl_add_u32 v205, v204, 3, v205
    v_add_u32 v244, 16640, v205
    v_mov_b32 v241, v244
    v_xor_b32 v249, 32, v241
    v_xor_b32 v250, 32, v245
    v_lshlrev_b32 v205, 5, v206
    v_xor_b32 v255, v205, v255
    s_add_u32 s64, s10, s79
    s_addc_u32 s65, s11, 0
    s_mov_b32 s66, 0x400000
    s_mov_b32 s67, 0x20000
    s_sub_u32 s66, s66, s79
    s_lshl_b32 s79, s36, 13
    s_add_u32 s79, s79, s37
    s_lshl_b32 s79, s79, 7
    s_add_u32 s60, s12, s79
    s_addc_u32 s61, s13, 0
    s_mov_b32 s62, 0x400000
    s_mov_b32 s63, 0x20000
    s_sub_u32 s62, s62, s79
    s_lshr_b32 s96, s2, 3
    s_lshl_b32 s97, s34, 5
    s_add_u32 s96, s96, s97
    s_sub_u32 s96, s96, 96
    s_cmp_lt_u32 s96, (L_last-adaLN_cond__sliding_block_cached__dense_activation_gelu__prompt_kernel+8191)/8192
    s_cbranch_scc0 L_nocode0
    s_lshl_b32 s96, s96, 13
    v_lshl_add_u32 v7, v254, 3, s96
    v_min_u32 v7, L_last-adaLN_cond__sliding_block_cached__dense_activation_gelu__prompt_kernel-4, v7
    s_getpc_b64 s[96:97]
L_pc0:
    s_add_u32 s96, s96, (adaLN_cond__sliding_block_cached__dense_activation_gelu__prompt_kernel-L_pc0)&0xffffffff
    s_addc_u32 s97, s97, (adaLN_cond__sliding_block_cached__dense_activation_gelu__prompt_kernel-L_pc0)>>32
    global_load_dword v239, v7, s[96:97]
L_nocode0:
    s_add_u32 s56, s32, 1048576
    s_addc_u32 s57, s33, 0
    s_mov_b32 s58, 2097152
    s_mov_b32 s59, 0x20000
    s_lshl_b32 s75, s73, 8
    s_add_u32 s98, s40, s75
    s_addc_u32 s99, s41, 0
    s_lshr_b32 s71, s73, 2
    s_lshl_b32 s71, s71, 15
    s_and_b32 s75, s73, 3
    s_lshl_b32 s75, s75, 7
    s_add_u32 s71, s71, s75
    v_lshlrev_b32 v64, 9, v5
    v_lshl_add_u32 v64, v4, 4, v64
    v_add_u32 v65, 0x4000, v64
    v_lshrrev_b32 v7, 4, v0
    v_lshlrev_b32 v7, 7, v7
    v_and_b32 v8, 60, v3
    v_add3_u32 v66, v7, v8, 64
    v_add_u32 v66, 149696, v66
    s_lshl_b32 s75, s74, 10
    s_add_u32 s75, s75, 149760
    v_lshrrev_b32 v7, 2, v5
    v_lshl_add_u32 v7, v7, 7, s75
    v_and_b32 v8, 3, v5
    v_lshl_add_u32 v67, v8, 4, v7
    v_lshlrev_b32 v68, 5, v0
    v_add_u32 v68, 151808, v68
    v_and_b32 v7, 15, v0
    v_lshlrev_b32 v69, 2, v7
    v_bfe_u32 v8, v0, 4, 2
    v_lshl_add_u32 v8, v8, 11, v69
    s_lshl_b32 s75, s34, 6
    s_add_u32 s77, s75, 151808
    v_add_u32 v70, s77, v8
    s_lshl_b32 s77, s38, 8
    s_add_u32 s77, s77, s75
    v_add_u32 v69, s77, v69
    s_add_u32 s72, s72, 65536
    s_lshl_b32 s75, s34, 2
    s_add_u32 s75, s75, 160000
    v_lshl_add_u32 v71, v4, 5, s75
    v_bfe_u32 v8, v0, 5, 1
    v_lshl_add_u32 v71, v8, 4, v71
    v_lshlrev_b32 v72, 5, v4
    v_add_u32 v72, 160000, v72
    v_lshlrev_b32 v73, 4, v0
    v_add_u32 v74, 4096, v73
    v_lshlrev_b32 v75, 5, v5
    s_mov_b32 s14, 0x3f803f80
    s_mov_b32 s76, 0x05040100
    s_mov_b32 s77, 0x07060302
    v_mov_b32 v80, 0
    v_mov_b32 v81, 0
    v_mov_b32 v82, 0
    v_mov_b32 v83, 0
    v_mov_b32 v84, 0
    v_mov_b32 v85, 0
    v_mov_b32 v86, 0
    v_mov_b32 v87, 0
    v_mov_b32 v88, 0
    v_mov_b32 v89, 0
    s_waitcnt vmcnt(10)
    v_lshlrev_b32 v8, 16, v6
    v_and_b32 v9, 0xffff0000, v6
    v_mul_f32 v10, 0xbfb8aa3b, v8
    v_mul_f32 v11, 0xbfb8aa3b, v9
    v_exp_f32 v10, v10
    v_exp_f32 v11, v11
    s_nop 0
    v_add_f32 v10, 1.0, v10
    v_add_f32 v11, 1.0, v11
    v_rcp_f32 v10, v10
    v_rcp_f32 v11, v11
    s_nop 0
    v_mul_f32 v8, v8, v10
    v_mul_f32 v9, v9, v11
    v_cvt_pk_bf16_f32 v8, v8, v9
    ds_write_b32 v66, v8
    s_add_u32 s75, s70, 0
    s_and_b32 s75, s75, 3
    s_lshl_b32 s75, s75, 2
    v_add_u32 v76, s75, v67
    s_add_u32 s75, s70, 1
    s_and_b32 s75, s75, 3
    s_lshl_b32 s75, s75, 2
    v_add_u32 v77, s75, v67
    s_add_u32 s75, s70, 2
    s_and_b32 s75, s75, 3
    s_lshl_b32 s75, s75, 2
    v_add_u32 v78, s75, v67
    s_add_u32 s75, s70, 3
    s_and_b32 s75, s75, 3
    s_lshl_b32 s75, s75, 2
    v_add_u32 v79, s75, v67
    s_waitcnt lgkmcnt(0)
    s_barrier
    ds_read_b32 v76, v76
    ds_read_b32 v77, v77
    ds_read_b32 v78, v78
    ds_read_b32 v79, v79
    s_add_u32 s79, s78, 0
    s_and_b32 s79, s79, 7
    s_lshl_b32 s79, s79, 19
    s_add_u32 m0, s39, 116480
    s_nop 0
    buffer_load_dwordx4 v246, s[64:67], s79 offen offset:0 lds
    s_addk_i32 s79, 31744
    buffer_load_dwordx4 v246, s[64:67], s79 offen offset:1024 lds
    s_addk_i32 s79, 31744
    buffer_load_dwordx4 v251, s[64:67], s79 offen offset:2048 lds
    s_addk_i32 s79, 31744
    buffer_load_dwordx4 v251, s[64:67], s79 offen offset:3072 lds
    s_waitcnt vmcnt(10)
    v_dot2c_f32_bf16 v88, s14, v48
    v_dot2c_f32_bf16 v89, v48, v48
    v_dot2c_f32_bf16 v88, s14, v49
    v_dot2c_f32_bf16 v89, v49, v49
    v_dot2c_f32_bf16 v88, s14, v50
    v_dot2c_f32_bf16 v89, v50, v50
    v_dot2c_f32_bf16 v88, s14, v51
    v_dot2c_f32_bf16 v89, v51, v51
    v_dot2c_f32_bf16 v88, s14, v52
    v_dot2c_f32_bf16 v89, v52, v52
    v_dot2c_f32_bf16 v88, s14, v53
    v_dot2c_f32_bf16 v89, v53, v53
    v_dot2c_f32_bf16 v88, s14, v54
    v_dot2c_f32_bf16 v89, v54, v54
    v_dot2c_f32_bf16 v88, s14, v55
    v_dot2c_f32_bf16 v89, v55, v55
    v_lshlrev_b32 v96, 16, v48
    v_and_b32 v97, 0xffff0000, v48
    v_lshlrev_b32 v98, 16, v49
    v_and_b32 v99, 0xffff0000, v49
    v_lshlrev_b32 v100, 16, v50
    v_and_b32 v101, 0xffff0000, v50
    v_lshlrev_b32 v102, 16, v51
    v_and_b32 v103, 0xffff0000, v51
    v_lshlrev_b32 v104, 16, v52
    v_and_b32 v105, 0xffff0000, v52
    v_lshlrev_b32 v106, 16, v53
    v_and_b32 v107, 0xffff0000, v53
    v_lshlrev_b32 v108, 16, v54
    v_and_b32 v109, 0xffff0000, v54
    v_lshlrev_b32 v110, 16, v55
    v_and_b32 v111, 0xffff0000, v55
    v_add_f32_dpp v88, v88, v88 row_ror:8 row_mask:0xf bank_mask:0xf
    v_add_f32_dpp v89, v89, v89 row_ror:8 row_mask:0xf bank_mask:0xf
    s_nop 1
    v_permlane32_swap_b32 v88, v89
    v_add_f32 v88, v88, v89
    v_mov_b32 v89, v88
    s_nop 1
    v_permlane16_swap_b32 v88, v89
    v_add_f32 v88, v88, v89
    s_waitcnt lgkmcnt(0)
    ds_write_b32 v71, v88
    s_waitcnt vmcnt(12)
    v_perm_b32 v8, v20, v16, s76
    v_perm_b32 v9, v20, v16, s77
    v_perm_b32 v10, v21, v17, s76
    v_perm_b32 v11, v21, v17, s77
    v_dot2c_f32_bf16 v80, v76, v8
    v_dot2c_f32_bf16 v81, v76, v9
    v_dot2c_f32_bf16 v82, v76, v10
    v_dot2c_f32_bf16 v83, v76, v11
    v_perm_b32 v8, v22, v18, s76
    v_perm_b32 v9, v22, v18, s77
    v_perm_b32 v10, v23, v19, s76
    v_perm_b32 v11, v23, v19, s77
    v_dot2c_f32_bf16 v84, v76, v8
    v_dot2c_f32_bf16 v85, v76, v9
    v_dot2c_f32_bf16 v86, v76, v10
    v_dot2c_f32_bf16 v87, v76, v11
    s_waitcnt vmcnt(8)
    v_perm_b32 v8, v28, v24, s76
    v_perm_b32 v9, v28, v24, s77
    v_perm_b32 v10, v29, v25, s76
    v_perm_b32 v11, v29, v25, s77
    v_dot2c_f32_bf16 v80, v77, v8
    v_dot2c_f32_bf16 v81, v77, v9
    v_dot2c_f32_bf16 v82, v77, v10
    v_dot2c_f32_bf16 v83, v77, v11
    v_perm_b32 v8, v30, v26, s76
    v_perm_b32 v9, v30, v26, s77
    v_perm_b32 v10, v31, v27, s76
    v_perm_b32 v11, v31, v27, s77
    v_dot2c_f32_bf16 v84, v77, v8
    v_dot2c_f32_bf16 v85, v77, v9
    v_dot2c_f32_bf16 v86, v77, v10
    v_dot2c_f32_bf16 v87, v77, v11
    s_waitcnt vmcnt(6)
    v_perm_b32 v8, v36, v32, s76
    v_perm_b32 v9, v36, v32, s77
    v_perm_b32 v10, v37, v33, s76
    v_perm_b32 v11, v37, v33, s77
    v_dot2c_f32_bf16 v80, v78, v8
    v_dot2c_f32_bf16 v81, v78, v9
    v_dot2c_f32_bf16 v82, v78, v10
    v_dot2c_f32_bf16 v83, v78, v11
    v_perm_b32 v8, v38, v34, s76
    v_perm_b32 v9, v38, v34, s77
    v_perm_b32 v10, v39, v35, s76
    v_perm_b32 v11, v39, v35, s77
    v_dot2c_f32_bf16 v84, v78, v8
    v_dot2c_f32_bf16 v85, v78, v9
    v_dot2c_f32_bf16 v86, v78, v10
    v_dot2c_f32_bf16 v87, v78, v11
    s_waitcnt vmcnt(4)
    s_cmp_lg_u32 s34, 2
    s_cbranch_scc1 L0_nos
    s_load_dword s96, s[30:31], s15
L0_nos:
    v_perm_b32 v8, v44, v40, s76
    v_perm_b32 v9, v44, v40, s77
    v_perm_b32 v10, v45, v41, s76
    v_perm_b32 v11, v45, v41, s77
    v_dot2c_f32_bf16 v80, v79, v8
    v_dot2c_f32_bf16 v81, v79, v9
    v_dot2c_f32_bf16 v82, v79, v10
    v_dot2c_f32_bf16 v83, v79, v11
    v_perm_b32 v8, v46, v42, s76
    v_perm_b32 v9, v46, v42, s77
    v_perm_b32 v10, v47, v43, s76
    v_perm_b32 v11, v47, v43, s77
    v_dot2c_f32_bf16 v84, v79, v8
    v_dot2c_f32_bf16 v85, v79, v9
    v_dot2c_f32_bf16 v86, v79, v10
    v_dot2c_f32_bf16 v87, v79, v11
    s_nop 1
    ds_write_b128 v68, v[80:83]
    ds_write_b128 v68, v[84:87] offset:16
    s_waitcnt lgkmcnt(0)
    s_cmp_lg_u32 s34, 2
    s_cbranch_scc1 L0_zok
    s_cmp_ge_u32 s96, 3
    s_cbranch_scc1 L0_zok
    s_mov_b32 s97, 0
L0_zpoll:
    buffer_load_dword v90, off, s[48:51], s15 sc1
    s_add_u32 s97, s97, 1
    s_cmp_gt_u32 s97, 200000
    s_waitcnt vmcnt(0)
    s_cbranch_scc1 L0_zok
    v_cmp_gt_u32 vcc, 3, v90
    s_cbranch_vccnz L0_zpoll
L0_zok:
    s_barrier
    ds_read_b32 v16, v70 offset:0
    ds_read_b32 v17, v70 offset:256
    ds_read_b32 v18, v70 offset:512
    ds_read_b32 v19, v70 offset:768
    ds_read_b32 v20, v70 offset:1024
    ds_read_b32 v21, v70 offset:1280
    ds_read_b32 v22, v70 offset:1536
    ds_read_b32 v23, v70 offset:1792
    ds_read_b128 v[24:27], v72
    ds_read_b128 v[28:31], v72 offset:16
    s_waitcnt lgkmcnt(2)
    v_pk_add_f32 v[16:17], v[16:17], v[18:19]
    v_pk_add_f32 v[20:21], v[20:21], v[22:23]
    v_pk_add_f32 v[16:17], v[16:17], v[20:21]
    v_add_f32 v16, v16, v17
    v_mov_b32 v17, v16
    s_nop 1
    v_permlane32_swap_b32 v16, v17
    v_add_f32 v16, v16, v17
    v_mov_b32 v17, v16
    s_nop 1
    v_permlane16_swap_b32 v16, v17
    v_add_f32 v16, v16, v17
    v_or_b32 v16, 1, v16
    s_mov_b64 exec, 0xffff
    buffer_store_dword v16, v69, s[40:43], s72 offen sc1
    s_mov_b64 exec, -1
    s_waitcnt lgkmcnt(0)
    v_pk_add_f32 v[24:25], v[24:25], v[26:27]
    v_pk_add_f32 v[28:29], v[28:29], v[30:31]
    v_add_f32 v24, v24, v25
    v_add_f32 v28, v28, v29
    v_mul_f32 v24, 0x3b000000, v24
    v_mul_f32 v28, 0x3b000000, v28
    v_fma_f32 v28, -v24, v24, v28
    v_max_f32 v28, 0, v28
    v_add_f32 v28, 0x3727c5ac, v28
    v_rsq_f32 v28, v28
    s_nop 0
    v_mul_f32 v24, -v24, v28
    v_pk_fma_f32 v[96:97], v[96:97], v[28:29], v[24:25] op_sel_hi:[1,0,0]
    v_pk_fma_f32 v[98:99], v[98:99], v[28:29], v[24:25] op_sel_hi:[1,0,0]
    v_pk_fma_f32 v[100:101], v[100:101], v[28:29], v[24:25] op_sel_hi:[1,0,0]
    v_pk_fma_f32 v[102:103], v[102:103], v[28:29], v[24:25] op_sel_hi:[1,0,0]
    v_pk_fma_f32 v[104:105], v[104:105], v[28:29], v[24:25] op_sel_hi:[1,0,0]
    v_pk_fma_f32 v[106:107], v[106:107], v[28:29], v[24:25] op_sel_hi:[1,0,0]
    v_pk_fma_f32 v[108:109], v[108:109], v[28:29], v[24:25] op_sel_hi:[1,0,0]
    v_pk_fma_f32 v[110:111], v[110:111], v[28:29], v[24:25] op_sel_hi:[1,0,0]
    v_mbcnt_lo_u32_b32 v7, -1, 0
    v_mov_b32 v6, 1
    v_lshlrev_b32 v7, 8, v7
    s_mov_b64 exec, 0
    s_cmp_eq_u32 s34, 1
    s_cbranch_scc1 L_pad3
    s_cmp_eq_u32 s34, 2
    s_cbranch_scc1 L_pad6
    s_cmp_eq_u32 s34, 3
    s_cbranch_scc1 L_pad9
    s_branch L_pad0
L_warmed1:
    s_mov_b64 exec, -1
    s_mov_b32 s97, 0
L0_mpoll:
    buffer_load_dwordx4 v[16:19], v73, s[40:43], s72 offen sc1
    buffer_load_dwordx4 v[20:23], v74, s[40:43], s72 offen sc1
    s_add_u32 s97, s97, 1
    s_cmp_gt_u32 s97, 200000
    s_waitcnt vmcnt(0)
    s_cbranch_scc1 L0_mok
    v_min3_u32 v8, v16, v17, v18
    v_min3_u32 v9, v19, v20, v21
    v_min3_u32 v8, v22, v23, v8
    v_min_u32 v8, v8, v9
    v_cmp_eq_u32 vcc, 0, v8
    s_cbranch_vccnz L0_mpoll
L0_mok:
    v_pk_add_f32 v[16:17], v[16:17], v[20:21]
    v_pk_add_f32 v[18:19], v[18:19], v[22:23]
    s_cmp_lt_u32 s34, 2
    v_cvt_pk_bf16_f32 v8, v16, v17
    v_cvt_pk_bf16_f32 v9, v18, v19
    v_lshlrev_b32 v16, 16, v8
    v_and_b32 v17, 0xffff0000, v8
    v_lshlrev_b32 v18, 16, v9
    v_and_b32 v19, 0xffff0000, v9
    s_cbranch_scc1 L0_issa
    v_pk_add_f32 v[16:17], v[16:17], 1.0 op_sel_hi:[1,0]
    v_pk_add_f32 v[18:19], v[18:19], 1.0 op_sel_hi:[1,0]
    v_cvt_pk_bf16_f32 v8, v16, v17
    v_cvt_pk_bf16_f32 v9, v18, v19
    v_lshlrev_b32 v16, 16, v8
    v_and_b32 v17, 0xffff0000, v8
    v_lshlrev_b32 v18, 16, v9
    v_and_b32 v19, 0xffff0000, v9
L0_issa:
    s_mov_b32 s14, 0x3e0293ee
    v_pk_mul_f32 v[16:17], v[16:17], s[14:15] op_sel_hi:[1,0]
    v_pk_mul_f32 v[18:19], v[18:19], s[14:15] op_sel_hi:[1,0]
    ds_write_b128 v73, v[16:19]
    s_lshl_b32 s76, s35, 13
    s_waitcnt lgkmcnt(0)
    s_barrier
    ds_read_b128 v[16:19], v75 offset:0
    ds_read_b128 v[20:23], v75 offset:16
    ds_read_b128 v[24:27], v75 offset:2048
    ds_read_b128 v[28:31], v75 offset:2064
    ds_read_b128 v[32:35], v75 offset:1024
    ds_read_b128 v[36:39], v75 offset:1040
    ds_read_b128 v[40:43], v75 offset:3072
    ds_read_b128 v[44:47], v75 offset:3088
    s_waitcnt lgkmcnt(4)
    v_pk_fma_f32 v[96:97], v[96:97], v[24:25], v[16:17]
    v_pk_fma_f32 v[98:99], v[98:99], v[26:27], v[18:19]
    v_pk_fma_f32 v[100:101], v[100:101], v[28:29], v[20:21]
    v_pk_fma_f32 v[102:103], v[102:103], v[30:31], v[22:23]
    v_cvt_pk_bf16_f32 v56, v96, v97
    v_cvt_pk_bf16_f32 v57, v98, v99
    v_cvt_pk_bf16_f32 v58, v100, v101
    v_cvt_pk_bf16_f32 v59, v102, v103
    buffer_store_dwordx4 v[56:59], v64, s[56:59], s71 offen sc1
    s_waitcnt lgkmcnt(0)
    v_pk_fma_f32 v[104:105], v[104:105], v[40:41], v[32:33]
    v_pk_fma_f32 v[106:107], v[106:107], v[42:43], v[34:35]
    v_pk_fma_f32 v[108:109], v[108:109], v[44:45], v[36:37]
    v_pk_fma_f32 v[110:111], v[110:111], v[46:47], v[38:39]
    v_cvt_pk_bf16_f32 v60, v104, v105
    v_cvt_pk_bf16_f32 v61, v106, v107
    v_cvt_pk_bf16_f32 v62, v108, v109
    v_cvt_pk_bf16_f32 v63, v110, v111
    buffer_store_dwordx4 v[60:63], v65, s[56:59], s71 offen sc1
    ds_write_b128 v68, v[48:51]
    ds_write_b128 v68, v[52:55] offset:16
    s_mov_b32 s15, s76
    s_lshl_b32 s79, s35, 18
    s_add_u32 s79, s79, 1048576
    s_add_u32 s52, s32, s79
    s_addc_u32 s53, s33, 0
    s_mov_b32 s54, 0x40000
    s_mov_b32 s55, 0x20000
    s_lshl_b32 s79, s38, 19
    s_add_u32 s79, s79, 393216
    s_add_u32 s44, s6, s79
    s_addc_u32 s45, s7, 0
    s_mov_b32 s46, 0x20000
    s_mov_b32 s47, 0x20000
    s_add_u32 s48, s8, s79
    s_addc_u32 s49, s9, 0
    s_mov_b32 s50, 0x20000
    s_mov_b32 s51, 0x20000
    s_lshl_b32 s74, s37, 13
    s_add_u32 s75, s74, 4096
    s_add_u32 s76, s74, 262144
    s_add_u32 s77, s74, 266240
    s_mov_b32 s73, 0
    s_mov_b32 s70, 0
    v_lshlrev_b32 v128, 1, v254
    s_lshl_b32 s68, s2, 2
    s_add_u32 s68, s68, s34
    v_mov_b32 v208, 0
    v_mov_b32 v209, 0
    v_mov_b32 v210, 0
    v_mov_b32 v211, 0
    v_mov_b32 v212, 0
    v_mov_b32 v213, 0
    v_mov_b32 v214, 0
    v_mov_b32 v215, 0
    v_mov_b32 v216, 0
    v_mov_b32 v217, 0
    v_mov_b32 v218, 0
    v_mov_b32 v219, 0
    v_mov_b32 v220, 0
    v_mov_b32 v221, 0
    v_mov_b32 v222, 0
    v_mov_b32 v223, 0
    v_mov_b32 v224, 0
    v_mov_b32 v225, 0
    v_mov_b32 v226, 0
    v_mov_b32 v227, 0
    v_mov_b32 v228, 0
    v_mov_b32 v229, 0
    v_mov_b32 v230, 0
    v_mov_b32 v231, 0
    v_mov_b32 v232, 0
    v_mov_b32 v233, 0
    v_mov_b32 v234, 0
    v_mov_b32 v235, 0
    v_mov_b32 v236, 0
    v_mov_b32 v237, 0
    v_mov_b32 v238, 0
    v_mov_b32 v239, 0
    v_subrev_u32 v132, 116480, v242
    v_subrev_u32 v133, 116480, v252
    v_subrev_u32 v134, 66560, v242
    v_subrev_u32 v135, 66560, v252
    s_waitcnt vmcnt(0)
    s_barrier
    s_cmp_lg_u32 s34, 0
    s_cbranch_scc1 L_nsig1
    s_mov_b64 exec, 0xffffffff
    buffer_atomic_add v6, v7, s[40:43], s15 offen offset:0 sc1
    s_mov_b64 exec, -1
L_nsig1:
    s_add_u32 s79, s78, 1
    s_and_b32 s79, s79, 7
    s_lshl_b32 s79, s79, 19
    s_add_u32 m0, s39, 0
    s_nop 0
    buffer_load_dwordx4 v246, s[64:67], s79 offen offset:0 lds
    s_addk_i32 s79, 31744
    buffer_load_dwordx4 v246, s[64:67], s79 offen offset:1024 lds
    s_addk_i32 s79, 31744
    buffer_load_dwordx4 v251, s[64:67], s79 offen offset:2048 lds
    s_addk_i32 s79, 31744
    buffer_load_dwordx4 v251, s[64:67], s79 offen offset:3072 lds
    s_add_u32 s79, s78, 2
    s_and_b32 s79, s79, 7
    s_lshl_b32 s79, s79, 19
    s_add_u32 m0, s39, 16640
    s_nop 0
    buffer_load_dwordx4 v246, s[64:67], s79 offen offset:0 lds
    s_addk_i32 s79, 31744
    buffer_load_dwordx4 v246, s[64:67], s79 offen offset:1024 lds
    s_addk_i32 s79, 31744
    buffer_load_dwordx4 v251, s[64:67], s79 offen offset:2048 lds
    s_addk_i32 s79, 31744
    buffer_load_dwordx4 v251, s[64:67], s79 offen offset:3072 lds
    s_branch L_al
    .p2align 12
L_al:
    ds_read_b64_tr_b16 v[136:137], v242 offset:0
    ds_read_b64_tr_b16 v[138:139], v242 offset:1024
    ds_read_b64_tr_b16 v[140:141], v242 offset:8192
    ds_read_b64_tr_b16 v[142:143], v242 offset:9216
    ds_read_b64_tr_b16 v[144:145], v252 offset:0
    ds_read_b64_tr_b16 v[146:147], v252 offset:1024
    ds_read_b64_tr_b16 v[148:149], v252 offset:8192
    ds_read_b64_tr_b16 v[150:151], v252 offset:9216
    s_mov_b32 s97, 0
L_poll2:
    s_load_dword s96, s[98:99], 0 glc
    s_add_u32 s97, s97, 1
    s_cmp_gt_u32 s97, 200000
    s_cbranch_scc1 L_pout2
    s_waitcnt lgkmcnt(0)
    s_cmp_lt_u32 s96, 32
    s_cbranch_scc1 L_poll2
L_pout2:
    s_waitcnt lgkmcnt(0)
    s_add_u32 s72, s78, 0
    s_and_b32 s72, s72, 7
    s_lshl_b32 s72, s72, 12
    buffer_load_dwordx4 a[0:3], v247, s[52:55], s72 offen offset:0 sc1
    buffer_load_dwordx4 a[4:7], v247, s[52:55], s72 offen offset:2048 sc1
    buffer_load_dwordx4 a[8:11], v247, s[52:55], s72 offen offset:256 sc1
    buffer_load_dwordx4 a[12:15], v247, s[52:55], s72 offen offset:2304 sc1
    buffer_load_dwordx4 a[16:19], v248, s[52:55], s72 offen offset:0 sc1
    buffer_load_dwordx4 a[20:23], v248, s[52:55], s72 offen offset:2048 sc1
    buffer_load_dwordx4 a[24:27], v248, s[52:55], s72 offen offset:256 sc1
    buffer_load_dwordx4 a[28:31], v248, s[52:55], s72 offen offset:2304 sc1
    s_add_u32 s72, s78, 1
    s_and_b32 s72, s72, 7
    s_lshl_b32 s72, s72, 12
    buffer_load_dwordx4 a[32:35], v247, s[52:55], s72 offen offset:0 sc1
    buffer_load_dwordx4 a[36:39], v247, s[52:55], s72 offen offset:2048 sc1
    buffer_load_dwordx4 a[40:43], v247, s[52:55], s72 offen offset:256 sc1
    buffer_load_dwordx4 a[44:47], v247, s[52:55], s72 offen offset:2304 sc1
    s_waitcnt vmcnt(10) lgkmcnt(4)
    v_mfma_f32_16x16x32_bf16 v[0:3], v[136:139], a[0:3], 0
    ds_read_b64_tr_b16 v[152:153], v242 offset:256
    buffer_load_dwordx4 a[48:51], v248, s[52:55], s72 offen offset:0 sc1
    v_mfma_f32_16x16x32_bf16 v[0:3], v[140:143], a[4:7], v[0:3]
    s_waitcnt vmcnt(9)
    v_mfma_f32_16x16x32_bf16 v[4:7], v[136:139], a[8:11], 0
    ds_read_b64_tr_b16 v[154:155], v242 offset:1280
    v_mfma_f32_16x16x32_bf16 v[4:7], v[140:143], a[12:15], v[4:7]
    s_waitcnt vmcnt(7)
    v_mfma_f32_16x16x32_bf16 v[8:11], v[136:139], a[16:19], 0
    ds_read_b64_tr_b16 v[156:157], v242 offset:8448
    buffer_load_dwordx4 a[52:55], v248, s[52:55], s72 offen offset:2048 sc1
    v_mfma_f32_16x16x32_bf16 v[8:11], v[140:143], a[20:23], v[8:11]
    s_waitcnt vmcnt(6)
    v_mfma_f32_16x16x32_bf16 v[12:15], v[136:139], a[24:27], 0
    ds_read_b64_tr_b16 v[158:159], v242 offset:9472
    v_mfma_f32_16x16x32_bf16 v[12:15], v[140:143], a[28:31], v[12:15]
    s_waitcnt lgkmcnt(4)
    v_mfma_f32_16x16x32_bf16 v[16:19], v[144:147], a[0:3], 0
    ds_read_b64_tr_b16 v[160:161], v252 offset:256
    s_add_u32 s79, s78, 3
    v_mfma_f32_16x16x32_bf16 v[16:19], v[148:151], a[4:7], v[16:19]
    s_and_b32 s79, s79, 7
    s_lshl_b32 s79, s79, 19
    v_mfma_f32_16x16x32_bf16 v[20:23], v[144:147], a[8:11], 0
    ds_read_b64_tr_b16 v[162:163], v252 offset:1280
    buffer_load_dwordx4 a[56:59], v248, s[52:55], s72 offen offset:256 sc1
    v_mfma_f32_16x16x32_bf16 v[20:23], v[148:151], a[12:15], v[20:23]
    s_add_u32 m0, s39, 33280
    v_mfma_f32_16x16x32_bf16 v[24:27], v[144:147], a[16:19], 0
    ds_read_b64_tr_b16 v[164:165], v252 offset:8448
    v_mfma_f32_16x16x32_bf16 v[24:27], v[148:151], a[20:23], v[24:27]
    v_mfma_f32_16x16x32_bf16 v[28:31], v[144:147], a[24:27], 0
    ds_read_b64_tr_b16 v[166:167], v252 offset:9472
    buffer_load_dwordx4 a[60:63], v248, s[52:55], s72 offen offset:2304 sc1
    v_mfma_f32_16x16x32_bf16 v[28:31], v[148:151], a[28:31], v[28:31]
    s_waitcnt lgkmcnt(4)
    v_mfma_f32_16x16x32_bf16 v[32:35], v[152:155], a[0:3], 0
    ds_read_b64_tr_b16 v[136:137], v242 offset:512
    v_mfma_f32_16x16x32_bf16 v[32:35], v[156:159], a[4:7], v[32:35]
    v_mfma_f32_16x16x32_bf16 v[36:39], v[152:155], a[8:11], 0
    ds_read_b64_tr_b16 v[138:139], v242 offset:1536
    v_mfma_f32_16x16x32_bf16 v[36:39], v[156:159], a[12:15], v[36:39]
    v_mfma_f32_16x16x32_bf16 v[40:43], v[152:155], a[16:19], 0
    ds_read_b64_tr_b16 v[140:141], v242 offset:8704
    buffer_load_dwordx4 v246, s[64:67], s79 offen offset:0 lds
    v_mfma_f32_16x16x32_bf16 v[40:43], v[156:159], a[20:23], v[40:43]
    v_mfma_f32_16x16x32_bf16 v[44:47], v[152:155], a[24:27], 0
    ds_read_b64_tr_b16 v[142:143], v242 offset:9728
    s_addk_i32 s79, 31744
    v_mfma_f32_16x16x32_bf16 v[44:47], v[156:159], a[28:31], v[44:47]
    s_waitcnt lgkmcnt(4)
    v_mfma_f32_16x16x32_bf16 v[48:51], v[160:163], a[0:3], 0
    ds_read_b64_tr_b16 v[144:145], v252 offset:512
    buffer_load_dwordx4 v246, s[64:67], s79 offen offset:1024 lds
    v_mfma_f32_16x16x32_bf16 v[48:51], v[164:167], a[4:7], v[48:51]
    v_mfma_f32_16x16x32_bf16 v[52:55], v[160:163], a[8:11], 0
    ds_read_b64_tr_b16 v[146:147], v252 offset:1536
    s_addk_i32 s79, 31744
    v_mfma_f32_16x16x32_bf16 v[52:55], v[164:167], a[12:15], v[52:55]
    v_mfma_f32_16x16x32_bf16 v[56:59], v[160:163], a[16:19], 0
    ds_read_b64_tr_b16 v[148:149], v252 offset:8704
    v_mfma_f32_16x16x32_bf16 v[56:59], v[164:167], a[20:23], v[56:59]
    v_mfma_f32_16x16x32_bf16 v[60:63], v[160:163], a[24:27], 0
    ds_read_b64_tr_b16 v[150:151], v252 offset:9728
    buffer_load_dwordx4 v251, s[64:67], s79 offen offset:2048 lds
    v_mfma_f32_16x16x32_bf16 v[60:63], v[164:167], a[28:31], v[60:63]
    s_waitcnt lgkmcnt(4)
    v_mfma_f32_16x16x32_bf16 v[64:67], v[136:139], a[0:3], 0
    ds_read_b64_tr_b16 v[152:153], v242 offset:768
    s_addk_i32 s79, 31744
    v_mfma_f32_16x16x32_bf16 v[64:67], v[140:143], a[4:7], v[64:67]
    s_add_u32 s72, s78, 2
    s_and_b32 s72, s72, 7
    v_mfma_f32_16x16x32_bf16 v[68:71], v[136:139], a[8:11], 0
    ds_read_b64_tr_b16 v[154:155], v242 offset:1792
    buffer_load_dwordx4 v251, s[64:67], s79 offen offset:3072 lds
    v_mfma_f32_16x16x32_bf16 v[68:71], v[140:143], a[12:15], v[68:71]
    s_lshl_b32 s72, s72, 12
    v_mfma_f32_16x16x32_bf16 v[72:75], v[136:139], a[16:19], 0
    ds_read_b64_tr_b16 v[156:157], v242 offset:8960
    s_add_u32 s79, s78, 4
    v_mfma_f32_16x16x32_bf16 v[72:75], v[140:143], a[20:23], v[72:75]
    s_and_b32 s79, s79, 7
    s_lshl_b32 s79, s79, 19
    v_mfma_f32_16x16x32_bf16 v[76:79], v[136:139], a[24:27], 0
    ds_read_b64_tr_b16 v[158:159], v242 offset:9984
    s_add_u32 m0, s39, 49920
    v_mfma_f32_16x16x32_bf16 v[76:79], v[140:143], a[28:31], v[76:79]
    s_waitcnt lgkmcnt(4)
    v_mfma_f32_16x16x32_bf16 v[80:83], v[144:147], a[0:3], 0
    ds_read_b64_tr_b16 v[160:161], v252 offset:768
    buffer_load_dwordx4 v246, s[64:67], s79 offen offset:0 lds
    v_mfma_f32_16x16x32_bf16 v[80:83], v[148:151], a[4:7], v[80:83]
    v_mfma_f32_16x16x32_bf16 v[84:87], v[144:147], a[8:11], 0
    ds_read_b64_tr_b16 v[162:163], v252 offset:1792
    v_mfma_f32_16x16x32_bf16 v[84:87], v[148:151], a[12:15], v[84:87]
    v_mfma_f32_16x16x32_bf16 v[88:91], v[144:147], a[16:19], 0
    ds_read_b64_tr_b16 v[164:165], v252 offset:8960
    v_mfma_f32_16x16x32_bf16 v[88:91], v[148:151], a[20:23], v[88:91]
    buffer_load_dwordx4 a[64:67], v247, s[52:55], s72 offen offset:0 sc1
    v_mfma_f32_16x16x32_bf16 v[92:95], v[144:147], a[24:27], 0
    ds_read_b64_tr_b16 v[166:167], v252 offset:9984
    s_barrier
    v_mfma_f32_16x16x32_bf16 v[92:95], v[148:151], a[28:31], v[92:95]
    s_waitcnt lgkmcnt(4)
    v_mfma_f32_16x16x32_bf16 v[96:99], v[152:155], a[0:3], 0
    ds_read_b64_tr_b16 v[136:137], v132 offset:0
    v_mfma_f32_16x16x32_bf16 v[96:99], v[156:159], a[4:7], v[96:99]
    v_mfma_f32_16x16x32_bf16 v[100:103], v[152:155], a[8:11], 0
    ds_read_b64_tr_b16 v[138:139], v132 offset:1024
    buffer_load_dwordx4 a[68:71], v247, s[52:55], s72 offen offset:2048 sc1
    v_mfma_f32_16x16x32_bf16 v[100:103], v[156:159], a[12:15], v[100:103]
    v_mfma_f32_16x16x32_bf16 v[104:107], v[152:155], a[16:19], 0
    ds_read_b64_tr_b16 v[140:141], v132 offset:8192
    v_mfma_f32_16x16x32_bf16 v[104:107], v[156:159], a[20:23], v[104:107]
    v_mfma_f32_16x16x32_bf16 v[108:111], v[152:155], a[24:27], 0
    ds_read_b64_tr_b16 v[142:143], v132 offset:9216
    buffer_load_dwordx4 a[72:75], v247, s[52:55], s72 offen offset:256 sc1
    v_mfma_f32_16x16x32_bf16 v[108:111], v[156:159], a[28:31], v[108:111]
    s_waitcnt lgkmcnt(4)
    v_mfma_f32_16x16x32_bf16 v[112:115], v[160:163], a[0:3], 0
    ds_read_b64_tr_b16 v[144:145], v133 offset:0
    v_mfma_f32_16x16x32_bf16 v[112:115], v[164:167], a[4:7], v[112:115]
    v_mfma_f32_16x16x32_bf16 v[116:119], v[160:163], a[8:11], 0
    ds_read_b64_tr_b16 v[146:147], v133 offset:1024
    v_mfma_f32_16x16x32_bf16 v[116:119], v[164:167], a[12:15], v[116:119]
    v_mfma_f32_16x16x32_bf16 v[120:123], v[160:163], a[16:19], 0
    ds_read_b64_tr_b16 v[148:149], v133 offset:8192
    buffer_load_dwordx4 a[76:79], v247, s[52:55], s72 offen offset:2304 sc1
    v_mfma_f32_16x16x32_bf16 v[120:123], v[164:167], a[20:23], v[120:123]
    v_mfma_f32_16x16x32_bf16 v[124:127], v[160:163], a[24:27], 0
    ds_read_b64_tr_b16 v[150:151], v133 offset:9216
    v_mfma_f32_16x16x32_bf16 v[124:127], v[164:167], a[28:31], v[124:127]
    s_waitcnt vmcnt(15) lgkmcnt(4)
    v_mfma_f32_16x16x32_bf16 v[0:3], v[136:139], a[32:35], v[0:3]
    ds_read_b64_tr_b16 v[152:153], v132 offset:256
    buffer_load_dwordx4 a[80:83], v248, s[52:55], s72 offen offset:0 sc1
    v_mfma_f32_16x16x32_bf16 v[0:3], v[140:143], a[36:39], v[0:3]
    s_waitcnt vmcnt(14)
    v_mfma_f32_16x16x32_bf16 v[4:7], v[136:139], a[40:43], v[4:7]
    ds_read_b64_tr_b16 v[154:155], v132 offset:1280
    v_mfma_f32_16x16x32_bf16 v[4:7], v[140:143], a[44:47], v[4:7]
    s_waitcnt vmcnt(12)
    v_mfma_f32_16x16x32_bf16 v[8:11], v[136:139], a[48:51], v[8:11]
    ds_read_b64_tr_b16 v[156:157], v132 offset:8448
    v_mfma_f32_16x16x32_bf16 v[8:11], v[140:143], a[52:55], v[8:11]
    s_waitcnt vmcnt(10)
    v_mfma_f32_16x16x32_bf16 v[12:15], v[136:139], a[56:59], v[12:15]
    ds_read_b64_tr_b16 v[158:159], v132 offset:9472
    buffer_load_dwordx4 a[84:87], v248, s[52:55], s72 offen offset:2048 sc1
    v_mfma_f32_16x16x32_bf16 v[12:15], v[140:143], a[60:63], v[12:15]
    s_waitcnt lgkmcnt(4)
    v_mfma_f32_16x16x32_bf16 v[16:19], v[144:147], a[32:35], v[16:19]
    ds_read_b64_tr_b16 v[160:161], v133 offset:256
    s_addk_i32 s79, 31744
    v_mfma_f32_16x16x32_bf16 v[16:19], v[148:151], a[36:39], v[16:19]
    v_mfma_f32_16x16x32_bf16 v[20:23], v[144:147], a[40:43], v[20:23]
    ds_read_b64_tr_b16 v[162:163], v133 offset:1280
    buffer_load_dwordx4 a[88:91], v248, s[52:55], s72 offen offset:256 sc1
    v_mfma_f32_16x16x32_bf16 v[20:23], v[148:151], a[44:47], v[20:23]
    v_mfma_f32_16x16x32_bf16 v[24:27], v[144:147], a[48:51], v[24:27]
    ds_read_b64_tr_b16 v[164:165], v133 offset:8448
    v_mfma_f32_16x16x32_bf16 v[24:27], v[148:151], a[52:55], v[24:27]
    v_mfma_f32_16x16x32_bf16 v[28:31], v[144:147], a[56:59], v[28:31]
    ds_read_b64_tr_b16 v[166:167], v133 offset:9472
    v_mfma_f32_16x16x32_bf16 v[28:31], v[148:151], a[60:63], v[28:31]
    s_waitcnt lgkmcnt(4)
    v_mfma_f32_16x16x32_bf16 v[32:35], v[152:155], a[32:35], v[32:35]
    ds_read_b64_tr_b16 v[136:137], v132 offset:512
    buffer_load_dwordx4 a[92:95], v248, s[52:55], s72 offen offset:2304 sc1
    v_mfma_f32_16x16x32_bf16 v[32:35], v[156:159], a[36:39], v[32:35]
    v_mov_b32 v184, 0x3f803f80
    v_mov_b32 v185, 0x3f803f80
    v_mfma_f32_16x16x32_bf16 v[36:39], v[152:155], a[40:43], v[36:39]
    ds_read_b64_tr_b16 v[138:139], v132 offset:1536
    s_lshl_b32 s68, s2, 2
    v_mfma_f32_16x16x32_bf16 v[36:39], v[156:159], a[44:47], v[36:39]
    v_mov_b32 v186, 0x3f803f80
    v_mov_b32 v187, 0x3f803f80
    v_mfma_f32_16x16x32_bf16 v[40:43], v[152:155], a[48:51], v[40:43]
    ds_read_b64_tr_b16 v[140:141], v132 offset:8704
    buffer_load_dwordx4 v246, s[64:67], s79 offen offset:1024 lds
    v_mfma_f32_16x16x32_bf16 v[40:43], v[156:159], a[52:55], v[40:43]
    s_add_u32 s68, s68, s34
    s_lshl_b32 s69, s68, 11
    v_mfma_f32_16x16x32_bf16 v[44:47], v[152:155], a[56:59], v[44:47]
    ds_read_b64_tr_b16 v[142:143], v132 offset:9728
    s_addk_i32 s79, 31744
    v_mfma_f32_16x16x32_bf16 v[44:47], v[156:159], a[60:63], v[44:47]
    v_lshl_add_u32 v188, v254, 1, s69
    s_waitcnt lgkmcnt(4)
    v_mfma_f32_16x16x32_bf16 v[48:51], v[160:163], a[32:35], v[48:51]
    ds_read_b64_tr_b16 v[144:145], v133 offset:512
    s_lshr_b32 s69, s68, 1
    v_mfma_f32_16x16x32_bf16 v[48:51], v[164:167], a[36:39], v[48:51]
    s_add_u32 s69, s69, s68
    s_addk_i32 s69, 1
    v_mfma_f32_16x16x32_bf16 v[52:55], v[160:163], a[40:43], v[52:55]
    ds_read_b64_tr_b16 v[146:147], v133 offset:1536
    buffer_load_dwordx4 v251, s[64:67], s79 offen offset:2048 lds
    v_mfma_f32_16x16x32_bf16 v[52:55], v[164:167], a[44:47], v[52:55]
    s_lshl_b32 s69, s69, 11
    v_lshl_add_u32 v189, v254, 1, s69
    v_mfma_f32_16x16x32_bf16 v[56:59], v[160:163], a[48:51], v[56:59]
    ds_read_b64_tr_b16 v[148:149], v133 offset:8704
    s_addk_i32 s79, 31744
    v_mfma_f32_16x16x32_bf16 v[56:59], v[164:167], a[52:55], v[56:59]
    s_add_u32 s72, s78, 3
    s_and_b32 s72, s72, 7
    v_mfma_f32_16x16x32_bf16 v[60:63], v[160:163], a[56:59], v[60:63]
    ds_read_b64_tr_b16 v[150:151], v133 offset:9728
    buffer_load_dwordx4 v251, s[64:67], s79 offen offset:3072 lds
    v_mfma_f32_16x16x32_bf16 v[60:63], v[164:167], a[60:63], v[60:63]
    s_lshl_b32 s72, s72, 12
    s_waitcnt lgkmcnt(4)
    v_mfma_f32_16x16x32_bf16 v[64:67], v[136:139], a[32:35], v[64:67]
    ds_read_b64_tr_b16 v[152:153], v132 offset:768
    s_add_u32 s79, s78, 5
    v_mfma_f32_16x16x32_bf16 v[64:67], v[140:143], a[36:39], v[64:67]
    s_and_b32 s79, s79, 7
    s_lshl_b32 s79, s79, 19
    v_mfma_f32_16x16x32_bf16 v[68:71], v[136:139], a[40:43], v[68:71]
    ds_read_b64_tr_b16 v[154:155], v132 offset:1792
    s_add_u32 m0, s39, 66560
    v_mfma_f32_16x16x32_bf16 v[68:71], v[140:143], a[44:47], v[68:71]
    s_lshr_b32 s68, s2, 3
    s_lshl_b32 s69, s36, 5
    v_mfma_f32_16x16x32_bf16 v[72:75], v[136:139], a[48:51], v[72:75]
    ds_read_b64_tr_b16 v[156:157], v132 offset:8960
    buffer_load_dwordx4 v246, s[64:67], s79 offen offset:0 lds
    v_mfma_f32_16x16x32_bf16 v[72:75], v[140:143], a[52:55], v[72:75]
    s_add_u32 s68, s68, s69
    s_lshl_b32 s68, s68, 2
    v_mfma_f32_16x16x32_bf16 v[76:79], v[136:139], a[56:59], v[76:79]
    ds_read_b64_tr_b16 v[158:159], v132 offset:9984
    s_add_u32 s68, s68, s34
    v_mfma_f32_16x16x32_bf16 v[76:79], v[140:143], a[60:63], v[76:79]
    s_lshl_b32 s69, s68, 13
    s_waitcnt lgkmcnt(4)
    v_mfma_f32_16x16x32_bf16 v[80:83], v[144:147], a[32:35], v[80:83]
    ds_read_b64_tr_b16 v[160:161], v133 offset:768
    buffer_load_dwordx4 a[96:99], v247, s[52:55], s72 offen offset:0 sc1
    v_mfma_f32_16x16x32_bf16 v[80:83], v[148:151], a[36:39], v[80:83]
    v_lshl_add_u32 v190, v254, 1, s69
    s_lshl_b32 s69, s35, 5
    v_mfma_f32_16x16x32_bf16 v[84:87], v[144:147], a[40:43], v[84:87]
    ds_read_b64_tr_b16 v[162:163], v133 offset:1792
    s_add_u32 s69, s69, s38
    v_mfma_f32_16x16x32_bf16 v[84:87], v[148:151], a[44:47], v[84:87]
    s_lshl_b32 s69, s69, 7
    s_add_u32 s69, s69, 196608
    v_mfma_f32_16x16x32_bf16 v[88:91], v[144:147], a[48:51], v[88:91]
    ds_read_b64_tr_b16 v[164:165], v133 offset:8960
    v_mov_b32 v191, s69
    v_mfma_f32_16x16x32_bf16 v[88:91], v[148:151], a[52:55], v[88:91]
    s_lshl_b32 s69, s35, 2
    s_add_u32 s69, s69, s34
    v_mfma_f32_16x16x32_bf16 v[92:95], v[144:147], a[56:59], v[92:95]
    ds_read_b64_tr_b16 v[166:167], v133 offset:9984
    buffer_load_dwordx4 a[100:103], v247, s[52:55], s72 offen offset:2048 sc1
    v_mfma_f32_16x16x32_bf16 v[92:95], v[148:151], a[60:63], v[92:95]
    s_lshl_b32 s69, s69, 3
    s_waitcnt lgkmcnt(4)
    v_mfma_f32_16x16x32_bf16 v[96:99], v[152:155], a[32:35], v[96:99]
    ds_read_b64_tr_b16 v[136:137], v132 offset:16640
    s_add_u32 s69, s69, s36
    v_mfma_f32_16x16x32_bf16 v[96:99], v[156:159], a[36:39], v[96:99]
    s_lshl_b32 s69, s69, 16
    s_add_u32 s69, s69, 22020096
    v_mfma_f32_16x16x32_bf16 v[100:103], v[152:155], a[40:43], v[100:103]
    ds_read_b64_tr_b16 v[138:139], v132 offset:17664
    buffer_load_dwordx4 a[104:107], v247, s[52:55], s72 offen offset:256 sc1
    v_mfma_f32_16x16x32_bf16 v[100:103], v[156:159], a[44:47], v[100:103]
    s_add_u32 s0, s32, s69
    s_addc_u32 s1, s33, 0
    v_mfma_f32_16x16x32_bf16 v[104:107], v[152:155], a[48:51], v[104:107]
    ds_read_b64_tr_b16 v[140:141], v132 offset:24832
    s_mov_b32 s71, 131072
    v_mfma_f32_16x16x32_bf16 v[104:107], v[156:159], a[52:55], v[104:107]
    s_lshl_b32 s68, s34, 15
    s_and_b32 s69, s37, 1
    v_mfma_f32_16x16x32_bf16 v[108:111], v[152:155], a[56:59], v[108:111]
    ds_read_b64_tr_b16 v[142:143], v132 offset:25856
    s_xor_b32 s69, s69, s34
    v_mfma_f32_16x16x32_bf16 v[108:111], v[156:159], a[60:63], v[108:111]
    s_lshl_b32 s69, s69, 15
    s_waitcnt lgkmcnt(4)
    v_mfma_f32_16x16x32_bf16 v[112:115], v[160:163], a[32:35], v[112:115]
    ds_read_b64_tr_b16 v[144:145], v133 offset:16640
    buffer_load_dwordx4 a[108:111], v247, s[52:55], s72 offen offset:2304 sc1
    v_mfma_f32_16x16x32_bf16 v[112:115], v[164:167], a[36:39], v[112:115]
    s_sub_u32 s69, s69, 131072
    v_mfma_f32_16x16x32_bf16 v[116:119], v[160:163], a[40:43], v[116:119]
    ds_read_b64_tr_b16 v[146:147], v133 offset:17664
    v_mfma_f32_16x16x32_bf16 v[116:119], v[164:167], a[44:47], v[116:119]
    v_mfma_f32_16x16x32_bf16 v[120:123], v[160:163], a[48:51], v[120:123]
    ds_read_b64_tr_b16 v[148:149], v133 offset:24832
    buffer_load_dwordx4 a[112:115], v248, s[52:55], s72 offen offset:0 sc1
    v_mfma_f32_16x16x32_bf16 v[120:123], v[164:167], a[52:55], v[120:123]
    v_mfma_f32_16x16x32_bf16 v[124:127], v[160:163], a[56:59], v[124:127]
    ds_read_b64_tr_b16 v[150:151], v133 offset:25856
    v_mfma_f32_16x16x32_bf16 v[124:127], v[164:167], a[60:63], v[124:127]
    s_waitcnt vmcnt(15) lgkmcnt(4)
    v_mfma_f32_16x16x32_bf16 v[0:3], v[136:139], a[64:67], v[0:3]
    ds_read_b64_tr_b16 v[152:153], v132 offset:16896
    v_mfma_f32_16x16x32_bf16 v[0:3], v[140:143], a[68:71], v[0:3]
    s_waitcnt vmcnt(13)
    v_mfma_f32_16x16x32_bf16 v[4:7], v[136:139], a[72:75], v[4:7]
    ds_read_b64_tr_b16 v[154:155], v132 offset:17920
    buffer_load_dwordx4 a[116:119], v248, s[52:55], s72 offen offset:2048 sc1
    v_mfma_f32_16x16x32_bf16 v[4:7], v[140:143], a[76:79], v[4:7]
    s_waitcnt vmcnt(12)
    v_mfma_f32_16x16x32_bf16 v[8:11], v[136:139], a[80:83], v[8:11]
    ds_read_b64_tr_b16 v[156:157], v132 offset:25088
    s_addk_i32 s79, 31744
    v_mfma_f32_16x16x32_bf16 v[8:11], v[140:143], a[84:87], v[8:11]
    s_waitcnt vmcnt(10)
    v_mfma_f32_16x16x32_bf16 v[12:15], v[136:139], a[88:91], v[12:15]
    ds_read_b64_tr_b16 v[158:159], v132 offset:26112
    buffer_load_dwordx4 a[120:123], v248, s[52:55], s72 offen offset:256 sc1
    v_mfma_f32_16x16x32_bf16 v[12:15], v[140:143], a[92:95], v[12:15]
    s_waitcnt lgkmcnt(4)
    v_mfma_f32_16x16x32_bf16 v[16:19], v[144:147], a[64:67], v[16:19]
    ds_read_b64_tr_b16 v[160:161], v133 offset:16896
    v_mfma_f32_16x16x32_bf16 v[16:19], v[148:151], a[68:71], v[16:19]
    v_mfma_f32_16x16x32_bf16 v[20:23], v[144:147], a[72:75], v[20:23]
    ds_read_b64_tr_b16 v[162:163], v133 offset:17920
    v_mfma_f32_16x16x32_bf16 v[20:23], v[148:151], a[76:79], v[20:23]
    v_mfma_f32_16x16x32_bf16 v[24:27], v[144:147], a[80:83], v[24:27]
    ds_read_b64_tr_b16 v[164:165], v133 offset:25088
    buffer_load_dwordx4 a[124:127], v248, s[52:55], s72 offen offset:2304 sc1
    v_mfma_f32_16x16x32_bf16 v[24:27], v[148:151], a[84:87], v[24:27]
    v_mfma_f32_16x16x32_bf16 v[28:31], v[144:147], a[88:91], v[28:31]
    ds_read_b64_tr_b16 v[166:167], v133 offset:26112
    v_mfma_f32_16x16x32_bf16 v[28:31], v[148:151], a[92:95], v[28:31]
    s_waitcnt lgkmcnt(4)
    v_mfma_f32_16x16x32_bf16 v[32:35], v[152:155], a[64:67], v[32:35]
    ds_read_b64_tr_b16 v[136:137], v132 offset:17152
    buffer_load_dwordx4 v246, s[64:67], s79 offen offset:1024 lds
    v_mfma_f32_16x16x32_bf16 v[32:35], v[156:159], a[68:71], v[32:35]
    v_mfma_f32_16x16x32_bf16 v[36:39], v[152:155], a[72:75], v[36:39]
    ds_read_b64_tr_b16 v[138:139], v132 offset:18176
    s_addk_i32 s79, 31744
    v_mfma_f32_16x16x32_bf16 v[36:39], v[156:159], a[76:79], v[36:39]
    v_mfma_f32_16x16x32_bf16 v[40:43], v[152:155], a[80:83], v[40:43]
    ds_read_b64_tr_b16 v[140:141], v132 offset:25344
    v_mfma_f32_16x16x32_bf16 v[40:43], v[156:159], a[84:87], v[40:43]
    v_mfma_f32_16x16x32_bf16 v[44:47], v[152:155], a[88:91], v[44:47]
    ds_read_b64_tr_b16 v[142:143], v132 offset:26368
    buffer_load_dwordx4 v251, s[64:67], s79 offen offset:2048 lds
    v_mfma_f32_16x16x32_bf16 v[44:47], v[156:159], a[92:95], v[44:47]
    s_waitcnt lgkmcnt(4)
    v_mfma_f32_16x16x32_bf16 v[48:51], v[160:163], a[64:67], v[48:51]
    ds_read_b64_tr_b16 v[144:145], v133 offset:17152
    s_addk_i32 s79, 31744
    v_mfma_f32_16x16x32_bf16 v[48:51], v[164:167], a[68:71], v[48:51]
    s_add_u32 s72, s78, 4
    s_and_b32 s72, s72, 7
    v_mfma_f32_16x16x32_bf16 v[52:55], v[160:163], a[72:75], v[52:55]
    ds_read_b64_tr_b16 v[146:147], v133 offset:18176
    buffer_load_dwordx4 v251, s[64:67], s79 offen offset:3072 lds
    v_mfma_f32_16x16x32_bf16 v[52:55], v[164:167], a[76:79], v[52:55]
    s_lshl_b32 s72, s72, 12
    v_mfma_f32_16x16x32_bf16 v[56:59], v[160:163], a[80:83], v[56:59]
    ds_read_b64_tr_b16 v[148:149], v133 offset:25344
    s_add_u32 s79, s78, 6
    v_mfma_f32_16x16x32_bf16 v[56:59], v[164:167], a[84:87], v[56:59]
    s_and_b32 s79, s79, 7
    s_lshl_b32 s79, s79, 19
    v_mfma_f32_16x16x32_bf16 v[60:63], v[160:163], a[88:91], v[60:63]
    ds_read_b64_tr_b16 v[150:151], v133 offset:26368
    s_add_u32 m0, s39, 83200
    v_mfma_f32_16x16x32_bf16 v[60:63], v[164:167], a[92:95], v[60:63]
    s_waitcnt lgkmcnt(4)
    v_mfma_f32_16x16x32_bf16 v[64:67], v[136:139], a[64:67], v[64:67]
    ds_read_b64_tr_b16 v[152:153], v132 offset:17408
    buffer_load_dwordx4 v246, s[64:67], s79 offen offset:0 lds
    v_mfma_f32_16x16x32_bf16 v[64:67], v[140:143], a[68:71], v[64:67]
    v_mfma_f32_16x16x32_bf16 v[68:71], v[136:139], a[72:75], v[68:71]
    ds_read_b64_tr_b16 v[154:155], v132 offset:18432
    v_mfma_f32_16x16x32_bf16 v[68:71], v[140:143], a[76:79], v[68:71]
    v_mfma_f32_16x16x32_bf16 v[72:75], v[136:139], a[80:83], v[72:75]
    ds_read_b64_tr_b16 v[156:157], v132 offset:25600
    buffer_load_dwordx4 a[128:131], v247, s[52:55], s72 offen offset:0 sc1
    v_mfma_f32_16x16x32_bf16 v[72:75], v[140:143], a[84:87], v[72:75]
    v_mfma_f32_16x16x32_bf16 v[76:79], v[136:139], a[88:91], v[76:79]
    ds_read_b64_tr_b16 v[158:159], v132 offset:26624
    v_mfma_f32_16x16x32_bf16 v[76:79], v[140:143], a[92:95], v[76:79]
    s_waitcnt lgkmcnt(4)
    v_mfma_f32_16x16x32_bf16 v[80:83], v[144:147], a[64:67], v[80:83]
    ds_read_b64_tr_b16 v[160:161], v133 offset:17408
    v_mfma_f32_16x16x32_bf16 v[80:83], v[148:151], a[68:71], v[80:83]
    v_mfma_f32_16x16x32_bf16 v[84:87], v[144:147], a[72:75], v[84:87]
    ds_read_b64_tr_b16 v[162:163], v133 offset:18432
    buffer_load_dwordx4 a[132:135], v247, s[52:55], s72 offen offset:2048 sc1
    v_mfma_f32_16x16x32_bf16 v[84:87], v[148:151], a[76:79], v[84:87]
    v_mfma_f32_16x16x32_bf16 v[88:91], v[144:147], a[80:83], v[88:91]
    ds_read_b64_tr_b16 v[164:165], v133 offset:25600
    v_mfma_f32_16x16x32_bf16 v[88:91], v[148:151], a[84:87], v[88:91]
    v_mfma_f32_16x16x32_bf16 v[92:95], v[144:147], a[88:91], v[92:95]
    ds_read_b64_tr_b16 v[166:167], v133 offset:26624
    s_barrier
    v_mfma_f32_16x16x32_bf16 v[92:95], v[148:151], a[92:95], v[92:95]
    buffer_load_dwordx4 a[136:139], v247, s[52:55], s72 offen offset:256 sc1
    s_waitcnt lgkmcnt(4)
    v_mfma_f32_16x16x32_bf16 v[96:99], v[152:155], a[64:67], v[96:99]
    ds_read_b64_tr_b16 v[136:137], v132 offset:33280
    v_mfma_f32_16x16x32_bf16 v[96:99], v[156:159], a[68:71], v[96:99]
    v_mfma_f32_16x16x32_bf16 v[100:103], v[152:155], a[72:75], v[100:103]
    ds_read_b64_tr_b16 v[138:139], v132 offset:34304
    v_mfma_f32_16x16x32_bf16 v[100:103], v[156:159], a[76:79], v[100:103]
    v_mfma_f32_16x16x32_bf16 v[104:107], v[152:155], a[80:83], v[104:107]
    ds_read_b64_tr_b16 v[140:141], v132 offset:41472
    buffer_load_dwordx4 a[140:143], v247, s[52:55], s72 offen offset:2304 sc1
    v_mfma_f32_16x16x32_bf16 v[104:107], v[156:159], a[84:87], v[104:107]
    v_mfma_f32_16x16x32_bf16 v[108:111], v[152:155], a[88:91], v[108:111]
    ds_read_b64_tr_b16 v[142:143], v132 offset:42496
    v_mfma_f32_16x16x32_bf16 v[108:111], v[156:159], a[92:95], v[108:111]
    s_waitcnt lgkmcnt(4)
    v_mfma_f32_16x16x32_bf16 v[112:115], v[160:163], a[64:67], v[112:115]
    ds_read_b64_tr_b16 v[144:145], v133 offset:33280
    buffer_load_dwordx4 a[144:147], v248, s[52:55], s72 offen offset:0 sc1
    v_mfma_f32_16x16x32_bf16 v[112:115], v[164:167], a[68:71], v[112:115]
    v_mfma_f32_16x16x32_bf16 v[116:119], v[160:163], a[72:75], v[116:119]
    ds_read_b64_tr_b16 v[146:147], v133 offset:34304
    v_mfma_f32_16x16x32_bf16 v[116:119], v[164:167], a[76:79], v[116:119]
    v_mfma_f32_16x16x32_bf16 v[120:123], v[160:163], a[80:83], v[120:123]
    ds_read_b64_tr_b16 v[148:149], v133 offset:41472
    v_mfma_f32_16x16x32_bf16 v[120:123], v[164:167], a[84:87], v[120:123]
    v_mfma_f32_16x16x32_bf16 v[124:127], v[160:163], a[88:91], v[124:127]
    ds_read_b64_tr_b16 v[150:151], v133 offset:42496
    buffer_load_dwordx4 a[148:151], v248, s[52:55], s72 offen offset:2048 sc1
    v_mfma_f32_16x16x32_bf16 v[124:127], v[164:167], a[92:95], v[124:127]
    s_waitcnt vmcnt(16) lgkmcnt(4)
    v_mfma_f32_16x16x32_bf16 v[0:3], v[136:139], a[96:99], v[0:3]
    ds_read_b64_tr_b16 v[152:153], v132 offset:33536
    s_addk_i32 s79, 31744
    v_mfma_f32_16x16x32_bf16 v[0:3], v[140:143], a[100:103], v[0:3]
    s_waitcnt vmcnt(14)
    v_mfma_f32_16x16x32_bf16 v[4:7], v[136:139], a[104:107], v[4:7]
    ds_read_b64_tr_b16 v[154:155], v132 offset:34560
    buffer_load_dwordx4 a[152:155], v248, s[52:55], s72 offen offset:256 sc1
    v_mfma_f32_16x16x32_bf16 v[4:7], v[140:143], a[108:111], v[4:7]
    s_waitcnt vmcnt(13)
    v_mfma_f32_16x16x32_bf16 v[8:11], v[136:139], a[112:115], v[8:11]
    ds_read_b64_tr_b16 v[156:157], v132 offset:41728
    v_mfma_f32_16x16x32_bf16 v[8:11], v[140:143], a[116:119], v[8:11]
    s_waitcnt vmcnt(11)
    v_mfma_f32_16x16x32_bf16 v[12:15], v[136:139], a[120:123], v[12:15]
    ds_read_b64_tr_b16 v[158:159], v132 offset:42752
    v_mfma_f32_16x16x32_bf16 v[12:15], v[140:143], a[124:127], v[12:15]
    s_waitcnt lgkmcnt(4)
    v_mfma_f32_16x16x32_bf16 v[16:19], v[144:147], a[96:99], v[16:19]
    ds_read_b64_tr_b16 v[160:161], v133 offset:33536
    buffer_load_dwordx4 a[156:159], v248, s[52:55], s72 offen offset:2304 sc1
    v_mfma_f32_16x16x32_bf16 v[16:19], v[148:151], a[100:103], v[16:19]
    v_mfma_f32_16x16x32_bf16 v[20:23], v[144:147], a[104:107], v[20:23]
    ds_read_b64_tr_b16 v[162:163], v133 offset:34560
    v_mfma_f32_16x16x32_bf16 v[20:23], v[148:151], a[108:111], v[20:23]
    v_mfma_f32_16x16x32_bf16 v[24:27], v[144:147], a[112:115], v[24:27]
    ds_read_b64_tr_b16 v[164:165], v133 offset:41728
    buffer_load_dwordx4 v246, s[64:67], s79 offen offset:1024 lds
    v_mfma_f32_16x16x32_bf16 v[24:27], v[148:151], a[116:119], v[24:27]
    v_mfma_f32_16x16x32_bf16 v[28:31], v[144:147], a[120:123], v[28:31]
    ds_read_b64_tr_b16 v[166:167], v133 offset:42752
    s_addk_i32 s79, 31744
    v_mfma_f32_16x16x32_bf16 v[28:31], v[148:151], a[124:127], v[28:31]
    s_waitcnt lgkmcnt(4)
    v_mfma_f32_16x16x32_bf16 v[32:35], v[152:155], a[96:99], v[32:35]
    ds_read_b64_tr_b16 v[136:137], v132 offset:33792
    v_mfma_f32_16x16x32_bf16 v[32:35], v[156:159], a[100:103], v[32:35]
    v_mfma_f32_16x16x32_bf16 v[36:39], v[152:155], a[104:107], v[36:39]
    ds_read_b64_tr_b16 v[138:139], v132 offset:34816
    buffer_load_dwordx4 v251, s[64:67], s79 offen offset:2048 lds
    v_mfma_f32_16x16x32_bf16 v[36:39], v[156:159], a[108:111], v[36:39]
    v_mfma_f32_16x16x32_bf16 v[40:43], v[152:155], a[112:115], v[40:43]
    ds_read_b64_tr_b16 v[140:141], v132 offset:41984
    s_addk_i32 s79, 31744
    v_mfma_f32_16x16x32_bf16 v[40:43], v[156:159], a[116:119], v[40:43]
    s_add_u32 s72, s78, 5
    s_and_b32 s72, s72, 7
    v_mfma_f32_16x16x32_bf16 v[44:47], v[152:155], a[120:123], v[44:47]
    ds_read_b64_tr_b16 v[142:143], v132 offset:43008
    buffer_load_dwordx4 v251, s[64:67], s79 offen offset:3072 lds
    v_mfma_f32_16x16x32_bf16 v[44:47], v[156:159], a[124:127], v[44:47]
    s_lshl_b32 s72, s72, 12
    s_waitcnt lgkmcnt(4)
    v_mfma_f32_16x16x32_bf16 v[48:51], v[160:163], a[96:99], v[48:51]
    ds_read_b64_tr_b16 v[144:145], v133 offset:33792
    s_add_u32 s79, s78, 7
    v_mfma_f32_16x16x32_bf16 v[48:51], v[164:167], a[100:103], v[48:51]
    s_and_b32 s79, s79, 7
    s_lshl_b32 s79, s79, 19
    v_mfma_f32_16x16x32_bf16 v[52:55], v[160:163], a[104:107], v[52:55]
    ds_read_b64_tr_b16 v[146:147], v133 offset:34816
    s_add_u32 m0, s39, 99840
    v_mfma_f32_16x16x32_bf16 v[52:55], v[164:167], a[108:111], v[52:55]
    v_mfma_f32_16x16x32_bf16 v[56:59], v[160:163], a[112:115], v[56:59]
    ds_read_b64_tr_b16 v[148:149], v133 offset:41984
    buffer_load_dwordx4 v246, s[64:67], s79 offen offset:0 lds
    v_mfma_f32_16x16x32_bf16 v[56:59], v[164:167], a[116:119], v[56:59]
    v_mfma_f32_16x16x32_bf16 v[60:63], v[160:163], a[120:123], v[60:63]
    ds_read_b64_tr_b16 v[150:151], v133 offset:43008
    v_mfma_f32_16x16x32_bf16 v[60:63], v[164:167], a[124:127], v[60:63]
    s_waitcnt lgkmcnt(4)
    v_mfma_f32_16x16x32_bf16 v[64:67], v[136:139], a[96:99], v[64:67]
    ds_read_b64_tr_b16 v[152:153], v132 offset:34048
    buffer_load_dwordx4 a[160:163], v247, s[52:55], s72 offen offset:0 sc1
    v_mfma_f32_16x16x32_bf16 v[64:67], v[140:143], a[100:103], v[64:67]
    v_mfma_f32_16x16x32_bf16 v[68:71], v[136:139], a[104:107], v[68:71]
    ds_read_b64_tr_b16 v[154:155], v132 offset:35072
    v_mfma_f32_16x16x32_bf16 v[68:71], v[140:143], a[108:111], v[68:71]
    v_mfma_f32_16x16x32_bf16 v[72:75], v[136:139], a[112:115], v[72:75]
    ds_read_b64_tr_b16 v[156:157], v132 offset:42240
    v_mfma_f32_16x16x32_bf16 v[72:75], v[140:143], a[116:119], v[72:75]
    v_mfma_f32_16x16x32_bf16 v[76:79], v[136:139], a[120:123], v[76:79]
    ds_read_b64_tr_b16 v[158:159], v132 offset:43264
    buffer_load_dwordx4 a[164:167], v247, s[52:55], s72 offen offset:2048 sc1
    v_mfma_f32_16x16x32_bf16 v[76:79], v[140:143], a[124:127], v[76:79]
    s_waitcnt lgkmcnt(4)
    v_mfma_f32_16x16x32_bf16 v[80:83], v[144:147], a[96:99], v[80:83]
    ds_read_b64_tr_b16 v[160:161], v133 offset:34048
    v_mfma_f32_16x16x32_bf16 v[80:83], v[148:151], a[100:103], v[80:83]
    v_mfma_f32_16x16x32_bf16 v[84:87], v[144:147], a[104:107], v[84:87]
    ds_read_b64_tr_b16 v[162:163], v133 offset:35072
    buffer_load_dwordx4 a[168:171], v247, s[52:55], s72 offen offset:256 sc1
    v_mfma_f32_16x16x32_bf16 v[84:87], v[148:151], a[108:111], v[84:87]
    v_mfma_f32_16x16x32_bf16 v[88:91], v[144:147], a[112:115], v[88:91]
    s_waitcnt vmcnt(16)
    ds_read_b64_tr_b16 v[164:165], v133 offset:42240
    v_mfma_f32_16x16x32_bf16 v[88:91], v[148:151], a[116:119], v[88:91]
    v_mfma_f32_16x16x32_bf16 v[92:95], v[144:147], a[120:123], v[92:95]
    ds_read_b64_tr_b16 v[166:167], v133 offset:43264
    s_barrier
    v_mfma_f32_16x16x32_bf16 v[92:95], v[148:151], a[124:127], v[92:95]
    s_waitcnt lgkmcnt(4)
    v_mfma_f32_16x16x32_bf16 v[96:99], v[152:155], a[96:99], v[96:99]
    ds_read_b64_tr_b16 v[136:137], v134 offset:0
    buffer_load_dwordx4 a[172:175], v247, s[52:55], s72 offen offset:2304 sc1
L_pad0:
    s_cbranch_execz L_pad1
    v_mfma_f32_16x16x32_bf16 v[96:99], v[156:159], a[100:103], v[96:99]
    v_mfma_f32_16x16x32_bf16 v[100:103], v[152:155], a[104:107], v[100:103]
    ds_read_b64_tr_b16 v[138:139], v134 offset:1024
    v_mfma_f32_16x16x32_bf16 v[100:103], v[156:159], a[108:111], v[100:103]
    v_mfma_f32_16x16x32_bf16 v[104:107], v[152:155], a[112:115], v[104:107]
    ds_read_b64_tr_b16 v[140:141], v134 offset:8192
    buffer_load_dwordx4 a[176:179], v248, s[52:55], s72 offen offset:0 sc1
    v_mfma_f32_16x16x32_bf16 v[104:107], v[156:159], a[116:119], v[104:107]
    v_mfma_f32_16x16x32_bf16 v[108:111], v[152:155], a[120:123], v[108:111]
    ds_read_b64_tr_b16 v[142:143], v134 offset:9216
    v_mfma_f32_16x16x32_bf16 v[108:111], v[156:159], a[124:127], v[108:111]
    s_waitcnt lgkmcnt(4)
    v_mfma_f32_16x16x32_bf16 v[112:115], v[160:163], a[96:99], v[112:115]
    ds_read_b64_tr_b16 v[144:145], v135 offset:0
    v_mfma_f32_16x16x32_bf16 v[112:115], v[164:167], a[100:103], v[112:115]
    v_mfma_f32_16x16x32_bf16 v[116:119], v[160:163], a[104:107], v[116:119]
    ds_read_b64_tr_b16 v[146:147], v135 offset:1024
    buffer_load_dwordx4 a[180:183], v248, s[52:55], s72 offen offset:2048 sc1
    v_mfma_f32_16x16x32_bf16 v[116:119], v[164:167], a[108:111], v[116:119]
    v_mfma_f32_16x16x32_bf16 v[120:123], v[160:163], a[112:115], v[120:123]
    ds_read_b64_tr_b16 v[148:149], v135 offset:8192
    s_addk_i32 s79, 31744
    v_mfma_f32_16x16x32_bf16 v[120:123], v[164:167], a[116:119], v[120:123]
    v_mfma_f32_16x16x32_bf16 v[124:127], v[160:163], a[120:123], v[124:127]
    ds_read_b64_tr_b16 v[150:151], v135 offset:9216
    buffer_load_dwordx4 a[184:187], v248, s[52:55], s72 offen offset:256 sc1
    v_mfma_f32_16x16x32_bf16 v[124:127], v[164:167], a[124:127], v[124:127]
    s_waitcnt vmcnt(17) lgkmcnt(4)
    v_mfma_f32_16x16x32_bf16 v[0:3], v[136:139], a[128:131], v[0:3]
    ds_read_b64_tr_b16 v[152:153], v134 offset:256
    v_mfma_f32_16x16x32_bf16 v[0:3], v[140:143], a[132:135], v[0:3]
    s_waitcnt vmcnt(15)
    v_mfma_f32_16x16x32_bf16 v[4:7], v[136:139], a[136:139], v[4:7]
    ds_read_b64_tr_b16 v[154:155], v134 offset:1280
    v_mfma_f32_16x16x32_bf16 v[4:7], v[140:143], a[140:143], v[4:7]
    s_waitcnt vmcnt(13)
    v_mfma_f32_16x16x32_bf16 v[8:11], v[136:139], a[144:147], v[8:11]
    ds_read_b64_tr_b16 v[156:157], v134 offset:8448
    buffer_load_dwordx4 a[188:191], v248, s[52:55], s72 offen offset:2304 sc1
    v_mfma_f32_16x16x32_bf16 v[8:11], v[140:143], a[148:151], v[8:11]
    s_waitcnt vmcnt(12)
    v_mfma_f32_16x16x32_bf16 v[12:15], v[136:139], a[152:155], v[12:15]
    ds_read_b64_tr_b16 v[158:159], v134 offset:9472
    v_mfma_f32_16x16x32_bf16 v[12:15], v[140:143], a[156:159], v[12:15]
    s_waitcnt lgkmcnt(4)
    v_mfma_f32_16x16x32_bf16 v[16:19], v[144:147], a[128:131], v[16:19]
    ds_read_b64_tr_b16 v[160:161], v135 offset:256
    buffer_load_dwordx4 v246, s[64:67], s79 offen offset:1024 lds
    v_mfma_f32_16x16x32_bf16 v[16:19], v[148:151], a[132:135], v[16:19]
    v_mfma_f32_16x16x32_bf16 v[20:23], v[144:147], a[136:139], v[20:23]
    ds_read_b64_tr_b16 v[162:163], v135 offset:1280
    s_addk_i32 s79, 31744
    v_mfma_f32_16x16x32_bf16 v[20:23], v[148:151], a[140:143], v[20:23]
    v_mfma_f32_16x16x32_bf16 v[24:27], v[144:147], a[144:147], v[24:27]
    ds_read_b64_tr_b16 v[164:165], v135 offset:8448
    s_add_u32 s72, s78, 6
    v_mfma_f32_16x16x32_bf16 v[24:27], v[148:151], a[148:151], v[24:27]
    s_and_b32 s72, s72, 7
    s_lshl_b32 s72, s72, 12
    v_mfma_f32_16x16x32_bf16 v[28:31], v[144:147], a[152:155], v[28:31]
    ds_read_b64_tr_b16 v[166:167], v135 offset:9472
    buffer_load_dwordx4 v251, s[64:67], s79 offen offset:2048 lds
    v_mfma_f32_16x16x32_bf16 v[28:31], v[148:151], a[156:159], v[28:31]
    s_waitcnt lgkmcnt(4)
    v_mfma_f32_16x16x32_bf16 v[32:35], v[152:155], a[128:131], v[32:35]
    ds_read_b64_tr_b16 v[136:137], v134 offset:512
    s_addk_i32 s79, 31744
    v_mfma_f32_16x16x32_bf16 v[32:35], v[156:159], a[132:135], v[32:35]
    v_mfma_f32_16x16x32_bf16 v[36:39], v[152:155], a[136:139], v[36:39]
    ds_read_b64_tr_b16 v[138:139], v134 offset:1536
    buffer_load_dwordx4 v251, s[64:67], s79 offen offset:3072 lds
    v_mfma_f32_16x16x32_bf16 v[36:39], v[156:159], a[140:143], v[36:39]
    v_mfma_f32_16x16x32_bf16 v[40:43], v[152:155], a[144:147], v[40:43]
    ds_read_b64_tr_b16 v[140:141], v134 offset:8704
    v_mfma_f32_16x16x32_bf16 v[40:43], v[156:159], a[148:151], v[40:43]
    v_mfma_f32_16x16x32_bf16 v[44:47], v[152:155], a[152:155], v[44:47]
    ds_read_b64_tr_b16 v[142:143], v134 offset:9728
    v_mfma_f32_16x16x32_bf16 v[44:47], v[156:159], a[156:159], v[44:47]
    s_waitcnt lgkmcnt(4)
    v_mfma_f32_16x16x32_bf16 v[48:51], v[160:163], a[128:131], v[48:51]
    ds_read_b64_tr_b16 v[144:145], v135 offset:512
    buffer_load_dwordx4 a[192:195], v247, s[52:55], s72 offen offset:0 sc1
    v_mfma_f32_16x16x32_bf16 v[48:51], v[164:167], a[132:135], v[48:51]
    v_mfma_f32_16x16x32_bf16 v[52:55], v[160:163], a[136:139], v[52:55]
    ds_read_b64_tr_b16 v[146:147], v135 offset:1536
    v_mfma_f32_16x16x32_bf16 v[52:55], v[164:167], a[140:143], v[52:55]
    v_mfma_f32_16x16x32_bf16 v[56:59], v[160:163], a[144:147], v[56:59]
    ds_read_b64_tr_b16 v[148:149], v135 offset:8704
    buffer_load_dwordx4 a[196:199], v247, s[52:55], s72 offen offset:2048 sc1
    v_mfma_f32_16x16x32_bf16 v[56:59], v[164:167], a[148:151], v[56:59]
    v_mfma_f32_16x16x32_bf16 v[60:63], v[160:163], a[152:155], v[60:63]
    ds_read_b64_tr_b16 v[150:151], v135 offset:9728
    v_mfma_f32_16x16x32_bf16 v[60:63], v[164:167], a[156:159], v[60:63]
    s_waitcnt lgkmcnt(4)
    v_mfma_f32_16x16x32_bf16 v[64:67], v[136:139], a[128:131], v[64:67]
    ds_read_b64_tr_b16 v[152:153], v134 offset:768
    v_mfma_f32_16x16x32_bf16 v[64:67], v[140:143], a[132:135], v[64:67]
    v_mfma_f32_16x16x32_bf16 v[68:71], v[136:139], a[136:139], v[68:71]
    ds_read_b64_tr_b16 v[154:155], v134 offset:1792
    buffer_load_dwordx4 a[200:203], v247, s[52:55], s72 offen offset:256 sc1
    v_mfma_f32_16x16x32_bf16 v[68:71], v[140:143], a[140:143], v[68:71]
    v_mfma_f32_16x16x32_bf16 v[72:75], v[136:139], a[144:147], v[72:75]
    ds_read_b64_tr_b16 v[156:157], v134 offset:8960
    v_mfma_f32_16x16x32_bf16 v[72:75], v[140:143], a[148:151], v[72:75]
    v_mfma_f32_16x16x32_bf16 v[76:79], v[136:139], a[152:155], v[76:79]
    ds_read_b64_tr_b16 v[158:159], v134 offset:9984
    buffer_load_dwordx4 a[204:207], v247, s[52:55], s72 offen offset:2304 sc1
    v_mfma_f32_16x16x32_bf16 v[76:79], v[140:143], a[156:159], v[76:79]
    s_waitcnt lgkmcnt(4)
    v_mfma_f32_16x16x32_bf16 v[80:83], v[144:147], a[128:131], v[80:83]
    ds_read_b64_tr_b16 v[160:161], v135 offset:768
    v_mfma_f32_16x16x32_bf16 v[80:83], v[148:151], a[132:135], v[80:83]
    v_mfma_f32_16x16x32_bf16 v[84:87], v[144:147], a[136:139], v[84:87]
    ds_read_b64_tr_b16 v[162:163], v135 offset:1792
    v_mfma_f32_16x16x32_bf16 v[84:87], v[148:151], a[140:143], v[84:87]
    v_mfma_f32_16x16x32_bf16 v[88:91], v[144:147], a[144:147], v[88:91]
    ds_read_b64_tr_b16 v[164:165], v135 offset:8960
    buffer_load_dwordx4 a[208:211], v248, s[52:55], s72 offen offset:0 sc1
    v_mfma_f32_16x16x32_bf16 v[88:91], v[148:151], a[148:151], v[88:91]
    v_mfma_f32_16x16x32_bf16 v[92:95], v[144:147], a[152:155], v[92:95]
    ds_read_b64_tr_b16 v[166:167], v135 offset:9984
    v_mfma_f32_16x16x32_bf16 v[92:95], v[148:151], a[156:159], v[92:95]
    s_waitcnt lgkmcnt(4)
    v_mfma_f32_16x16x32_bf16 v[96:99], v[152:155], a[128:131], v[96:99]
    ds_read_b64_tr_b16 v[136:137], v134 offset:16640
    buffer_load_dwordx4 a[212:215], v248, s[52:55], s72 offen offset:2048 sc1
    v_mfma_f32_16x16x32_bf16 v[96:99], v[156:159], a[132:135], v[96:99]
    v_mfma_f32_16x16x32_bf16 v[100:103], v[152:155], a[136:139], v[100:103]
    ds_read_b64_tr_b16 v[138:139], v134 offset:17664
    v_mfma_f32_16x16x32_bf16 v[100:103], v[156:159], a[140:143], v[100:103]
    v_mfma_f32_16x16x32_bf16 v[104:107], v[152:155], a[144:147], v[104:107]
    ds_read_b64_tr_b16 v[140:141], v134 offset:24832
    v_mfma_f32_16x16x32_bf16 v[104:107], v[156:159], a[148:151], v[104:107]
    v_mfma_f32_16x16x32_bf16 v[108:111], v[152:155], a[152:155], v[108:111]
    ds_read_b64_tr_b16 v[142:143], v134 offset:25856
    buffer_load_dwordx4 a[216:219], v248, s[52:55], s72 offen offset:256 sc1
    v_mfma_f32_16x16x32_bf16 v[108:111], v[156:159], a[156:159], v[108:111]
    s_waitcnt lgkmcnt(4)
    v_mfma_f32_16x16x32_bf16 v[112:115], v[160:163], a[128:131], v[112:115]
    ds_read_b64_tr_b16 v[144:145], v135 offset:16640
    v_mfma_f32_16x16x32_bf16 v[112:115], v[164:167], a[132:135], v[112:115]
    v_mfma_f32_16x16x32_bf16 v[116:119], v[160:163], a[136:139], v[116:119]
    ds_read_b64_tr_b16 v[146:147], v135 offset:17664
    buffer_load_dwordx4 a[220:223], v248, s[52:55], s72 offen offset:2304 sc1
    v_mfma_f32_16x16x32_bf16 v[116:119], v[164:167], a[140:143], v[116:119]
    v_mfma_f32_16x16x32_bf16 v[120:123], v[160:163], a[144:147], v[120:123]
    ds_read_b64_tr_b16 v[148:149], v135 offset:24832
    s_add_u32 s72, s78, 7
    v_mfma_f32_16x16x32_bf16 v[120:123], v[164:167], a[148:151], v[120:123]
    s_and_b32 s72, s72, 7
    s_lshl_b32 s72, s72, 12
    v_mfma_f32_16x16x32_bf16 v[124:127], v[160:163], a[152:155], v[124:127]
    ds_read_b64_tr_b16 v[150:151], v135 offset:25856
    v_mfma_f32_16x16x32_bf16 v[124:127], v[164:167], a[156:159], v[124:127]
    s_waitcnt vmcnt(17) lgkmcnt(4)
    v_mfma_f32_16x16x32_bf16 v[0:3], v[136:139], a[160:163], v[0:3]
    ds_read_b64_tr_b16 v[152:153], v134 offset:16896
    buffer_load_dwordx4 a[224:227], v247, s[52:55], s72 offen offset:0 sc1
    v_mfma_f32_16x16x32_bf16 v[0:3], v[140:143], a[164:167], v[0:3]
    s_waitcnt vmcnt(16)
    v_mfma_f32_16x16x32_bf16 v[4:7], v[136:139], a[168:171], v[4:7]
    ds_read_b64_tr_b16 v[154:155], v134 offset:17920
    v_mfma_f32_16x16x32_bf16 v[4:7], v[140:143], a[172:175], v[4:7]
    s_waitcnt vmcnt(14)
    v_mfma_f32_16x16x32_bf16 v[8:11], v[136:139], a[176:179], v[8:11]
    ds_read_b64_tr_b16 v[156:157], v134 offset:25088
    buffer_load_dwordx4 a[228:231], v247, s[52:55], s72 offen offset:2048 sc1
    v_mfma_f32_16x16x32_bf16 v[8:11], v[140:143], a[180:183], v[8:11]
    s_waitcnt vmcnt(13)
    v_mfma_f32_16x16x32_bf16 v[12:15], v[136:139], a[184:187], v[12:15]
    ds_read_b64_tr_b16 v[158:159], v134 offset:26112
    v_mfma_f32_16x16x32_bf16 v[12:15], v[140:143], a[188:191], v[12:15]
    s_waitcnt lgkmcnt(4)
    v_mfma_f32_16x16x32_bf16 v[16:19], v[144:147], a[160:163], v[16:19]
    ds_read_b64_tr_b16 v[160:161], v135 offset:16896
    v_mfma_f32_16x16x32_bf16 v[16:19], v[148:151], a[164:167], v[16:19]
    v_mfma_f32_16x16x32_bf16 v[20:23], v[144:147], a[168:171], v[20:23]
    ds_read_b64_tr_b16 v[162:163], v135 offset:17920
    buffer_load_dwordx4 a[232:235], v247, s[52:55], s72 offen offset:256 sc1
    v_mfma_f32_16x16x32_bf16 v[20:23], v[148:151], a[172:175], v[20:23]
    v_mfma_f32_16x16x32_bf16 v[24:27], v[144:147], a[176:179], v[24:27]
    ds_read_b64_tr_b16 v[164:165], v135 offset:25088
    v_mfma_f32_16x16x32_bf16 v[24:27], v[148:151], a[180:183], v[24:27]
    v_mfma_f32_16x16x32_bf16 v[28:31], v[144:147], a[184:187], v[28:31]
    ds_read_b64_tr_b16 v[166:167], v135 offset:26112
    buffer_load_dwordx4 a[236:239], v247, s[52:55], s72 offen offset:2304 sc1
    v_mfma_f32_16x16x32_bf16 v[28:31], v[148:151], a[188:191], v[28:31]
    s_waitcnt lgkmcnt(4)
    v_mfma_f32_16x16x32_bf16 v[32:35], v[152:155], a[160:163], v[32:35]
    ds_read_b64_tr_b16 v[136:137], v134 offset:17152
    v_mfma_f32_16x16x32_bf16 v[32:35], v[156:159], a[164:167], v[32:35]
    v_mfma_f32_16x16x32_bf16 v[36:39], v[152:155], a[168:171], v[36:39]
    ds_read_b64_tr_b16 v[138:139], v134 offset:18176
    v_mfma_f32_16x16x32_bf16 v[36:39], v[156:159], a[172:175], v[36:39]
    v_mfma_f32_16x16x32_bf16 v[40:43], v[152:155], a[176:179], v[40:43]
    ds_read_b64_tr_b16 v[140:141], v134 offset:25344
    buffer_load_dwordx4 a[240:243], v248, s[52:55], s72 offen offset:0 sc1
    v_mfma_f32_16x16x32_bf16 v[40:43], v[156:159], a[180:183], v[40:43]
    v_mfma_f32_16x16x32_bf16 v[44:47], v[152:155], a[184:187], v[44:47]
    ds_read_b64_tr_b16 v[142:143], v134 offset:26368
    v_mfma_f32_16x16x32_bf16 v[44:47], v[156:159], a[188:191], v[44:47]
    s_waitcnt lgkmcnt(4)
    v_mfma_f32_16x16x32_bf16 v[48:51], v[160:163], a[160:163], v[48:51]
    ds_read_b64_tr_b16 v[144:145], v135 offset:17152
    buffer_load_dwordx4 a[244:247], v248, s[52:55], s72 offen offset:2048 sc1
    v_mfma_f32_16x16x32_bf16 v[48:51], v[164:167], a[164:167], v[48:51]
    v_mfma_f32_16x16x32_bf16 v[52:55], v[160:163], a[168:171], v[52:55]
    ds_read_b64_tr_b16 v[146:147], v135 offset:18176
    v_mfma_f32_16x16x32_bf16 v[52:55], v[164:167], a[172:175], v[52:55]
    v_mfma_f32_16x16x32_bf16 v[56:59], v[160:163], a[176:179], v[56:59]
    ds_read_b64_tr_b16 v[148:149], v135 offset:25344
    v_mfma_f32_16x16x32_bf16 v[56:59], v[164:167], a[180:183], v[56:59]
    v_mfma_f32_16x16x32_bf16 v[60:63], v[160:163], a[184:187], v[60:63]
    ds_read_b64_tr_b16 v[150:151], v135 offset:26368
    buffer_load_dwordx4 a[248:251], v248, s[52:55], s72 offen offset:256 sc1
    v_mfma_f32_16x16x32_bf16 v[60:63], v[164:167], a[188:191], v[60:63]
    s_waitcnt lgkmcnt(4)
    v_mfma_f32_16x16x32_bf16 v[64:67], v[136:139], a[160:163], v[64:67]
    ds_read_b64_tr_b16 v[152:153], v134 offset:17408
    v_mfma_f32_16x16x32_bf16 v[64:67], v[140:143], a[164:167], v[64:67]
    v_mfma_f32_16x16x32_bf16 v[68:71], v[136:139], a[168:171], v[68:71]
    ds_read_b64_tr_b16 v[154:155], v134 offset:18432
    buffer_load_dwordx4 a[252:255], v248, s[52:55], s72 offen offset:2304 sc1
    v_mfma_f32_16x16x32_bf16 v[68:71], v[140:143], a[172:175], v[68:71]
    v_mfma_f32_16x16x32_bf16 v[72:75], v[136:139], a[176:179], v[72:75]
    ds_read_b64_tr_b16 v[156:157], v134 offset:25600
    v_mfma_f32_16x16x32_bf16 v[72:75], v[140:143], a[180:183], v[72:75]
    v_mfma_f32_16x16x32_bf16 v[76:79], v[136:139], a[184:187], v[76:79]
    ds_read_b64_tr_b16 v[158:159], v134 offset:26624
    s_add_u32 m0, s3, 0
    v_mfma_f32_16x16x32_bf16 v[76:79], v[140:143], a[188:191], v[76:79]
    v_lshrrev_b32 v248, 7, v254
    s_waitcnt lgkmcnt(4)
    v_mfma_f32_16x16x32_bf16 v[80:83], v[144:147], a[160:163], v[80:83]
    ds_read_b64_tr_b16 v[160:161], v135 offset:17408
    buffer_load_dwordx4 v245, s[44:47], s70 offen offset:0 lds
    v_mfma_f32_16x16x32_bf16 v[80:83], v[148:151], a[164:167], v[80:83]
    s_addk_i32 m0, 16
    s_lshl_b32 s79, s34, 3
    v_mfma_f32_16x16x32_bf16 v[84:87], v[144:147], a[168:171], v[84:87]
    ds_read_b64_tr_b16 v[162:163], v135 offset:18432
    v_add_u32 v248, s79, v248
    v_mfma_f32_16x16x32_bf16 v[84:87], v[148:151], a[172:175], v[84:87]
    s_mov_b32 s79, 98304
    v_and_b32 v253, 0x70, v254
    v_mfma_f32_16x16x32_bf16 v[88:91], v[144:147], a[176:179], v[88:91]
    s_waitcnt vmcnt(17)
    ds_read_b64_tr_b16 v[164:165], v135 offset:25600
    v_mfma_f32_16x16x32_bf16 v[88:91], v[148:151], a[180:183], v[88:91]
    v_mad_u32_u24 v248, v248, s79, v253
    v_lshrrev_b32 v246, 6, v254
    v_mfma_f32_16x16x32_bf16 v[92:95], v[144:147], a[184:187], v[92:95]
    ds_read_b64_tr_b16 v[166:167], v135 offset:26624
    s_barrier
    v_mfma_f32_16x16x32_bf16 v[92:95], v[148:151], a[188:191], v[92:95]
    buffer_load_dwordx4 v245, s[44:47], s70 offen offset:1024 lds
    s_waitcnt lgkmcnt(4)
    v_mfma_f32_16x16x32_bf16 v[96:99], v[152:155], a[160:163], v[96:99]
    ds_read_b64_tr_b16 v[136:137], v134 offset:33280
    s_addk_i32 m0, 16
    v_mfma_f32_16x16x32_bf16 v[96:99], v[156:159], a[164:167], v[96:99]
    v_mul_u32_u24 v246, 2752, v246
    v_and_b32 v253, 0x30, v254
    v_mfma_f32_16x16x32_bf16 v[100:103], v[152:155], a[168:171], v[100:103]
    ds_read_b64_tr_b16 v[138:139], v134 offset:34304
    v_add_u32 v246, v246, v253
    v_mfma_f32_16x16x32_bf16 v[100:103], v[156:159], a[172:175], v[100:103]
    v_lshrrev_b32 v253, 9, v254
    v_lshlrev_b32 v253, 5, v253
    v_mfma_f32_16x16x32_bf16 v[104:107], v[152:155], a[176:179], v[104:107]
    ds_read_b64_tr_b16 v[140:141], v134 offset:41472
    buffer_load_dwordx4 v245, s[44:47], s70 offen offset:2048 lds
    v_mfma_f32_16x16x32_bf16 v[104:107], v[156:159], a[180:183], v[104:107]
    s_addk_i32 m0, 16
    v_xor_b32 v246, v253, v246
    v_mfma_f32_16x16x32_bf16 v[108:111], v[152:155], a[184:187], v[108:111]
    ds_read_b64_tr_b16 v[142:143], v134 offset:42496
    s_and_b32 s79, s38, 15
    v_mfma_f32_16x16x32_bf16 v[108:111], v[156:159], a[188:191], v[108:111]
    s_mul_i32 s79, s79, 192
    s_waitcnt lgkmcnt(4)
    v_mfma_f32_16x16x32_bf16 v[112:115], v[160:163], a[160:163], v[112:115]
    ds_read_b64_tr_b16 v[144:145], v135 offset:33280
    v_mfma_f32_16x16x32_bf16 v[112:115], v[164:167], a[164:167], v[112:115]
    s_add_u32 s64, s16, s79
    s_addc_u32 s65, s17, 0
    s_sub_u32 s66, 1409024, s79
    v_mfma_f32_16x16x32_bf16 v[116:119], v[160:163], a[168:171], v[116:119]
    ds_read_b64_tr_b16 v[146:147], v135 offset:34304
    buffer_load_dwordx4 v245, s[44:47], s70 offen offset:3072 lds
    v_mfma_f32_16x16x32_bf16 v[116:119], v[164:167], a[172:175], v[116:119]
    s_cmp_gt_u32 s79, 2688
    s_cselect_b32 s66, 0, s66
    v_mfma_f32_16x16x32_bf16 v[120:123], v[160:163], a[176:179], v[120:123]
    ds_read_b64_tr_b16 v[148:149], v135 offset:41472
    s_add_u32 m0, s39, 0
    v_mfma_f32_16x16x32_bf16 v[120:123], v[164:167], a[180:183], v[120:123]
    s_cmp_ge_u32 s79, 2688
    s_cselect_b32 s14, 0x1000000, 0
    v_mfma_f32_16x16x32_bf16 v[124:127], v[160:163], a[184:187], v[124:127]
    ds_read_b64_tr_b16 v[150:151], v135 offset:42496
    buffer_load_dwordx4 v245, s[48:51], s70 offen offset:0 lds
    v_mfma_f32_16x16x32_bf16 v[124:127], v[164:167], a[188:191], v[124:127]
    v_add_u32 v251, 7168, v255
    s_waitcnt vmcnt(19) lgkmcnt(4)
    v_mfma_f32_16x16x32_bf16 v[0:3], v[136:139], a[192:195], v[0:3]
    ds_read_b64_tr_b16 v[152:153], v134 offset:33536
    v_add_u32 v252, 14336, v255
    v_mfma_f32_16x16x32_bf16 v[0:3], v[140:143], a[196:199], v[0:3]
    v_add_u32 v253, 21504, v255
    s_waitcnt vmcnt(17)
    v_mfma_f32_16x16x32_bf16 v[4:7], v[136:139], a[200:203], v[4:7]
    ds_read_b64_tr_b16 v[154:155], v134 offset:34560
    s_mul_i32 s72, s34, 44032
    v_mfma_f32_16x16x32_bf16 v[4:7], v[140:143], a[204:207], v[4:7]
    s_or_b32 s15, s14, s72
    s_waitcnt vmcnt(15)
    v_mfma_f32_16x16x32_bf16 v[8:11], v[136:139], a[208:211], v[8:11]
    ds_read_b64_tr_b16 v[156:157], v134 offset:41728
    buffer_load_dwordx4 v250, s[48:51], s70 offen offset:1024 lds
    v_mfma_f32_16x16x32_bf16 v[8:11], v[140:143], a[212:215], v[8:11]
    s_mov_b64 s[52:53], s[26:27]
    s_waitcnt vmcnt(14)
    v_mfma_f32_16x16x32_bf16 v[12:15], v[136:139], a[216:219], v[12:15]
    ds_read_b64_tr_b16 v[158:159], v134 offset:42752
    s_mov_b32 s54, 0x300000
    v_mfma_f32_16x16x32_bf16 v[12:15], v[140:143], a[220:223], v[12:15]
    s_lshl_b32 s96, s38, 7
    s_waitcnt lgkmcnt(4)
    v_mfma_f32_16x16x32_bf16 v[16:19], v[144:147], a[192:195], v[16:19]
    ds_read_b64_tr_b16 v[160:161], v135 offset:33536
    s_add_u32 s96, s96, 2048
    v_mfma_f32_16x16x32_bf16 v[16:19], v[148:151], a[196:199], v[16:19]
    s_movk_i32 s97, 4096
    v_mfma_f32_16x16x32_bf16 v[20:23], v[144:147], a[200:203], v[20:23]
    ds_read_b64_tr_b16 v[162:163], v135 offset:34560
    buffer_load_dwordx4 v245, s[48:51], s70 offen offset:2048 lds
    v_mfma_f32_16x16x32_bf16 v[20:23], v[148:151], a[204:207], v[20:23]
    v_mfma_f32_16x16x32_bf16 v[24:27], v[144:147], a[208:211], v[24:27]
    ds_read_b64_tr_b16 v[164:165], v135 offset:41728
    v_mfma_f32_16x16x32_bf16 v[24:27], v[148:151], a[212:215], v[24:27]
    v_mfma_f32_16x16x32_bf16 v[28:31], v[144:147], a[216:219], v[28:31]
    ds_read_b64_tr_b16 v[166:167], v135 offset:42752
    v_mfma_f32_16x16x32_bf16 v[28:31], v[148:151], a[220:223], v[28:31]
    s_waitcnt lgkmcnt(4)
    v_mfma_f32_16x16x32_bf16 v[32:35], v[152:155], a[192:195], v[32:35]
    ds_read_b64_tr_b16 v[136:137], v134 offset:49920
    buffer_load_dwordx4 v250, s[48:51], s70 offen offset:3072 lds
    v_mfma_f32_16x16x32_bf16 v[32:35], v[156:159], a[196:199], v[32:35]
    s_addk_i32 s70, 16384
    v_mfma_f32_16x16x32_bf16 v[36:39], v[152:155], a[200:203], v[36:39]
    ds_read_b64_tr_b16 v[138:139], v134 offset:50944
    s_add_u32 m0, s3, 33280
    v_mfma_f32_16x16x32_bf16 v[36:39], v[156:159], a[204:207], v[36:39]
    v_mfma_f32_16x16x32_bf16 v[40:43], v[152:155], a[208:211], v[40:43]
    ds_read_b64_tr_b16 v[140:141], v134 offset:58112
    buffer_load_dwordx4 v245, s[44:47], s70 offen offset:0 lds
    v_mfma_f32_16x16x32_bf16 v[40:43], v[156:159], a[212:215], v[40:43]
    s_addk_i32 m0, 16
    v_mfma_f32_16x16x32_bf16 v[44:47], v[152:155], a[216:219], v[44:47]
    ds_read_b64_tr_b16 v[142:143], v134 offset:59136
    v_mfma_f32_16x16x32_bf16 v[44:47], v[156:159], a[220:223], v[44:47]
    s_waitcnt lgkmcnt(4)
    v_mfma_f32_16x16x32_bf16 v[48:51], v[160:163], a[192:195], v[48:51]
    ds_read_b64_tr_b16 v[144:145], v135 offset:49920
    v_mfma_f32_16x16x32_bf16 v[48:51], v[164:167], a[196:199], v[48:51]
    v_mfma_f32_16x16x32_bf16 v[52:55], v[160:163], a[200:203], v[52:55]
    ds_read_b64_tr_b16 v[146:147], v135 offset:50944
    buffer_load_dwordx4 v245, s[44:47], s70 offen offset:1024 lds
    v_mfma_f32_16x16x32_bf16 v[52:55], v[164:167], a[204:207], v[52:55]
    s_addk_i32 m0, 16
    v_mfma_f32_16x16x32_bf16 v[56:59], v[160:163], a[208:211], v[56:59]
    ds_read_b64_tr_b16 v[148:149], v135 offset:58112
    v_mfma_f32_16x16x32_bf16 v[56:59], v[164:167], a[212:215], v[56:59]
    v_mfma_f32_16x16x32_bf16 v[60:63], v[160:163], a[216:219], v[60:63]
    ds_read_b64_tr_b16 v[150:151], v135 offset:59136
    v_mfma_f32_16x16x32_bf16 v[60:63], v[164:167], a[220:223], v[60:63]
    s_waitcnt vmcnt(16) lgkmcnt(4)
    v_mfma_f32_16x16x32_bf16 v[0:3], v[136:139], a[224:227], v[0:3]
    ds_read_b64_tr_b16 v[152:153], v134 offset:33792
    buffer_load_dwordx4 v245, s[44:47], s70 offen offset:2048 lds
    v_mfma_f32_16x16x32_bf16 v[0:3], v[140:143], a[228:231], v[0:3]
    s_addk_i32 m0, 16
    s_waitcnt vmcnt(15)
    v_mfma_f32_16x16x32_bf16 v[4:7], v[136:139], a[232:235], v[4:7]
    ds_read_b64_tr_b16 v[154:155], v134 offset:34816
    v_mfma_f32_16x16x32_bf16 v[4:7], v[140:143], a[236:239], v[4:7]
    s_waitcnt vmcnt(13)
    v_mfma_f32_16x16x32_bf16 v[8:11], v[136:139], a[240:243], v[8:11]
    ds_read_b64_tr_b16 v[156:157], v134 offset:41984
    v_mfma_f32_16x16x32_bf16 v[8:11], v[140:143], a[244:247], v[8:11]
    s_waitcnt vmcnt(11)
    v_mfma_f32_16x16x32_bf16 v[12:15], v[136:139], a[248:251], v[12:15]
    ds_read_b64_tr_b16 v[158:159], v134 offset:43008
    buffer_load_dwordx4 v245, s[44:47], s70 offen offset:3072 lds
    v_mfma_f32_16x16x32_bf16 v[12:15], v[140:143], a[252:255], v[12:15]
    s_waitcnt lgkmcnt(4)
    v_mfma_f32_16x16x32_bf16 v[16:19], v[144:147], a[224:227], v[16:19]
    ds_read_b64_tr_b16 v[160:161], v135 offset:33792
    v_mfma_f32_16x16x32_bf16 v[16:19], v[148:151], a[228:231], v[16:19]
    v_mfma_f32_16x16x32_bf16 v[20:23], v[144:147], a[232:235], v[20:23]
    ds_read_b64_tr_b16 v[162:163], v135 offset:34816
    v_mfma_f32_16x16x32_bf16 v[20:23], v[148:151], a[236:239], v[20:23]
    v_mfma_f32_16x16x32_bf16 v[24:27], v[144:147], a[240:243], v[24:27]
    ds_read_b64_tr_b16 v[164:165], v135 offset:41984
    s_add_u32 m0, s39, 33280
    v_mfma_f32_16x16x32_bf16 v[24:27], v[148:151], a[244:247], v[24:27]
    v_mfma_f32_16x16x32_bf16 v[28:31], v[144:147], a[248:251], v[28:31]
    ds_read_b64_tr_b16 v[166:167], v135 offset:43008
    buffer_load_dwordx4 v245, s[48:51], s70 offen offset:0 lds
    v_mfma_f32_16x16x32_bf16 v[28:31], v[148:151], a[252:255], v[28:31]
    s_waitcnt lgkmcnt(4)
    v_mfma_f32_16x16x32_bf16 v[64:67], v[152:155], a[192:195], v[64:67]
    ds_read_b64_tr_b16 v[136:137], v134 offset:50176
    v_mfma_f32_16x16x32_bf16 v[64:67], v[156:159], a[196:199], v[64:67]
    v_mfma_f32_16x16x32_bf16 v[68:71], v[152:155], a[200:203], v[68:71]
    ds_read_b64_tr_b16 v[138:139], v134 offset:51200
    v_cvt_pk_bf16_f32 v192, v0, v1
    v_mfma_f32_16x16x32_bf16 v[68:71], v[156:159], a[204:207], v[68:71]
    v_cvt_pk_bf16_f32 v193, v2, v3
    v_cvt_pk_bf16_f32 v194, v16, v17
    v_mfma_f32_16x16x32_bf16 v[72:75], v[152:155], a[208:211], v[72:75]
    ds_read_b64_tr_b16 v[140:141], v134 offset:58368
    v_cvt_pk_bf16_f32 v195, v18, v19
    v_mfma_f32_16x16x32_bf16 v[72:75], v[156:159], a[212:215], v[72:75]
    v_cvt_pk_bf16_f32 v196, v4, v5
    v_cvt_pk_bf16_f32 v197, v6, v7
    v_mfma_f32_16x16x32_bf16 v[76:79], v[152:155], a[216:219], v[76:79]
    ds_read_b64_tr_b16 v[142:143], v134 offset:59392
    buffer_load_dwordx4 v250, s[48:51], s70 offen offset:1024 lds
    v_mfma_f32_16x16x32_bf16 v[76:79], v[156:159], a[220:223], v[76:79]
    v_cvt_pk_bf16_f32 v198, v20, v21
    s_waitcnt lgkmcnt(4)
    v_mfma_f32_16x16x32_bf16 v[80:83], v[160:163], a[192:195], v[80:83]
    ds_read_b64_tr_b16 v[144:145], v135 offset:50176
    v_cvt_pk_bf16_f32 v199, v22, v23
    v_mfma_f32_16x16x32_bf16 v[80:83], v[164:167], a[196:199], v[80:83]
    v_permlane16_swap_b32 v192, v194
    v_mfma_f32_16x16x32_bf16 v[84:87], v[160:163], a[200:203], v[84:87]
    ds_read_b64_tr_b16 v[146:147], v135 offset:51200
    v_mfma_f32_16x16x32_bf16 v[84:87], v[164:167], a[204:207], v[84:87]
    v_permlane16_swap_b32 v193, v195
    v_mfma_f32_16x16x32_bf16 v[88:91], v[160:163], a[208:211], v[88:91]
    ds_read_b64_tr_b16 v[148:149], v135 offset:58368
    v_mfma_f32_16x16x32_bf16 v[88:91], v[164:167], a[212:215], v[88:91]
    v_permlane16_swap_b32 v196, v198
    v_mfma_f32_16x16x32_bf16 v[92:95], v[160:163], a[216:219], v[92:95]
    ds_read_b64_tr_b16 v[150:151], v135 offset:59392
    buffer_load_dwordx4 v245, s[48:51], s70 offen offset:2048 lds
    v_mfma_f32_16x16x32_bf16 v[92:95], v[164:167], a[220:223], v[92:95]
    s_waitcnt lgkmcnt(4)
    v_mfma_f32_16x16x32_bf16 v[32:35], v[136:139], a[224:227], v[32:35]
    ds_read_b64_tr_b16 v[152:153], v134 offset:34048
    v_mfma_f32_16x16x32_bf16 v[32:35], v[140:143], a[228:231], v[32:35]
    v_permlane16_swap_b32 v197, v199
    v_accvgpr_write_b32 a0, v192
    v_mfma_f32_16x16x32_bf16 v[36:39], v[136:139], a[232:235], v[36:39]
    ds_read_b64_tr_b16 v[154:155], v134 offset:35072
    v_accvgpr_write_b32 a1, v193
    v_mfma_f32_16x16x32_bf16 v[36:39], v[140:143], a[236:239], v[36:39]
    v_accvgpr_write_b32 a2, v194
    v_accvgpr_write_b32 a3, v195
    v_mfma_f32_16x16x32_bf16 v[40:43], v[136:139], a[240:243], v[40:43]
    ds_read_b64_tr_b16 v[156:157], v134 offset:42240
    v_accvgpr_write_b32 a16, v196
    v_mfma_f32_16x16x32_bf16 v[40:43], v[140:143], a[244:247], v[40:43]
    v_accvgpr_write_b32 a17, v197
    v_accvgpr_write_b32 a18, v198
    v_mfma_f32_16x16x32_bf16 v[44:47], v[136:139], a[248:251], v[44:47]
    ds_read_b64_tr_b16 v[158:159], v134 offset:43264
    buffer_load_dwordx4 v250, s[48:51], s70 offen offset:3072 lds
    v_mfma_f32_16x16x32_bf16 v[44:47], v[140:143], a[252:255], v[44:47]
    s_addk_i32 s70, 16384
    s_waitcnt lgkmcnt(4)
    v_mfma_f32_16x16x32_bf16 v[48:51], v[144:147], a[224:227], v[48:51]
    ds_read_b64_tr_b16 v[160:161], v135 offset:34048
    v_accvgpr_write_b32 a19, v199
    v_mfma_f32_16x16x32_bf16 v[48:51], v[148:151], a[228:231], v[48:51]
    v_cvt_pk_bf16_f32 v200, v8, v9
    v_cvt_pk_bf16_f32 v201, v10, v11
    v_mfma_f32_16x16x32_bf16 v[52:55], v[144:147], a[232:235], v[52:55]
    ds_read_b64_tr_b16 v[162:163], v135 offset:35072
    v_cvt_pk_bf16_f32 v202, v24, v25
    v_mfma_f32_16x16x32_bf16 v[52:55], v[148:151], a[236:239], v[52:55]
    v_cvt_pk_bf16_f32 v203, v26, v27
    v_cvt_pk_bf16_f32 v204, v12, v13
    v_mfma_f32_16x16x32_bf16 v[56:59], v[144:147], a[240:243], v[56:59]
    ds_read_b64_tr_b16 v[164:165], v135 offset:42240
    s_add_u32 m0, s3, 66560
    v_mfma_f32_16x16x32_bf16 v[56:59], v[148:151], a[244:247], v[56:59]
    v_cvt_pk_bf16_f32 v205, v14, v15
    v_cvt_pk_bf16_f32 v206, v28, v29
    v_mfma_f32_16x16x32_bf16 v[60:63], v[144:147], a[248:251], v[60:63]
    ds_read_b64_tr_b16 v[166:167], v135 offset:43264
    buffer_load_dwordx4 v245, s[44:47], s70 offen offset:0 lds
    v_mfma_f32_16x16x32_bf16 v[60:63], v[148:151], a[252:255], v[60:63]
    s_addk_i32 m0, 16
    s_waitcnt lgkmcnt(4)
    v_mfma_f32_16x16x32_bf16 v[96:99], v[152:155], a[192:195], v[96:99]
    ds_read_b64_tr_b16 v[136:137], v134 offset:50432
    v_cvt_pk_bf16_f32 v207, v30, v31
    v_mfma_f32_16x16x32_bf16 v[96:99], v[156:159], a[196:199], v[96:99]
    v_permlane16_swap_b32 v200, v202
    v_mfma_f32_16x16x32_bf16 v[100:103], v[152:155], a[200:203], v[100:103]
    ds_read_b64_tr_b16 v[138:139], v134 offset:51456
    v_mfma_f32_16x16x32_bf16 v[100:103], v[156:159], a[204:207], v[100:103]
    v_permlane16_swap_b32 v201, v203
    v_mfma_f32_16x16x32_bf16 v[104:107], v[152:155], a[208:211], v[104:107]
    ds_read_b64_tr_b16 v[140:141], v134 offset:58624
    v_mfma_f32_16x16x32_bf16 v[104:107], v[156:159], a[212:215], v[104:107]
    v_permlane16_swap_b32 v204, v206
    v_mfma_f32_16x16x32_bf16 v[108:111], v[152:155], a[216:219], v[108:111]
    ds_read_b64_tr_b16 v[142:143], v134 offset:59648
    buffer_load_dwordx4 v245, s[44:47], s70 offen offset:1024 lds
    v_mfma_f32_16x16x32_bf16 v[108:111], v[156:159], a[220:223], v[108:111]
    s_addk_i32 m0, 16
    s_waitcnt lgkmcnt(4)
    v_mfma_f32_16x16x32_bf16 v[112:115], v[160:163], a[192:195], v[112:115]
    ds_read_b64_tr_b16 v[144:145], v135 offset:50432
    v_mfma_f32_16x16x32_bf16 v[112:115], v[164:167], a[196:199], v[112:115]
    v_permlane16_swap_b32 v205, v207
    v_accvgpr_write_b32 a32, v200
    v_mfma_f32_16x16x32_bf16 v[116:119], v[160:163], a[200:203], v[116:119]
    ds_read_b64_tr_b16 v[146:147], v135 offset:51456
    v_accvgpr_write_b32 a33, v201
    v_mfma_f32_16x16x32_bf16 v[116:119], v[164:167], a[204:207], v[116:119]
    v_accvgpr_write_b32 a34, v202
    v_accvgpr_write_b32 a35, v203
    v_mfma_f32_16x16x32_bf16 v[120:123], v[160:163], a[208:211], v[120:123]
    ds_read_b64_tr_b16 v[148:149], v135 offset:58624
    v_accvgpr_write_b32 a48, v204
    v_mfma_f32_16x16x32_bf16 v[120:123], v[164:167], a[212:215], v[120:123]
    v_accvgpr_write_b32 a49, v205
    v_accvgpr_write_b32 a50, v206
    v_mfma_f32_16x16x32_bf16 v[124:127], v[160:163], a[216:219], v[124:127]
    ds_read_b64_tr_b16 v[150:151], v135 offset:59648
    buffer_load_dwordx4 v245, s[44:47], s70 offen offset:2048 lds
    v_mfma_f32_16x16x32_bf16 v[124:127], v[164:167], a[220:223], v[124:127]
    s_addk_i32 m0, 16
    s_waitcnt lgkmcnt(4)
    v_mfma_f32_16x16x32_bf16 v[64:67], v[136:139], a[224:227], v[64:67]
    ds_read_b64_tr_b16 v[152:153], v134 offset:50688
    v_accvgpr_write_b32 a51, v207
    v_mfma_f32_16x16x32_bf16 v[64:67], v[140:143], a[228:231], v[64:67]
    v_cvt_pk_bf16_f32 v208, v32, v33
    v_cvt_pk_bf16_f32 v209, v34, v35
    v_mfma_f32_16x16x32_bf16 v[68:71], v[136:139], a[232:235], v[68:71]
    ds_read_b64_tr_b16 v[154:155], v134 offset:51712
    v_cvt_pk_bf16_f32 v210, v48, v49
    v_mfma_f32_16x16x32_bf16 v[68:71], v[140:143], a[236:239], v[68:71]
    v_cvt_pk_bf16_f32 v211, v50, v51
    v_cvt_pk_bf16_f32 v212, v36, v37
    v_mfma_f32_16x16x32_bf16 v[72:75], v[136:139], a[240:243], v[72:75]
    ds_read_b64_tr_b16 v[156:157], v134 offset:58880
    v_cvt_pk_bf16_f32 v213, v38, v39
    v_mfma_f32_16x16x32_bf16 v[72:75], v[140:143], a[244:247], v[72:75]
    v_cvt_pk_bf16_f32 v214, v52, v53
L_pad1:
    s_cbranch_execz L_pad2
    v_cvt_pk_bf16_f32 v215, v54, v55
    v_mfma_f32_16x16x32_bf16 v[76:79], v[136:139], a[248:251], v[76:79]
    ds_read_b64_tr_b16 v[158:159], v134 offset:59904
    buffer_load_dwordx4 v245, s[44:47], s70 offen offset:3072 lds
    v_mfma_f32_16x16x32_bf16 v[76:79], v[140:143], a[252:255], v[76:79]
    s_waitcnt lgkmcnt(4)
    v_mfma_f32_16x16x32_bf16 v[80:83], v[144:147], a[224:227], v[80:83]
    ds_read_b64_tr_b16 v[160:161], v135 offset:50688
    v_mfma_f32_16x16x32_bf16 v[80:83], v[148:151], a[228:231], v[80:83]
    v_permlane16_swap_b32 v208, v210
    v_mfma_f32_16x16x32_bf16 v[84:87], v[144:147], a[232:235], v[84:87]
    ds_read_b64_tr_b16 v[162:163], v135 offset:51712
    v_mfma_f32_16x16x32_bf16 v[84:87], v[148:151], a[236:239], v[84:87]
    v_permlane16_swap_b32 v209, v211
    v_mfma_f32_16x16x32_bf16 v[88:91], v[144:147], a[240:243], v[88:91]
    ds_read_b64_tr_b16 v[164:165], v135 offset:58880
    s_waitcnt vmcnt(16)
    v_mfma_f32_16x16x32_bf16 v[88:91], v[148:151], a[244:247], v[88:91]
    v_permlane16_swap_b32 v212, v214
    v_mfma_f32_16x16x32_bf16 v[92:95], v[144:147], a[248:251], v[92:95]
    ds_read_b64_tr_b16 v[166:167], v135 offset:59904
    s_barrier
    v_mfma_f32_16x16x32_bf16 v[92:95], v[148:151], a[252:255], v[92:95]
    s_waitcnt lgkmcnt(4)
    v_mfma_f32_16x16x32_bf16 v[96:99], v[152:155], a[224:227], v[96:99]
    ds_read_b128 a[64:67], v240 offset:0
    v_mfma_f32_16x16x32_bf16 v[96:99], v[156:159], a[228:231], v[96:99]
    v_permlane16_swap_b32 v213, v215
    v_accvgpr_write_b32 a4, v208
    v_mfma_f32_16x16x32_bf16 v[100:103], v[152:155], a[232:235], v[100:103]
    ds_read_b128 a[68:71], v240 offset:4160
    s_add_u32 m0, s39, 66560
    v_mfma_f32_16x16x32_bf16 v[100:103], v[156:159], a[236:239], v[100:103]
    v_accvgpr_write_b32 a5, v209
    v_accvgpr_write_b32 a6, v210
    v_mfma_f32_16x16x32_bf16 v[104:107], v[152:155], a[240:243], v[104:107]
    ds_read_b128 a[72:75], v240 offset:256
    buffer_load_dwordx4 v245, s[48:51], s70 offen offset:0 lds
    v_mfma_f32_16x16x32_bf16 v[104:107], v[156:159], a[244:247], v[104:107]
    v_accvgpr_write_b32 a7, v211
    v_accvgpr_write_b32 a20, v212
    v_mfma_f32_16x16x32_bf16 v[108:111], v[152:155], a[248:251], v[108:111]
    ds_read_b128 a[76:79], v240 offset:4416
    v_accvgpr_write_b32 a21, v213
    v_mfma_f32_16x16x32_bf16 v[108:111], v[156:159], a[252:255], v[108:111]
    v_accvgpr_write_b32 a22, v214
    s_waitcnt lgkmcnt(4)
    v_mfma_f32_16x16x32_bf16 v[112:115], v[160:163], a[224:227], v[112:115]
    ds_read_b128 a[80:83], v240 offset:512
    v_accvgpr_write_b32 a23, v215
    v_mfma_f32_16x16x32_bf16 v[112:115], v[164:167], a[228:231], v[112:115]
    v_cvt_pk_bf16_f32 v216, v40, v41
    v_cvt_pk_bf16_f32 v217, v42, v43
    v_mfma_f32_16x16x32_bf16 v[116:119], v[160:163], a[232:235], v[116:119]
    ds_read_b128 a[84:87], v240 offset:4672
    v_cvt_pk_bf16_f32 v218, v56, v57
    v_mfma_f32_16x16x32_bf16 v[116:119], v[164:167], a[236:239], v[116:119]
    v_cvt_pk_bf16_f32 v219, v58, v59
    v_cvt_pk_bf16_f32 v220, v44, v45
    v_mfma_f32_16x16x32_bf16 v[120:123], v[160:163], a[240:243], v[120:123]
    v_cvt_pk_bf16_f32 v221, v46, v47
    v_cvt_pk_bf16_f32 v222, v60, v61
    v_mfma_f32_16x16x32_bf16 v[120:123], v[164:167], a[244:247], v[120:123]
    v_cvt_pk_bf16_f32 v223, v62, v63
    v_mfma_f32_16x16x32_bf16 v[124:127], v[160:163], a[248:251], v[124:127]
    v_permlane16_swap_b32 v216, v218
    v_mfma_f32_16x16x32_bf16 v[124:127], v[164:167], a[252:255], v[124:127]
    s_waitcnt lgkmcnt(4)
    v_mfma_f32_16x16x32_bf16 v[0:3], a[64:67], a[0:3], v[224:227]
    ds_read_b128 a[88:91], v240 offset:768
    v_mfma_f32_16x16x32_bf16 v[4:7], a[64:67], a[16:19], v[228:231]
    buffer_load_dwordx4 v250, s[48:51], s70 offen offset:1024 lds
    v_mfma_f32_16x16x32_bf16 v[8:11], a[64:67], a[32:35], v[232:235]
    ds_read_b128 a[92:95], v240 offset:4928
    v_mfma_f32_16x16x32_bf16 v[12:15], a[64:67], a[48:51], v[236:239]
    v_permlane16_swap_b32 v217, v219
    v_mfma_f32_16x16x32_bf16 v[16:19], a[68:71], a[0:3], v[224:227]
    v_permlane16_swap_b32 v220, v222
    v_mfma_f32_16x16x32_bf16 v[20:23], a[68:71], a[16:19], v[228:231]
    v_permlane16_swap_b32 v221, v223
    v_mfma_f32_16x16x32_bf16 v[24:27], a[68:71], a[32:35], v[232:235]
    v_accvgpr_write_b32 a36, v216
    v_accvgpr_write_b32 a37, v217
    v_mfma_f32_16x16x32_bf16 v[28:31], a[68:71], a[48:51], v[236:239]
    v_accvgpr_write_b32 a38, v218
    s_waitcnt lgkmcnt(4)
    v_mfma_f32_16x16x32_bf16 v[0:3], a[72:75], a[4:7], v[0:3]
    buffer_load_dwordx4 v245, s[48:51], s70 offen offset:2048 lds
    v_accvgpr_write_b32 a39, v219
    v_accvgpr_write_b32 a52, v220
    v_accvgpr_write_b32 a53, v221
    v_accvgpr_write_b32 a54, v222
    v_accvgpr_write_b32 a55, v223
    v_mfma_f32_16x16x32_bf16 v[4:7], a[72:75], a[20:23], v[4:7]
    v_cvt_pk_bf16_f32 v192, v64, v65
    v_cvt_pk_bf16_f32 v193, v66, v67
    v_mfma_f32_16x16x32_bf16 v[8:11], a[72:75], a[36:39], v[8:11]
    v_cvt_pk_bf16_f32 v194, v80, v81
    v_cvt_pk_bf16_f32 v195, v82, v83
    v_mfma_f32_16x16x32_bf16 v[12:15], a[72:75], a[52:55], v[12:15]
    v_cvt_pk_bf16_f32 v196, v68, v69
    v_cvt_pk_bf16_f32 v197, v70, v71
    v_mfma_f32_16x16x32_bf16 v[16:19], a[76:79], a[4:7], v[16:19]
    v_cvt_pk_bf16_f32 v198, v84, v85
    v_cvt_pk_bf16_f32 v199, v86, v87
    v_mfma_f32_16x16x32_bf16 v[20:23], a[76:79], a[20:23], v[20:23]
    v_permlane16_swap_b32 v192, v194
    v_mfma_f32_16x16x32_bf16 v[24:27], a[76:79], a[36:39], v[24:27]
    v_permlane16_swap_b32 v193, v195
    v_permlane16_swap_b32 v196, v198
    v_permlane16_swap_b32 v197, v199
    v_accvgpr_write_b32 a8, v192
    v_accvgpr_write_b32 a9, v193
    v_accvgpr_write_b32 a10, v194
    v_accvgpr_write_b32 a11, v195
    v_accvgpr_write_b32 a24, v196
    v_accvgpr_write_b32 a25, v197
    v_accvgpr_write_b32 a26, v198
    v_accvgpr_write_b32 a27, v199
    v_mfma_f32_16x16x32_bf16 v[28:31], a[76:79], a[52:55], v[28:31]
    buffer_load_dwordx4 v250, s[48:51], s70 offen offset:3072 lds
    v_cvt_pk_bf16_f32 v200, v72, v73
    s_waitcnt lgkmcnt(2)
    v_mfma_f32_16x16x32_bf16 v[0:3], a[80:83], a[8:11], v[0:3]
    ds_read_b128 a[64:67], v240 offset:8320
    s_addk_i32 s70, 16384
    v_cvt_pk_bf16_f32 v201, v74, v75
    v_cvt_pk_bf16_f32 v202, v88, v89
    v_cvt_pk_bf16_f32 v203, v90, v91
    v_cvt_pk_bf16_f32 v204, v76, v77
    v_cvt_pk_bf16_f32 v205, v78, v79
    v_cvt_pk_bf16_f32 v206, v92, v93
    v_cvt_pk_bf16_f32 v207, v94, v95
    v_permlane16_swap_b32 v200, v202
    v_permlane16_swap_b32 v201, v203
    v_permlane16_swap_b32 v204, v206
    v_permlane16_swap_b32 v205, v207
    v_accvgpr_write_b32 a40, v200
    v_accvgpr_write_b32 a41, v201
    v_accvgpr_write_b32 a42, v202
    v_accvgpr_write_b32 a43, v203
    v_accvgpr_write_b32 a56, v204
    v_accvgpr_write_b32 a57, v205
    v_accvgpr_write_b32 a58, v206
    v_accvgpr_write_b32 a59, v207
    v_mfma_f32_16x16x32_bf16 v[4:7], a[80:83], a[24:27], v[4:7]
    v_cvt_pk_bf16_f32 v208, v96, v97
    v_cvt_pk_bf16_f32 v209, v98, v99
    v_mfma_f32_16x16x32_bf16 v[8:11], a[80:83], a[40:43], v[8:11]
    v_cvt_pk_bf16_f32 v210, v112, v113
    v_cvt_pk_bf16_f32 v211, v114, v115
    v_mfma_f32_16x16x32_bf16 v[12:15], a[80:83], a[56:59], v[12:15]
    ds_read_b128 a[68:71], v240 offset:8576
    v_cvt_pk_bf16_f32 v212, v100, v101
    v_mfma_f32_16x16x32_bf16 v[16:19], a[84:87], a[8:11], v[16:19]
    v_cvt_pk_bf16_f32 v213, v102, v103
    v_cvt_pk_bf16_f32 v214, v116, v117
    v_mfma_f32_16x16x32_bf16 v[20:23], a[84:87], a[24:27], v[20:23]
    v_cvt_pk_bf16_f32 v215, v118, v119
    v_permlane16_swap_b32 v208, v210
    v_mfma_f32_16x16x32_bf16 v[24:27], a[84:87], a[40:43], v[24:27]
    ds_read_b128 a[72:75], v240 offset:8832
    v_permlane16_swap_b32 v209, v211
    v_permlane16_swap_b32 v212, v214
    v_permlane16_swap_b32 v213, v215
    v_accvgpr_write_b32 a12, v208
    v_accvgpr_write_b32 a13, v209
    v_accvgpr_write_b32 a14, v210
    v_accvgpr_write_b32 a15, v211
    v_accvgpr_write_b32 a28, v212
    v_accvgpr_write_b32 a29, v213
    v_accvgpr_write_b32 a30, v214
    v_accvgpr_write_b32 a31, v215
    v_mfma_f32_16x16x32_bf16 v[28:31], a[84:87], a[56:59], v[28:31]
    v_cvt_pk_bf16_f32 v216, v104, v105
    s_waitcnt lgkmcnt(3)
    v_mfma_f32_16x16x32_bf16 v[0:3], a[88:91], a[12:15], v[0:3]
    v_cvt_pk_bf16_f32 v217, v106, v107
    v_cvt_pk_bf16_f32 v218, v120, v121
    v_cvt_pk_bf16_f32 v219, v122, v123
    v_cvt_pk_bf16_f32 v220, v108, v109
    v_cvt_pk_bf16_f32 v221, v110, v111
    v_cvt_pk_bf16_f32 v222, v124, v125
    v_cvt_pk_bf16_f32 v223, v126, v127
    v_permlane16_swap_b32 v216, v218
    v_permlane16_swap_b32 v217, v219
    v_permlane16_swap_b32 v220, v222
    v_permlane16_swap_b32 v221, v223
    v_accvgpr_write_b32 a44, v216
    v_accvgpr_write_b32 a45, v217
    v_accvgpr_write_b32 a46, v218
    v_accvgpr_write_b32 a47, v219
    v_accvgpr_write_b32 a60, v220
    v_accvgpr_write_b32 a61, v221
    v_accvgpr_write_b32 a62, v222
    v_accvgpr_write_b32 a63, v223
    v_mfma_f32_16x16x32_bf16 v[4:7], a[88:91], a[28:31], v[4:7]
    ds_read_b128 a[76:79], v240 offset:9088
    v_mfma_f32_16x16x32_bf16 v[8:11], a[88:91], a[44:47], v[8:11]
    v_mfma_f32_16x16x32_bf16 v[12:15], a[88:91], a[60:63], v[12:15]
    v_mfma_f32_16x16x32_bf16 v[16:19], a[92:95], a[12:15], v[16:19]
    v_mfma_f32_16x16x32_bf16 v[20:23], a[92:95], a[28:31], v[20:23]
    v_mfma_f32_16x16x32_bf16 v[24:27], a[92:95], a[44:47], v[24:27]
    v_mfma_f32_16x16x32_bf16 v[28:31], a[92:95], a[60:63], v[28:31]
    s_waitcnt lgkmcnt(0)
L1_qk1:
    v_mfma_f32_16x16x32_bf16 v[128:131], a[64:67], a[0:3], v[224:227]
    ds_read_b128 a[80:83], v240 offset:12480
    v_exp_f32 v0, v0
    v_mfma_f32_16x16x32_bf16 v[128:131], a[68:71], a[4:7], v[128:131]
    v_exp_f32 v1, v1
    v_mfma_f32_16x16x32_bf16 v[128:131], a[72:75], a[8:11], v[128:131]
    ds_read_b128 a[84:87], v240 offset:12736
    v_exp_f32 v2, v2
    v_mfma_f32_16x16x32_bf16 v[128:131], a[76:79], a[12:15], v[128:131]
    v_exp_f32 v3, v3
    v_cvt_pk_bf16_f32 v192, v0, v1
    v_mfma_f32_16x16x32_bf16 v[132:135], a[64:67], a[16:19], v[228:231]
    ds_read_b128 a[88:91], v240 offset:12992
    v_exp_f32 v4, v4
    v_mfma_f32_16x16x32_bf16 v[132:135], a[68:71], a[20:23], v[132:135]
    v_exp_f32 v5, v5
    v_cvt_pk_bf16_f32 v193, v2, v3
    v_mfma_f32_16x16x32_bf16 v[132:135], a[72:75], a[24:27], v[132:135]
    ds_read_b128 a[92:95], v240 offset:13248
    v_exp_f32 v6, v6
    v_mfma_f32_16x16x32_bf16 v[132:135], a[76:79], a[28:31], v[132:135]
    v_exp_f32 v7, v7
    v_cvt_pk_bf16_f32 v196, v4, v5
    v_mfma_f32_16x16x32_bf16 v[136:139], a[64:67], a[32:35], v[232:235]
    v_exp_f32 v8, v8
    v_cvt_pk_bf16_f32 v197, v6, v7
    v_mfma_f32_16x16x32_bf16 v[136:139], a[68:71], a[36:39], v[136:139]
    v_exp_f32 v9, v9
    v_mfma_f32_16x16x32_bf16 v[136:139], a[72:75], a[40:43], v[136:139]
    v_exp_f32 v10, v10
    v_cvt_pk_bf16_f32 v200, v8, v9
    v_mfma_f32_16x16x32_bf16 v[136:139], a[76:79], a[44:47], v[136:139]
    v_exp_f32 v11, v11
    v_add_u32 v240, 33280, v243
    v_mfma_f32_16x16x32_bf16 v[140:143], a[64:67], a[48:51], v[236:239]
    v_exp_f32 v12, v12
    v_cvt_pk_bf16_f32 v201, v10, v11
    v_mfma_f32_16x16x32_bf16 v[140:143], a[68:71], a[52:55], v[140:143]
    v_exp_f32 v13, v13
    v_mfma_f32_16x16x32_bf16 v[140:143], a[72:75], a[56:59], v[140:143]
    s_waitcnt vmcnt(16)
    v_exp_f32 v14, v14
    v_mfma_f32_16x16x32_bf16 v[140:143], a[76:79], a[60:63], v[140:143]
    s_waitcnt lgkmcnt(0)
    s_barrier
    v_exp_f32 v15, v15
    v_mfma_f32_16x16x32_bf16 v[144:147], a[80:83], a[0:3], v[224:227]
    ds_read_b64_tr_b16 a[64:65], v241 offset:0
    v_exp_f32 v16, v16
    v_mfma_f32_16x16x32_bf16 v[144:147], a[84:87], a[4:7], v[144:147]
    v_exp_f32 v17, v17
    v_cvt_pk_bf16_f32 v204, v12, v13
    v_mfma_f32_16x16x32_bf16 v[144:147], a[88:91], a[8:11], v[144:147]
    ds_read_b64_tr_b16 a[66:67], v241 offset:4096
    v_exp_f32 v18, v18
    v_mfma_f32_16x16x32_bf16 v[144:147], a[92:95], a[12:15], v[144:147]
    v_exp_f32 v19, v19
    v_cvt_pk_bf16_f32 v205, v14, v15
    v_mfma_f32_16x16x32_bf16 v[148:151], a[80:83], a[16:19], v[228:231]
    ds_read_b64_tr_b16 a[68:69], v249 offset:0
    v_exp_f32 v20, v20
    v_mfma_f32_16x16x32_bf16 v[148:151], a[84:87], a[20:23], v[148:151]
    v_exp_f32 v21, v21
    v_cvt_pk_bf16_f32 v194, v16, v17
    v_mfma_f32_16x16x32_bf16 v[148:151], a[88:91], a[24:27], v[148:151]
    ds_read_b64_tr_b16 a[70:71], v249 offset:4096
    v_exp_f32 v22, v22
    v_mfma_f32_16x16x32_bf16 v[148:151], a[92:95], a[28:31], v[148:151]
    v_exp_f32 v23, v23
    v_cvt_pk_bf16_f32 v195, v18, v19
    v_mfma_f32_16x16x32_bf16 v[152:155], a[80:83], a[32:35], v[232:235]
    ds_read_b64_tr_b16 a[72:73], v241 offset:256
    v_exp_f32 v24, v24
    v_mfma_f32_16x16x32_bf16 v[152:155], a[84:87], a[36:39], v[152:155]
    v_exp_f32 v25, v25
    v_cvt_pk_bf16_f32 v198, v20, v21
    v_mfma_f32_16x16x32_bf16 v[152:155], a[88:91], a[40:43], v[152:155]
    ds_read_b64_tr_b16 a[74:75], v241 offset:4352
    v_exp_f32 v26, v26
    v_mfma_f32_16x16x32_bf16 v[152:155], a[92:95], a[44:47], v[152:155]
    v_exp_f32 v27, v27
    v_cvt_pk_bf16_f32 v199, v22, v23
    v_mfma_f32_16x16x32_bf16 v[156:159], a[80:83], a[48:51], v[236:239]
    ds_read_b64_tr_b16 a[76:77], v249 offset:256
    v_exp_f32 v28, v28
    v_mfma_f32_16x16x32_bf16 v[156:159], a[84:87], a[52:55], v[156:159]
    v_exp_f32 v29, v29
    v_cvt_pk_bf16_f32 v203, v26, v27
    v_mfma_f32_16x16x32_bf16 v[156:159], a[88:91], a[56:59], v[156:159]
    ds_read_b64_tr_b16 a[78:79], v249 offset:4352
    v_exp_f32 v30, v30
    v_mfma_f32_16x16x32_bf16 v[156:159], a[92:95], a[60:63], v[156:159]
    s_waitcnt lgkmcnt(4)
    v_exp_f32 v31, v31
    v_mfma_f32_16x16x32_bf16 v[0:3], a[64:67], v[192:195], 0
    ds_read_b64_tr_b16 a[80:81], v241 offset:512
    v_cvt_pk_bf16_f32 v202, v24, v25
    v_cvt_pk_bf16_f32 v207, v30, v31
    v_mfma_f32_16x16x32_bf16 v[4:7], a[64:67], v[196:199], 0
    ds_read_b64_tr_b16 a[82:83], v241 offset:4608
    v_cvt_pk_bf16_f32 v206, v28, v29
    v_mfma_f32_16x16x32_bf16 v[8:11], a[64:67], v[200:203], 0
    v_exp_f32 v128, v128
    v_mfma_f32_16x16x32_bf16 v[12:15], a[64:67], v[204:207], 0
    ds_read_b64_tr_b16 a[84:85], v249 offset:512
    s_add_u32 m0, s3, 99840
    v_mfma_f32_16x16x32_bf16 v[168:171], v[184:187], v[192:195], 0
    v_exp_f32 v129, v129
    v_mfma_f32_16x16x32_bf16 v[16:19], a[68:71], v[192:195], 0
    ds_read_b64_tr_b16 a[86:87], v249 offset:4608
    v_cvt_pk_bf16_f32 v208, v128, v129
    v_mfma_f32_16x16x32_bf16 v[20:23], a[68:71], v[196:199], 0
    v_exp_f32 v130, v130
    v_mfma_f32_16x16x32_bf16 v[24:27], a[68:71], v[200:203], 0
    s_waitcnt lgkmcnt(4)
    ds_read_b64_tr_b16 a[88:89], v241 offset:768
    v_mfma_f32_16x16x32_bf16 v[28:31], a[68:71], v[204:207], 0
    v_exp_f32 v131, v131
    v_mfma_f32_16x16x32_bf16 v[32:35], a[72:75], v[192:195], 0
    ds_read_b64_tr_b16 a[90:91], v241 offset:4864
    v_cvt_pk_bf16_f32 v209, v130, v131
    v_mfma_f32_16x16x32_bf16 v[36:39], a[72:75], v[196:199], 0
    v_exp_f32 v132, v132
    v_mfma_f32_16x16x32_bf16 v[40:43], a[72:75], v[200:203], 0
    ds_read_b64_tr_b16 a[92:93], v249 offset:768
    buffer_load_dwordx4 v245, s[44:47], s70 offen offset:0 lds
    s_addk_i32 m0, 16
    v_mfma_f32_16x16x32_bf16 v[44:47], a[72:75], v[204:207], 0
    v_exp_f32 v133, v133
    v_mfma_f32_16x16x32_bf16 v[172:175], v[184:187], v[196:199], 0
    ds_read_b64_tr_b16 a[94:95], v249 offset:4864
    v_cvt_pk_bf16_f32 v212, v132, v133
    v_mfma_f32_16x16x32_bf16 v[48:51], a[76:79], v[192:195], 0
    v_exp_f32 v134, v134
    v_mfma_f32_16x16x32_bf16 v[52:55], a[76:79], v[196:199], 0
    v_exp_f32 v135, v135
    v_mfma_f32_16x16x32_bf16 v[56:59], a[76:79], v[200:203], 0
    buffer_load_dwordx4 v245, s[44:47], s70 offen offset:1024 lds
    s_addk_i32 m0, 16
    s_nop 0
    buffer_load_dwordx4 v245, s[44:47], s70 offen offset:2048 lds
    s_addk_i32 m0, 16
    s_nop 0
    buffer_load_dwordx4 v245, s[44:47], s70 offen offset:3072 lds
    v_exp_f32 v136, v136
    v_mfma_f32_16x16x32_bf16 v[60:63], a[76:79], v[204:207], 0
    s_waitcnt lgkmcnt(4)
    s_waitcnt vmcnt(12)
    s_barrier
    v_mfma_f32_16x16x32_bf16 v[64:67], a[80:83], v[192:195], 0
    ds_read_b128 a[64:67], v240 offset:0
    v_cvt_pk_bf16_f32 v213, v134, v135
    v_mfma_f32_16x16x32_bf16 v[68:71], a[80:83], v[196:199], 0
    v_exp_f32 v137, v137
    v_mfma_f32_16x16x32_bf16 v[72:75], a[80:83], v[200:203], 0
    ds_read_b128 a[68:71], v240 offset:256
    s_add_u32 m0, s39, 99840
    v_mfma_f32_16x16x32_bf16 v[76:79], a[80:83], v[204:207], 0
    v_exp_f32 v138, v138
    v_mfma_f32_16x16x32_bf16 v[176:179], v[184:187], v[200:203], 0
    ds_read_b128 a[72:75], v240 offset:512
    buffer_load_dwordx4 v245, s[48:51], s70 offen offset:0 lds
    v_mfma_f32_16x16x32_bf16 v[80:83], a[84:87], v[192:195], 0
    v_exp_f32 v139, v139
    v_mfma_f32_16x16x32_bf16 v[84:87], a[84:87], v[196:199], 0
    ds_read_b128 a[76:79], v240 offset:768
    v_cvt_pk_bf16_f32 v216, v136, v137
    v_mfma_f32_16x16x32_bf16 v[88:91], a[84:87], v[200:203], 0
    v_exp_f32 v140, v140
    v_mfma_f32_16x16x32_bf16 v[92:95], a[84:87], v[204:207], 0
    s_waitcnt lgkmcnt(4)
    v_cvt_pk_bf16_f32 v217, v138, v139
    v_mfma_f32_16x16x32_bf16 v[96:99], a[88:91], v[192:195], 0
    v_exp_f32 v141, v141
    v_mfma_f32_16x16x32_bf16 v[100:103], a[88:91], v[196:199], 0
    buffer_load_dwordx4 v250, s[48:51], s70 offen offset:1024 lds
    v_cvt_pk_bf16_f32 v220, v140, v141
    v_mfma_f32_16x16x32_bf16 v[104:107], a[88:91], v[200:203], 0
    v_exp_f32 v142, v142
    v_mfma_f32_16x16x32_bf16 v[108:111], a[88:91], v[204:207], 0
    v_exp_f32 v143, v143
    v_mfma_f32_16x16x32_bf16 v[180:183], v[184:187], v[204:207], 0
    v_exp_f32 v144, v144
    v_mfma_f32_16x16x32_bf16 v[112:115], a[92:95], v[192:195], 0
    v_exp_f32 v145, v145
    v_mfma_f32_16x16x32_bf16 v[116:119], a[92:95], v[196:199], 0
    v_exp_f32 v146, v146
    v_mfma_f32_16x16x32_bf16 v[120:123], a[92:95], v[200:203], 0
    buffer_load_dwordx4 v245, s[48:51], s70 offen offset:2048 lds
    v_cvt_pk_bf16_f32 v221, v142, v143
    v_mfma_f32_16x16x32_bf16 v[124:127], a[92:95], v[204:207], 0
    s_waitcnt lgkmcnt(0)
    v_cvt_pk_bf16_f32 v210, v144, v145
    v_mfma_f32_16x16x32_bf16 v[128:131], a[64:67], a[0:3], v[224:227]
    v_exp_f32 v147, v147
    v_mfma_f32_16x16x32_bf16 v[128:131], a[68:71], a[4:7], v[128:131]
    ds_read_b128 a[80:83], v240 offset:4160
    v_cvt_pk_bf16_f32 v211, v146, v147
    v_mfma_f32_16x16x32_bf16 v[128:131], a[72:75], a[8:11], v[128:131]
    v_exp_f32 v148, v148
    v_mfma_f32_16x16x32_bf16 v[128:131], a[76:79], a[12:15], v[128:131]
    ds_read_b128 a[84:87], v240 offset:4416
    buffer_load_dwordx4 v250, s[48:51], s70 offen offset:3072 lds
    v_mfma_f32_16x16x32_bf16 v[132:135], a[64:67], a[16:19], v[228:231]
    v_exp_f32 v149, v149
    v_mfma_f32_16x16x32_bf16 v[132:135], a[68:71], a[20:23], v[132:135]
    ds_read_b128 a[88:91], v240 offset:4672
    s_addk_i32 s70, 16384
    v_cvt_pk_bf16_f32 v214, v148, v149
    v_mfma_f32_16x16x32_bf16 v[132:135], a[72:75], a[24:27], v[132:135]
    v_exp_f32 v150, v150
    v_mfma_f32_16x16x32_bf16 v[132:135], a[76:79], a[28:31], v[132:135]
    ds_read_b128 a[92:95], v240 offset:4928
    s_add_u32 m0, s3, 0
    v_mfma_f32_16x16x32_bf16 v[136:139], a[64:67], a[32:35], v[232:235]
    v_exp_f32 v151, v151
    v_mfma_f32_16x16x32_bf16 v[136:139], a[68:71], a[36:39], v[136:139]
    buffer_load_dwordx4 v245, s[44:47], s70 offen offset:0 lds
    s_addk_i32 m0, 16
    v_mfma_f32_16x16x32_bf16 v[136:139], a[72:75], a[40:43], v[136:139]
    v_exp_f32 v152, v152
    v_mfma_f32_16x16x32_bf16 v[136:139], a[76:79], a[44:47], v[136:139]
    v_exp_f32 v153, v153
    v_mfma_f32_16x16x32_bf16 v[140:143], a[64:67], a[48:51], v[236:239]
    v_exp_f32 v154, v154
    v_cvt_pk_bf16_f32 v218, v152, v153
    v_mfma_f32_16x16x32_bf16 v[140:143], a[68:71], a[52:55], v[140:143]
    v_exp_f32 v155, v155
    v_mfma_f32_16x16x32_bf16 v[140:143], a[72:75], a[56:59], v[140:143]
    v_exp_f32 v156, v156
    v_mfma_f32_16x16x32_bf16 v[140:143], a[76:79], a[60:63], v[140:143]
    s_waitcnt lgkmcnt(0)
    v_cvt_pk_bf16_f32 v215, v150, v151
    v_mfma_f32_16x16x32_bf16 v[144:147], a[80:83], a[0:3], v[224:227]
    ds_read_b64_tr_b16 a[64:65], v241 offset:8192
    buffer_load_dwordx4 v245, s[44:47], s70 offen offset:1024 lds
    v_mfma_f32_16x16x32_bf16 v[144:147], a[84:87], a[4:7], v[144:147]
    v_exp_f32 v157, v157
    v_mfma_f32_16x16x32_bf16 v[144:147], a[88:91], a[8:11], v[144:147]
    ds_read_b64_tr_b16 a[66:67], v241 offset:12288
    s_addk_i32 m0, 16
    v_mfma_f32_16x16x32_bf16 v[144:147], a[92:95], a[12:15], v[144:147]
    v_exp_f32 v158, v158
    v_mfma_f32_16x16x32_bf16 v[148:151], a[80:83], a[16:19], v[228:231]
    ds_read_b64_tr_b16 a[68:69], v249 offset:8192
    v_cvt_pk_bf16_f32 v219, v154, v155
    v_mfma_f32_16x16x32_bf16 v[148:151], a[84:87], a[20:23], v[148:151]
    v_exp_f32 v159, v159
    v_mfma_f32_16x16x32_bf16 v[148:151], a[88:91], a[24:27], v[148:151]
    ds_read_b64_tr_b16 a[70:71], v249 offset:12288
    v_cvt_pk_bf16_f32 v222, v156, v157
    v_cvt_pk_bf16_f32 v223, v158, v159
    v_mfma_f32_16x16x32_bf16 v[148:151], a[92:95], a[28:31], v[148:151]
    v_exp_f32 v128, v128
    v_mfma_f32_16x16x32_bf16 v[152:155], a[80:83], a[32:35], v[232:235]
    ds_read_b64_tr_b16 a[72:73], v241 offset:8448
    buffer_load_dwordx4 v245, s[44:47], s70 offen offset:2048 lds
    v_mfma_f32_16x16x32_bf16 v[152:155], a[84:87], a[36:39], v[152:155]
    v_exp_f32 v129, v129
    v_mfma_f32_16x16x32_bf16 v[152:155], a[88:91], a[40:43], v[152:155]
    ds_read_b64_tr_b16 a[74:75], v241 offset:12544
    s_addk_i32 m0, 16
    v_mfma_f32_16x16x32_bf16 v[152:155], a[92:95], a[44:47], v[152:155]
    v_exp_f32 v130, v130
    v_mfma_f32_16x16x32_bf16 v[156:159], a[80:83], a[48:51], v[236:239]
    ds_read_b64_tr_b16 a[76:77], v249 offset:8448
    v_cvt_pk_bf16_f32 v192, v128, v129
    v_mfma_f32_16x16x32_bf16 v[156:159], a[84:87], a[52:55], v[156:159]
    v_exp_f32 v131, v131
    v_mfma_f32_16x16x32_bf16 v[156:159], a[88:91], a[56:59], v[156:159]
    s_waitcnt lgkmcnt(3)
    ds_read_b64_tr_b16 a[78:79], v249 offset:12544
    v_mfma_f32_16x16x32_bf16 v[156:159], a[92:95], a[60:63], v[156:159]
    v_exp_f32 v132, v132
    v_mfma_f32_16x16x32_bf16 v[0:3], a[64:67], v[208:211], v[0:3]
    ds_read_b64_tr_b16 a[80:81], v241 offset:8704
    buffer_load_dwordx4 v245, s[44:47], s70 offen offset:3072 lds
    v_mfma_f32_16x16x32_bf16 v[4:7], a[64:67], v[212:215], v[4:7]
    ds_read_b64_tr_b16 a[82:83], v241 offset:12800
    v_cvt_pk_bf16_f32 v193, v130, v131
    v_mfma_f32_16x16x32_bf16 v[8:11], a[64:67], v[216:219], v[8:11]
    v_exp_f32 v133, v133
    v_mfma_f32_16x16x32_bf16 v[12:15], a[64:67], v[220:223], v[12:15]
    ds_read_b64_tr_b16 a[84:85], v249 offset:8704
    v_cvt_pk_bf16_f32 v196, v132, v133
    v_mfma_f32_16x16x32_bf16 v[168:171], v[184:187], v[208:211], v[168:171]
    v_exp_f32 v134, v134
    v_mfma_f32_16x16x32_bf16 v[16:19], a[68:71], v[208:211], v[16:19]
    ds_read_b64_tr_b16 a[86:87], v249 offset:12800
    buffer_load_dword v242, v189, s[52:55], 0 offen
    v_mfma_f32_16x16x32_bf16 v[20:23], a[68:71], v[212:215], v[20:23]
    v_exp_f32 v135, v135
    v_mfma_f32_16x16x32_bf16 v[24:27], a[68:71], v[216:219], v[24:27]
    s_waitcnt lgkmcnt(4)
    ds_read_b64_tr_b16 a[88:89], v241 offset:8960
    v_mfma_f32_16x16x32_bf16 v[28:31], a[68:71], v[220:223], v[28:31]
    v_exp_f32 v136, v136
    v_mfma_f32_16x16x32_bf16 v[32:35], a[72:75], v[208:211], v[32:35]
    ds_read_b64_tr_b16 a[90:91], v241 offset:13056
    v_cvt_pk_bf16_f32 v197, v134, v135
    v_mfma_f32_16x16x32_bf16 v[36:39], a[72:75], v[212:215], v[36:39]
    v_exp_f32 v137, v137
    v_mfma_f32_16x16x32_bf16 v[40:43], a[72:75], v[216:219], v[40:43]
    ds_read_b64_tr_b16 a[92:93], v249 offset:8960
    v_cvt_pk_bf16_f32 v200, v136, v137
    v_mfma_f32_16x16x32_bf16 v[44:47], a[72:75], v[220:223], v[44:47]
    v_exp_f32 v138, v138
    v_mfma_f32_16x16x32_bf16 v[172:175], v[184:187], v[212:215], v[172:175]
    ds_read_b64_tr_b16 a[94:95], v249 offset:13056
    s_mov_b64 s[56:57], s[16:17]
    v_mfma_f32_16x16x32_bf16 v[48:51], a[76:79], v[208:211], v[48:51]
    v_exp_f32 v139, v139
    v_mfma_f32_16x16x32_bf16 v[52:55], a[76:79], v[212:215], v[52:55]
    ds_read_b128 a[64:67], v240 offset:8320
    v_cvt_pk_bf16_f32 v201, v138, v139
    v_mfma_f32_16x16x32_bf16 v[56:59], a[76:79], v[216:219], v[56:59]
    v_exp_f32 v140, v140
    v_mfma_f32_16x16x32_bf16 v[60:63], a[76:79], v[220:223], v[60:63]
    s_waitcnt lgkmcnt(5)
    ds_read_b128 a[68:71], v240 offset:8576
    v_mfma_f32_16x16x32_bf16 v[64:67], a[80:83], v[208:211], v[64:67]
    ds_read_b128 a[72:75], v240 offset:8832
    s_mov_b32 s58, 1409024
    v_mfma_f32_16x16x32_bf16 v[68:71], a[80:83], v[212:215], v[68:71]
    v_exp_f32 v141, v141
    v_mfma_f32_16x16x32_bf16 v[72:75], a[80:83], v[216:219], v[72:75]
    ds_read_b128 a[76:79], v240 offset:9088
    v_cvt_pk_bf16_f32 v204, v140, v141
    v_mfma_f32_16x16x32_bf16 v[76:79], a[80:83], v[220:223], v[76:79]
    v_exp_f32 v142, v142
    v_mfma_f32_16x16x32_bf16 v[176:179], v[184:187], v[216:219], v[176:179]
    v_exp_f32 v143, v143
    v_mfma_f32_16x16x32_bf16 v[80:83], a[84:87], v[208:211], v[80:83]
    v_exp_f32 v144, v144
    v_mfma_f32_16x16x32_bf16 v[84:87], a[84:87], v[212:215], v[84:87]
    v_exp_f32 v145, v145
    v_mfma_f32_16x16x32_bf16 v[88:91], a[84:87], v[216:219], v[88:91]
    v_exp_f32 v146, v146
    v_cvt_pk_bf16_f32 v194, v144, v145
    v_mfma_f32_16x16x32_bf16 v[92:95], a[84:87], v[220:223], v[92:95]
    s_waitcnt lgkmcnt(4)
    v_cvt_pk_bf16_f32 v205, v142, v143
    v_mfma_f32_16x16x32_bf16 v[96:99], a[88:91], v[208:211], v[96:99]
    v_exp_f32 v147, v147
    v_mfma_f32_16x16x32_bf16 v[100:103], a[88:91], v[212:215], v[100:103]
    v_exp_f32 v148, v148
    v_mfma_f32_16x16x32_bf16 v[104:107], a[88:91], v[216:219], v[104:107]
    v_exp_f32 v149, v149
    v_mfma_f32_16x16x32_bf16 v[108:111], a[88:91], v[220:223], v[108:111]
    v_exp_f32 v150, v150
    v_mfma_f32_16x16x32_bf16 v[180:183], v[184:187], v[220:223], v[180:183]
    v_exp_f32 v151, v151
    v_mfma_f32_16x16x32_bf16 v[112:115], a[92:95], v[208:211], v[112:115]
    v_exp_f32 v152, v152
    v_mfma_f32_16x16x32_bf16 v[116:119], a[92:95], v[212:215], v[116:119]
    v_exp_f32 v153, v153
    v_mfma_f32_16x16x32_bf16 v[120:123], a[92:95], v[216:219], v[120:123]
    v_exp_f32 v154, v154
    v_mfma_f32_16x16x32_bf16 v[124:127], a[92:95], v[220:223], v[124:127]
    s_waitcnt lgkmcnt(0)
    v_cvt_pk_bf16_f32 v195, v146, v147
    v_mfma_f32_16x16x32_bf16 v[128:131], a[64:67], a[0:3], v[224:227]
    v_exp_f32 v155, v155
    v_mfma_f32_16x16x32_bf16 v[128:131], a[68:71], a[4:7], v[128:131]
    ds_read_b128 a[80:83], v240 offset:12480
    v_cvt_pk_bf16_f32 v198, v148, v149
    v_mfma_f32_16x16x32_bf16 v[128:131], a[72:75], a[8:11], v[128:131]
    v_exp_f32 v156, v156
    v_mfma_f32_16x16x32_bf16 v[128:131], a[76:79], a[12:15], v[128:131]
    ds_read_b128 a[84:87], v240 offset:12736
    v_cvt_pk_bf16_f32 v199, v150, v151
    v_mfma_f32_16x16x32_bf16 v[132:135], a[64:67], a[16:19], v[228:231]
    v_exp_f32 v157, v157
    v_mfma_f32_16x16x32_bf16 v[132:135], a[68:71], a[20:23], v[132:135]
    ds_read_b128 a[88:91], v240 offset:12992
    v_cvt_pk_bf16_f32 v202, v152, v153
    v_mfma_f32_16x16x32_bf16 v[132:135], a[72:75], a[24:27], v[132:135]
    v_exp_f32 v158, v158
    v_mfma_f32_16x16x32_bf16 v[132:135], a[76:79], a[28:31], v[132:135]
    ds_read_b128 a[92:95], v240 offset:13248
    v_cvt_pk_bf16_f32 v203, v154, v155
    v_mfma_f32_16x16x32_bf16 v[136:139], a[64:67], a[32:35], v[232:235]
    v_exp_f32 v159, v159
    v_mfma_f32_16x16x32_bf16 v[136:139], a[68:71], a[36:39], v[136:139]
    v_exp_f32 v128, v128
    v_mfma_f32_16x16x32_bf16 v[136:139], a[72:75], a[40:43], v[136:139]
L_pad2:
    s_cbranch_execz L_warmed1
    v_exp_f32 v129, v129
    v_mfma_f32_16x16x32_bf16 v[136:139], a[76:79], a[44:47], v[136:139]
    v_cvt_pk_bf16_f32 v206, v156, v157
    v_cvt_pk_bf16_f32 v207, v158, v159
    v_mfma_f32_16x16x32_bf16 v[140:143], a[64:67], a[48:51], v[236:239]
    v_exp_f32 v130, v130
    v_mfma_f32_16x16x32_bf16 v[140:143], a[68:71], a[52:55], v[140:143]
    v_cvt_pk_bf16_f32 v208, v128, v129
    v_add_u32 v241, 33280, v244
    v_xor_b32 v249, 32, v241
    v_mfma_f32_16x16x32_bf16 v[140:143], a[72:75], a[56:59], v[140:143]
    v_exp_f32 v131, v131
    v_mfma_f32_16x16x32_bf16 v[140:143], a[76:79], a[60:63], v[140:143]
    s_waitcnt lgkmcnt(0)
    v_cvt_pk_bf16_f32 v209, v130, v131
    v_mfma_f32_16x16x32_bf16 v[144:147], a[80:83], a[0:3], v[224:227]
    ds_read_b64_tr_b16 a[64:65], v241 offset:0
    v_add_u32 v240, 66560, v243
    v_mfma_f32_16x16x32_bf16 v[144:147], a[84:87], a[4:7], v[144:147]
    v_exp_f32 v132, v132
    v_mfma_f32_16x16x32_bf16 v[144:147], a[88:91], a[8:11], v[144:147]
    ds_read_b64_tr_b16 a[66:67], v241 offset:4096
    buffer_load_dword v242, v188, s[56:59], 0 offen offset:0
    v_mfma_f32_16x16x32_bf16 v[144:147], a[92:95], a[12:15], v[144:147]
    v_exp_f32 v133, v133
    v_mfma_f32_16x16x32_bf16 v[148:151], a[80:83], a[16:19], v[228:231]
    ds_read_b64_tr_b16 a[68:69], v249 offset:0
    v_cvt_pk_bf16_f32 v212, v132, v133
    v_mfma_f32_16x16x32_bf16 v[148:151], a[84:87], a[20:23], v[148:151]
    v_exp_f32 v134, v134
    v_mfma_f32_16x16x32_bf16 v[148:151], a[88:91], a[24:27], v[148:151]
    ds_read_b64_tr_b16 a[70:71], v249 offset:4096
    s_mov_b64 s[56:57], s[12:13]
    v_mfma_f32_16x16x32_bf16 v[148:151], a[92:95], a[28:31], v[148:151]
    v_exp_f32 v135, v135
    v_mfma_f32_16x16x32_bf16 v[152:155], a[80:83], a[32:35], v[232:235]
    ds_read_b64_tr_b16 a[72:73], v241 offset:256
    v_cvt_pk_bf16_f32 v213, v134, v135
    v_mfma_f32_16x16x32_bf16 v[152:155], a[84:87], a[36:39], v[152:155]
    v_exp_f32 v136, v136
    v_mfma_f32_16x16x32_bf16 v[152:155], a[88:91], a[40:43], v[152:155]
    ds_read_b64_tr_b16 a[74:75], v241 offset:4352
    s_mov_b32 s58, 4194304
    v_mfma_f32_16x16x32_bf16 v[152:155], a[92:95], a[44:47], v[152:155]
    v_exp_f32 v137, v137
    v_mfma_f32_16x16x32_bf16 v[156:159], a[80:83], a[48:51], v[236:239]
    ds_read_b64_tr_b16 a[76:77], v249 offset:256
    v_cvt_pk_bf16_f32 v216, v136, v137
    v_mfma_f32_16x16x32_bf16 v[156:159], a[84:87], a[52:55], v[156:159]
    v_exp_f32 v138, v138
    v_mfma_f32_16x16x32_bf16 v[156:159], a[88:91], a[56:59], v[156:159]
    s_waitcnt lgkmcnt(3)
    ds_read_b64_tr_b16 a[78:79], v249 offset:4352
    v_mfma_f32_16x16x32_bf16 v[156:159], a[92:95], a[60:63], v[156:159]
    v_exp_f32 v139, v139
    v_mfma_f32_16x16x32_bf16 v[0:3], a[64:67], v[192:195], v[0:3]
    ds_read_b64_tr_b16 a[80:81], v241 offset:512
    v_cvt_pk_bf16_f32 v217, v138, v139
    v_mfma_f32_16x16x32_bf16 v[4:7], a[64:67], v[196:199], v[4:7]
    ds_read_b64_tr_b16 a[82:83], v241 offset:4608
    v_mfma_f32_16x16x32_bf16 v[8:11], a[64:67], v[200:203], v[8:11]
    v_exp_f32 v140, v140
    v_mfma_f32_16x16x32_bf16 v[12:15], a[64:67], v[204:207], v[12:15]
    ds_read_b64_tr_b16 a[84:85], v249 offset:512
    v_mfma_f32_16x16x32_bf16 v[168:171], v[184:187], v[192:195], v[168:171]
    v_exp_f32 v141, v141
    v_mfma_f32_16x16x32_bf16 v[16:19], a[68:71], v[192:195], v[16:19]
    ds_read_b64_tr_b16 a[86:87], v249 offset:4608
    v_cvt_pk_bf16_f32 v220, v140, v141
    v_mfma_f32_16x16x32_bf16 v[20:23], a[68:71], v[196:199], v[20:23]
    v_exp_f32 v142, v142
    v_mfma_f32_16x16x32_bf16 v[24:27], a[68:71], v[200:203], v[24:27]
    s_waitcnt lgkmcnt(4)
    ds_read_b64_tr_b16 a[88:89], v241 offset:768
    v_mfma_f32_16x16x32_bf16 v[28:31], a[68:71], v[204:207], v[28:31]
    v_exp_f32 v143, v143
    v_mfma_f32_16x16x32_bf16 v[32:35], a[72:75], v[192:195], v[32:35]
    ds_read_b64_tr_b16 a[90:91], v241 offset:4864
    v_cvt_pk_bf16_f32 v221, v142, v143
    v_mfma_f32_16x16x32_bf16 v[36:39], a[72:75], v[196:199], v[36:39]
    v_exp_f32 v144, v144
    v_mfma_f32_16x16x32_bf16 v[40:43], a[72:75], v[200:203], v[40:43]
    ds_read_b64_tr_b16 a[92:93], v249 offset:768
    v_mfma_f32_16x16x32_bf16 v[44:47], a[72:75], v[204:207], v[44:47]
    v_exp_f32 v145, v145
    v_mfma_f32_16x16x32_bf16 v[172:175], v[184:187], v[196:199], v[172:175]
    ds_read_b64_tr_b16 a[94:95], v249 offset:4864
    v_cvt_pk_bf16_f32 v210, v144, v145
    v_mfma_f32_16x16x32_bf16 v[48:51], a[76:79], v[192:195], v[48:51]
    v_exp_f32 v146, v146
    v_mfma_f32_16x16x32_bf16 v[52:55], a[76:79], v[196:199], v[52:55]
    v_mfma_f32_16x16x32_bf16 v[56:59], a[76:79], v[200:203], v[56:59]
    v_exp_f32 v147, v147
    v_mfma_f32_16x16x32_bf16 v[60:63], a[76:79], v[204:207], v[60:63]
    s_waitcnt lgkmcnt(4)
    s_waitcnt vmcnt(14)
    s_barrier
    v_mfma_f32_16x16x32_bf16 v[64:67], a[80:83], v[192:195], v[64:67]
    ds_read_b128 a[64:67], v240 offset:0
    v_cvt_pk_bf16_f32 v211, v146, v147
    v_mfma_f32_16x16x32_bf16 v[68:71], a[80:83], v[196:199], v[68:71]
    v_exp_f32 v148, v148
    v_mfma_f32_16x16x32_bf16 v[72:75], a[80:83], v[200:203], v[72:75]
    ds_read_b128 a[68:71], v240 offset:256
    s_add_u32 m0, s39, 0
    v_mfma_f32_16x16x32_bf16 v[76:79], a[80:83], v[204:207], v[76:79]
    v_exp_f32 v149, v149
    v_mfma_f32_16x16x32_bf16 v[176:179], v[184:187], v[200:203], v[176:179]
    ds_read_b128 a[72:75], v240 offset:512
    v_cvt_pk_bf16_f32 v214, v148, v149
    v_mfma_f32_16x16x32_bf16 v[80:83], a[84:87], v[192:195], v[80:83]
    v_exp_f32 v150, v150
    v_mfma_f32_16x16x32_bf16 v[84:87], a[84:87], v[196:199], v[84:87]
    ds_read_b128 a[76:79], v240 offset:768
    buffer_load_dwordx4 v245, s[48:51], s70 offen offset:0 lds
    v_mfma_f32_16x16x32_bf16 v[88:91], a[84:87], v[200:203], v[88:91]
    v_exp_f32 v151, v151
    v_mfma_f32_16x16x32_bf16 v[92:95], a[84:87], v[204:207], v[92:95]
    s_waitcnt lgkmcnt(4)
    v_cvt_pk_bf16_f32 v215, v150, v151
    v_mfma_f32_16x16x32_bf16 v[96:99], a[88:91], v[192:195], v[96:99]
    v_exp_f32 v152, v152
    v_mfma_f32_16x16x32_bf16 v[100:103], a[88:91], v[196:199], v[100:103]
    buffer_load_dwordx4 v250, s[48:51], s70 offen offset:1024 lds
    v_mfma_f32_16x16x32_bf16 v[104:107], a[88:91], v[200:203], v[104:107]
    v_exp_f32 v153, v153
    v_mfma_f32_16x16x32_bf16 v[108:111], a[88:91], v[204:207], v[108:111]
    v_cvt_pk_bf16_f32 v218, v152, v153
    v_mfma_f32_16x16x32_bf16 v[180:183], v[184:187], v[204:207], v[180:183]
    v_exp_f32 v154, v154
    v_mfma_f32_16x16x32_bf16 v[112:115], a[92:95], v[192:195], v[112:115]
    buffer_load_dwordx4 v245, s[48:51], s70 offen offset:2048 lds
    v_mfma_f32_16x16x32_bf16 v[116:119], a[92:95], v[196:199], v[116:119]
    v_exp_f32 v155, v155
    v_mfma_f32_16x16x32_bf16 v[120:123], a[92:95], v[200:203], v[120:123]
    v_cvt_pk_bf16_f32 v219, v154, v155
    v_mfma_f32_16x16x32_bf16 v[124:127], a[92:95], v[204:207], v[124:127]
    s_waitcnt lgkmcnt(0)
    v_mfma_f32_16x16x32_bf16 v[128:131], a[64:67], a[0:3], v[224:227]
    v_exp_f32 v156, v156
    v_mfma_f32_16x16x32_bf16 v[128:131], a[68:71], a[4:7], v[128:131]
    ds_read_b128 a[80:83], v240 offset:4160
    buffer_load_dwordx4 v250, s[48:51], s70 offen offset:3072 lds
    v_mfma_f32_16x16x32_bf16 v[128:131], a[72:75], a[8:11], v[128:131]
    v_exp_f32 v157, v157
    v_mfma_f32_16x16x32_bf16 v[128:131], a[76:79], a[12:15], v[128:131]
    ds_read_b128 a[84:87], v240 offset:4416
    v_cvt_pk_bf16_f32 v222, v156, v157
    v_mfma_f32_16x16x32_bf16 v[132:135], a[64:67], a[16:19], v[228:231]
    v_exp_f32 v158, v158
    v_mfma_f32_16x16x32_bf16 v[132:135], a[68:71], a[20:23], v[132:135]
    ds_read_b128 a[88:91], v240 offset:4672
    s_addk_i32 s70, 16384
    v_mfma_f32_16x16x32_bf16 v[132:135], a[72:75], a[24:27], v[132:135]
    v_exp_f32 v159, v159
    v_mfma_f32_16x16x32_bf16 v[132:135], a[76:79], a[28:31], v[132:135]
    ds_read_b128 a[92:95], v240 offset:4928
    v_cvt_pk_bf16_f32 v223, v158, v159
    v_mfma_f32_16x16x32_bf16 v[136:139], a[64:67], a[32:35], v[232:235]
    v_exp_f32 v128, v128
    v_mfma_f32_16x16x32_bf16 v[136:139], a[68:71], a[36:39], v[136:139]
    s_add_u32 m0, s3, 33280
    v_mfma_f32_16x16x32_bf16 v[136:139], a[72:75], a[40:43], v[136:139]
    v_exp_f32 v129, v129
    v_mfma_f32_16x16x32_bf16 v[136:139], a[76:79], a[44:47], v[136:139]
    buffer_load_dwordx4 v245, s[44:47], s70 offen offset:0 lds
    v_cvt_pk_bf16_f32 v192, v128, v129
    v_mfma_f32_16x16x32_bf16 v[140:143], a[64:67], a[48:51], v[236:239]
    v_exp_f32 v130, v130
    v_mfma_f32_16x16x32_bf16 v[140:143], a[68:71], a[52:55], v[140:143]
    s_addk_i32 m0, 16
    v_mfma_f32_16x16x32_bf16 v[140:143], a[72:75], a[56:59], v[140:143]
    v_exp_f32 v131, v131
    v_mfma_f32_16x16x32_bf16 v[140:143], a[76:79], a[60:63], v[140:143]
    s_waitcnt lgkmcnt(0)
    v_cvt_pk_bf16_f32 v193, v130, v131
    v_mfma_f32_16x16x32_bf16 v[144:147], a[80:83], a[0:3], v[224:227]
    ds_read_b64_tr_b16 a[64:65], v241 offset:8192
    buffer_load_dwordx4 v245, s[44:47], s70 offen offset:1024 lds
    v_mfma_f32_16x16x32_bf16 v[144:147], a[84:87], a[4:7], v[144:147]
    v_exp_f32 v132, v132
    v_mfma_f32_16x16x32_bf16 v[144:147], a[88:91], a[8:11], v[144:147]
    ds_read_b64_tr_b16 a[66:67], v241 offset:12288
    s_addk_i32 m0, 16
    v_mfma_f32_16x16x32_bf16 v[144:147], a[92:95], a[12:15], v[144:147]
    v_exp_f32 v133, v133
    v_mfma_f32_16x16x32_bf16 v[148:151], a[80:83], a[16:19], v[228:231]
    ds_read_b64_tr_b16 a[68:69], v249 offset:8192
    v_cvt_pk_bf16_f32 v196, v132, v133
    v_mfma_f32_16x16x32_bf16 v[148:151], a[84:87], a[20:23], v[148:151]
    v_exp_f32 v134, v134
    v_mfma_f32_16x16x32_bf16 v[148:151], a[88:91], a[24:27], v[148:151]
    ds_read_b64_tr_b16 a[70:71], v249 offset:12288
    buffer_load_dwordx4 v245, s[44:47], s70 offen offset:2048 lds
    v_mfma_f32_16x16x32_bf16 v[148:151], a[92:95], a[28:31], v[148:151]
    v_exp_f32 v135, v135
    v_mfma_f32_16x16x32_bf16 v[152:155], a[80:83], a[32:35], v[232:235]
    ds_read_b64_tr_b16 a[72:73], v241 offset:8448
    v_cvt_pk_bf16_f32 v197, v134, v135
    v_mfma_f32_16x16x32_bf16 v[152:155], a[84:87], a[36:39], v[152:155]
    v_exp_f32 v136, v136
    v_mfma_f32_16x16x32_bf16 v[152:155], a[88:91], a[40:43], v[152:155]
    ds_read_b64_tr_b16 a[74:75], v241 offset:12544
    s_addk_i32 m0, 16
    v_mfma_f32_16x16x32_bf16 v[152:155], a[92:95], a[44:47], v[152:155]
    v_exp_f32 v137, v137
    v_mfma_f32_16x16x32_bf16 v[156:159], a[80:83], a[48:51], v[236:239]
    ds_read_b64_tr_b16 a[76:77], v249 offset:8448
    v_cvt_pk_bf16_f32 v200, v136, v137
    v_mfma_f32_16x16x32_bf16 v[156:159], a[84:87], a[52:55], v[156:159]
    v_exp_f32 v138, v138
    v_mfma_f32_16x16x32_bf16 v[156:159], a[88:91], a[56:59], v[156:159]
    s_waitcnt lgkmcnt(3)
    ds_read_b64_tr_b16 a[78:79], v249 offset:12544
    v_mfma_f32_16x16x32_bf16 v[156:159], a[92:95], a[60:63], v[156:159]
    v_exp_f32 v139, v139
    v_mfma_f32_16x16x32_bf16 v[0:3], a[64:67], v[208:211], v[0:3]
    ds_read_b64_tr_b16 a[80:81], v241 offset:8704
    v_cvt_pk_bf16_f32 v201, v138, v139
    v_mfma_f32_16x16x32_bf16 v[4:7], a[64:67], v[212:215], v[4:7]
    ds_read_b64_tr_b16 a[82:83], v241 offset:12800
    buffer_load_dwordx4 v245, s[44:47], s70 offen offset:3072 lds
    v_mfma_f32_16x16x32_bf16 v[8:11], a[64:67], v[216:219], v[8:11]
    v_exp_f32 v140, v140
    v_mfma_f32_16x16x32_bf16 v[12:15], a[64:67], v[220:223], v[12:15]
    ds_read_b64_tr_b16 a[84:85], v249 offset:8704
    v_mfma_f32_16x16x32_bf16 v[168:171], v[184:187], v[208:211], v[168:171]
    v_exp_f32 v141, v141
    v_mfma_f32_16x16x32_bf16 v[16:19], a[68:71], v[208:211], v[16:19]
    ds_read_b64_tr_b16 a[86:87], v249 offset:12800
    v_cvt_pk_bf16_f32 v204, v140, v141
    v_mfma_f32_16x16x32_bf16 v[20:23], a[68:71], v[212:215], v[20:23]
    v_exp_f32 v142, v142
    v_mfma_f32_16x16x32_bf16 v[24:27], a[68:71], v[216:219], v[24:27]
    s_waitcnt lgkmcnt(4)
    ds_read_b64_tr_b16 a[88:89], v241 offset:8960
    v_mfma_f32_16x16x32_bf16 v[28:31], a[68:71], v[220:223], v[28:31]
    v_exp_f32 v143, v143
    v_mfma_f32_16x16x32_bf16 v[32:35], a[72:75], v[208:211], v[32:35]
    ds_read_b64_tr_b16 a[90:91], v241 offset:13056
    v_cvt_pk_bf16_f32 v205, v142, v143
    v_mfma_f32_16x16x32_bf16 v[36:39], a[72:75], v[212:215], v[36:39]
    v_exp_f32 v144, v144
    v_mfma_f32_16x16x32_bf16 v[40:43], a[72:75], v[216:219], v[40:43]
    ds_read_b64_tr_b16 a[92:93], v249 offset:8960
    buffer_load_dword v242, v190, s[56:59], 0 offen offset:0
    v_mfma_f32_16x16x32_bf16 v[44:47], a[72:75], v[220:223], v[44:47]
    v_exp_f32 v145, v145
    v_mfma_f32_16x16x32_bf16 v[172:175], v[184:187], v[212:215], v[172:175]
    ds_read_b64_tr_b16 a[94:95], v249 offset:13056
    v_cvt_pk_bf16_f32 v194, v144, v145
    v_mfma_f32_16x16x32_bf16 v[48:51], a[76:79], v[208:211], v[48:51]
    v_exp_f32 v146, v146
    v_mfma_f32_16x16x32_bf16 v[52:55], a[76:79], v[212:215], v[52:55]
    ds_read_b128 a[64:67], v240 offset:8320
    buffer_load_dword v242, v190, s[56:59], 0 offen offset:2048
    v_mfma_f32_16x16x32_bf16 v[56:59], a[76:79], v[216:219], v[56:59]
    v_exp_f32 v147, v147
    v_mfma_f32_16x16x32_bf16 v[60:63], a[76:79], v[220:223], v[60:63]
    s_waitcnt lgkmcnt(5)
    ds_read_b128 a[68:71], v240 offset:8576
    v_mfma_f32_16x16x32_bf16 v[64:67], a[80:83], v[208:211], v[64:67]
    ds_read_b128 a[72:75], v240 offset:8832
    v_cvt_pk_bf16_f32 v195, v146, v147
    v_mfma_f32_16x16x32_bf16 v[68:71], a[80:83], v[212:215], v[68:71]
    v_exp_f32 v148, v148
    v_mfma_f32_16x16x32_bf16 v[72:75], a[80:83], v[216:219], v[72:75]
    ds_read_b128 a[76:79], v240 offset:9088
    v_mfma_f32_16x16x32_bf16 v[76:79], a[80:83], v[220:223], v[76:79]
    v_exp_f32 v149, v149
    v_mfma_f32_16x16x32_bf16 v[176:179], v[184:187], v[216:219], v[176:179]
    v_cvt_pk_bf16_f32 v198, v148, v149
    v_add_u32 v241, 66560, v244
    v_mfma_f32_16x16x32_bf16 v[80:83], a[84:87], v[208:211], v[80:83]
    v_exp_f32 v150, v150
    v_mfma_f32_16x16x32_bf16 v[84:87], a[84:87], v[212:215], v[84:87]
    v_xor_b32 v249, 32, v241
    v_mfma_f32_16x16x32_bf16 v[88:91], a[84:87], v[216:219], v[88:91]
    v_exp_f32 v151, v151
    v_mfma_f32_16x16x32_bf16 v[92:95], a[84:87], v[220:223], v[92:95]
    s_waitcnt lgkmcnt(4)
    v_cvt_pk_bf16_f32 v199, v150, v151
    v_mfma_f32_16x16x32_bf16 v[96:99], a[88:91], v[208:211], v[96:99]
    v_exp_f32 v152, v152
    v_mfma_f32_16x16x32_bf16 v[100:103], a[88:91], v[212:215], v[100:103]
    v_mfma_f32_16x16x32_bf16 v[104:107], a[88:91], v[216:219], v[104:107]
    v_exp_f32 v153, v153
    v_mfma_f32_16x16x32_bf16 v[108:111], a[88:91], v[220:223], v[108:111]
    v_cvt_pk_bf16_f32 v202, v152, v153
    v_mfma_f32_16x16x32_bf16 v[180:183], v[184:187], v[220:223], v[180:183]
    v_exp_f32 v154, v154
    v_mfma_f32_16x16x32_bf16 v[112:115], a[92:95], v[208:211], v[112:115]
    v_mfma_f32_16x16x32_bf16 v[116:119], a[92:95], v[212:215], v[116:119]
    v_exp_f32 v155, v155
    v_mfma_f32_16x16x32_bf16 v[120:123], a[92:95], v[216:219], v[120:123]
    v_cvt_pk_bf16_f32 v203, v154, v155
    v_mfma_f32_16x16x32_bf16 v[124:127], a[92:95], v[220:223], v[124:127]
    s_waitcnt lgkmcnt(0)
    v_mfma_f32_16x16x32_bf16 v[128:131], a[64:67], a[0:3], v[224:227]
    v_exp_f32 v156, v156
    v_mfma_f32_16x16x32_bf16 v[128:131], a[68:71], a[4:7], v[128:131]
    ds_read_b128 a[80:83], v240 offset:12480
    v_mfma_f32_16x16x32_bf16 v[128:131], a[72:75], a[8:11], v[128:131]
    v_exp_f32 v157, v157
    v_mfma_f32_16x16x32_bf16 v[128:131], a[76:79], a[12:15], v[128:131]
    ds_read_b128 a[84:87], v240 offset:12736
    v_cvt_pk_bf16_f32 v206, v156, v157
    v_mfma_f32_16x16x32_bf16 v[132:135], a[64:67], a[16:19], v[228:231]
    v_exp_f32 v158, v158
    v_mfma_f32_16x16x32_bf16 v[132:135], a[68:71], a[20:23], v[132:135]
    ds_read_b128 a[88:91], v240 offset:12992
    v_mfma_f32_16x16x32_bf16 v[132:135], a[72:75], a[24:27], v[132:135]
    v_exp_f32 v159, v159
    v_mfma_f32_16x16x32_bf16 v[132:135], a[76:79], a[28:31], v[132:135]
    ds_read_b128 a[92:95], v240 offset:13248
    v_cvt_pk_bf16_f32 v207, v158, v159
    v_mfma_f32_16x16x32_bf16 v[136:139], a[64:67], a[32:35], v[232:235]
    v_exp_f32 v128, v128
    v_mfma_f32_16x16x32_bf16 v[136:139], a[68:71], a[36:39], v[136:139]
    v_mfma_f32_16x16x32_bf16 v[136:139], a[72:75], a[40:43], v[136:139]
    v_exp_f32 v129, v129
    v_mfma_f32_16x16x32_bf16 v[136:139], a[76:79], a[44:47], v[136:139]
    v_cvt_pk_bf16_f32 v208, v128, v129
    v_add_u32 v240, 99840, v243
    v_mfma_f32_16x16x32_bf16 v[140:143], a[64:67], a[48:51], v[236:239]
    v_exp_f32 v130, v130
    v_mfma_f32_16x16x32_bf16 v[140:143], a[68:71], a[52:55], v[140:143]
    v_mfma_f32_16x16x32_bf16 v[140:143], a[72:75], a[56:59], v[140:143]
    v_exp_f32 v131, v131
    v_mfma_f32_16x16x32_bf16 v[140:143], a[76:79], a[60:63], v[140:143]
    s_waitcnt lgkmcnt(0)
    v_cvt_pk_bf16_f32 v209, v130, v131
    v_mfma_f32_16x16x32_bf16 v[144:147], a[80:83], a[0:3], v[224:227]
    ds_read_b64_tr_b16 a[64:65], v241 offset:0
    v_mfma_f32_16x16x32_bf16 v[144:147], a[84:87], a[4:7], v[144:147]
    v_exp_f32 v132, v132
    v_mfma_f32_16x16x32_bf16 v[144:147], a[88:91], a[8:11], v[144:147]
    ds_read_b64_tr_b16 a[66:67], v241 offset:4096
    v_mfma_f32_16x16x32_bf16 v[144:147], a[92:95], a[12:15], v[144:147]
    v_exp_f32 v133, v133
    v_mfma_f32_16x16x32_bf16 v[148:151], a[80:83], a[16:19], v[228:231]
    ds_read_b64_tr_b16 a[68:69], v249 offset:0
    v_cvt_pk_bf16_f32 v212, v132, v133
    v_mfma_f32_16x16x32_bf16 v[148:151], a[84:87], a[20:23], v[148:151]
    v_exp_f32 v134, v134
    v_mfma_f32_16x16x32_bf16 v[148:151], a[88:91], a[24:27], v[148:151]
    ds_read_b64_tr_b16 a[70:71], v249 offset:4096
    v_mfma_f32_16x16x32_bf16 v[148:151], a[92:95], a[28:31], v[148:151]
    v_exp_f32 v135, v135
    v_mfma_f32_16x16x32_bf16 v[152:155], a[80:83], a[32:35], v[232:235]
    ds_read_b64_tr_b16 a[72:73], v241 offset:256
    v_cvt_pk_bf16_f32 v213, v134, v135
    v_mfma_f32_16x16x32_bf16 v[152:155], a[84:87], a[36:39], v[152:155]
    v_exp_f32 v136, v136
    v_mfma_f32_16x16x32_bf16 v[152:155], a[88:91], a[40:43], v[152:155]
    ds_read_b64_tr_b16 a[74:75], v241 offset:4352
    v_mfma_f32_16x16x32_bf16 v[152:155], a[92:95], a[44:47], v[152:155]
    v_exp_f32 v137, v137
    v_mfma_f32_16x16x32_bf16 v[156:159], a[80:83], a[48:51], v[236:239]
    ds_read_b64_tr_b16 a[76:77], v249 offset:256
    v_cvt_pk_bf16_f32 v216, v136, v137
    v_mfma_f32_16x16x32_bf16 v[156:159], a[84:87], a[52:55], v[156:159]
    v_exp_f32 v138, v138
    v_mfma_f32_16x16x32_bf16 v[156:159], a[88:91], a[56:59], v[156:159]
    s_waitcnt lgkmcnt(3)
    ds_read_b64_tr_b16 a[78:79], v249 offset:4352
    v_mfma_f32_16x16x32_bf16 v[156:159], a[92:95], a[60:63], v[156:159]
    v_exp_f32 v139, v139
    v_mfma_f32_16x16x32_bf16 v[0:3], a[64:67], v[192:195], v[0:3]
    ds_read_b64_tr_b16 a[80:81], v241 offset:512
    v_cvt_pk_bf16_f32 v217, v138, v139
    v_mfma_f32_16x16x32_bf16 v[4:7], a[64:67], v[196:199], v[4:7]
    ds_read_b64_tr_b16 a[82:83], v241 offset:4608
    v_mfma_f32_16x16x32_bf16 v[8:11], a[64:67], v[200:203], v[8:11]
    v_exp_f32 v140, v140
    v_mfma_f32_16x16x32_bf16 v[12:15], a[64:67], v[204:207], v[12:15]
    ds_read_b64_tr_b16 a[84:85], v249 offset:512
    v_mfma_f32_16x16x32_bf16 v[168:171], v[184:187], v[192:195], v[168:171]
    v_exp_f32 v141, v141
    v_mfma_f32_16x16x32_bf16 v[16:19], a[68:71], v[192:195], v[16:19]
    ds_read_b64_tr_b16 a[86:87], v249 offset:4608
    v_cvt_pk_bf16_f32 v220, v140, v141
    v_mfma_f32_16x16x32_bf16 v[20:23], a[68:71], v[196:199], v[20:23]
    v_exp_f32 v142, v142
    v_mfma_f32_16x16x32_bf16 v[24:27], a[68:71], v[200:203], v[24:27]
    s_waitcnt lgkmcnt(4)
    ds_read_b64_tr_b16 a[88:89], v241 offset:768
    v_mfma_f32_16x16x32_bf16 v[28:31], a[68:71], v[204:207], v[28:31]
    v_exp_f32 v143, v143
    v_mfma_f32_16x16x32_bf16 v[32:35], a[72:75], v[192:195], v[32:35]
    ds_read_b64_tr_b16 a[90:91], v241 offset:4864
    v_cvt_pk_bf16_f32 v221, v142, v143
    v_mfma_f32_16x16x32_bf16 v[36:39], a[72:75], v[196:199], v[36:39]
    v_exp_f32 v144, v144
    v_mfma_f32_16x16x32_bf16 v[40:43], a[72:75], v[200:203], v[40:43]
    ds_read_b64_tr_b16 a[92:93], v249 offset:768
    v_mfma_f32_16x16x32_bf16 v[44:47], a[72:75], v[204:207], v[44:47]
    v_exp_f32 v145, v145
    v_mfma_f32_16x16x32_bf16 v[172:175], v[184:187], v[196:199], v[172:175]
    ds_read_b64_tr_b16 a[94:95], v249 offset:4864
    v_cvt_pk_bf16_f32 v210, v144, v145
    v_mfma_f32_16x16x32_bf16 v[48:51], a[76:79], v[192:195], v[48:51]
    v_exp_f32 v146, v146
    v_mfma_f32_16x16x32_bf16 v[52:55], a[76:79], v[196:199], v[52:55]
    v_mfma_f32_16x16x32_bf16 v[56:59], a[76:79], v[200:203], v[56:59]
    v_exp_f32 v147, v147
    v_mfma_f32_16x16x32_bf16 v[60:63], a[76:79], v[204:207], v[60:63]
    s_waitcnt lgkmcnt(4)
    s_waitcnt vmcnt(16)
    s_barrier
    v_mfma_f32_16x16x32_bf16 v[64:67], a[80:83], v[192:195], v[64:67]
    ds_read_b128 a[64:67], v240 offset:0
    v_cvt_pk_bf16_f32 v211, v146, v147
    v_mfma_f32_16x16x32_bf16 v[68:71], a[80:83], v[196:199], v[68:71]
    v_exp_f32 v148, v148
    v_mfma_f32_16x16x32_bf16 v[72:75], a[80:83], v[200:203], v[72:75]
    ds_read_b128 a[68:71], v240 offset:256
    s_add_u32 m0, s39, 33280
    v_mfma_f32_16x16x32_bf16 v[76:79], a[80:83], v[204:207], v[76:79]
    v_exp_f32 v149, v149
    v_mfma_f32_16x16x32_bf16 v[176:179], v[184:187], v[200:203], v[176:179]
    ds_read_b128 a[72:75], v240 offset:512
    v_cvt_pk_bf16_f32 v214, v148, v149
    v_mfma_f32_16x16x32_bf16 v[80:83], a[84:87], v[192:195], v[80:83]
    v_exp_f32 v150, v150
    v_mfma_f32_16x16x32_bf16 v[84:87], a[84:87], v[196:199], v[84:87]
    ds_read_b128 a[76:79], v240 offset:768
    buffer_load_dwordx4 v245, s[48:51], s70 offen offset:0 lds
    v_mfma_f32_16x16x32_bf16 v[88:91], a[84:87], v[200:203], v[88:91]
    v_exp_f32 v151, v151
    v_mfma_f32_16x16x32_bf16 v[92:95], a[84:87], v[204:207], v[92:95]
    s_waitcnt lgkmcnt(4)
    v_cvt_pk_bf16_f32 v215, v150, v151
    v_mfma_f32_16x16x32_bf16 v[96:99], a[88:91], v[192:195], v[96:99]
    v_exp_f32 v152, v152
    v_mfma_f32_16x16x32_bf16 v[100:103], a[88:91], v[196:199], v[100:103]
    buffer_load_dwordx4 v250, s[48:51], s70 offen offset:1024 lds
    v_mfma_f32_16x16x32_bf16 v[104:107], a[88:91], v[200:203], v[104:107]
    v_exp_f32 v153, v153
    v_mfma_f32_16x16x32_bf16 v[108:111], a[88:91], v[204:207], v[108:111]
    v_cvt_pk_bf16_f32 v218, v152, v153
    v_mfma_f32_16x16x32_bf16 v[180:183], v[184:187], v[204:207], v[180:183]
    v_exp_f32 v154, v154
    v_mfma_f32_16x16x32_bf16 v[112:115], a[92:95], v[192:195], v[112:115]
    buffer_load_dwordx4 v245, s[48:51], s70 offen offset:2048 lds
    v_mfma_f32_16x16x32_bf16 v[116:119], a[92:95], v[196:199], v[116:119]
    v_exp_f32 v155, v155
    v_mfma_f32_16x16x32_bf16 v[120:123], a[92:95], v[200:203], v[120:123]
    v_cvt_pk_bf16_f32 v219, v154, v155
    v_mfma_f32_16x16x32_bf16 v[124:127], a[92:95], v[204:207], v[124:127]
    s_waitcnt lgkmcnt(0)
    v_mfma_f32_16x16x32_bf16 v[128:131], a[64:67], a[0:3], v[224:227]
    v_exp_f32 v156, v156
    v_mfma_f32_16x16x32_bf16 v[128:131], a[68:71], a[4:7], v[128:131]
    ds_read_b128 a[80:83], v240 offset:4160
    buffer_load_dwordx4 v250, s[48:51], s70 offen offset:3072 lds
    v_mfma_f32_16x16x32_bf16 v[128:131], a[72:75], a[8:11], v[128:131]
    v_exp_f32 v157, v157
    v_mfma_f32_16x16x32_bf16 v[128:131], a[76:79], a[12:15], v[128:131]
    ds_read_b128 a[84:87], v240 offset:4416
    v_cvt_pk_bf16_f32 v222, v156, v157
    v_mfma_f32_16x16x32_bf16 v[132:135], a[64:67], a[16:19], v[228:231]
    v_exp_f32 v158, v158
    v_mfma_f32_16x16x32_bf16 v[132:135], a[68:71], a[20:23], v[132:135]
    ds_read_b128 a[88:91], v240 offset:4672
    s_addk_i32 s70, 16384
    v_mfma_f32_16x16x32_bf16 v[132:135], a[72:75], a[24:27], v[132:135]
    v_exp_f32 v159, v159
    v_mfma_f32_16x16x32_bf16 v[132:135], a[76:79], a[28:31], v[132:135]
    ds_read_b128 a[92:95], v240 offset:4928
    v_cvt_pk_bf16_f32 v223, v158, v159
    v_mfma_f32_16x16x32_bf16 v[136:139], a[64:67], a[32:35], v[232:235]
    v_exp_f32 v128, v128
    v_mfma_f32_16x16x32_bf16 v[136:139], a[68:71], a[36:39], v[136:139]
    s_add_u32 m0, s3, 66560
    v_mfma_f32_16x16x32_bf16 v[136:139], a[72:75], a[40:43], v[136:139]
    v_exp_f32 v129, v129
    v_mfma_f32_16x16x32_bf16 v[136:139], a[76:79], a[44:47], v[136:139]
    buffer_load_dwordx4 v245, s[44:47], s70 offen offset:0 lds
    v_cvt_pk_bf16_f32 v192, v128, v129
    v_mfma_f32_16x16x32_bf16 v[140:143], a[64:67], a[48:51], v[236:239]
    v_exp_f32 v130, v130
    v_mfma_f32_16x16x32_bf16 v[140:143], a[68:71], a[52:55], v[140:143]
    s_addk_i32 m0, 16
    v_mfma_f32_16x16x32_bf16 v[140:143], a[72:75], a[56:59], v[140:143]
    v_exp_f32 v131, v131
    v_mfma_f32_16x16x32_bf16 v[140:143], a[76:79], a[60:63], v[140:143]
    s_waitcnt lgkmcnt(0)
    v_cvt_pk_bf16_f32 v193, v130, v131
    v_mfma_f32_16x16x32_bf16 v[144:147], a[80:83], a[0:3], v[224:227]
    ds_read_b64_tr_b16 a[64:65], v241 offset:8192
    buffer_load_dwordx4 v245, s[44:47], s70 offen offset:1024 lds
    v_mfma_f32_16x16x32_bf16 v[144:147], a[84:87], a[4:7], v[144:147]
    v_exp_f32 v132, v132
    v_mfma_f32_16x16x32_bf16 v[144:147], a[88:91], a[8:11], v[144:147]
    ds_read_b64_tr_b16 a[66:67], v241 offset:12288
    s_addk_i32 m0, 16
    v_mfma_f32_16x16x32_bf16 v[144:147], a[92:95], a[12:15], v[144:147]
    v_exp_f32 v133, v133
    v_mfma_f32_16x16x32_bf16 v[148:151], a[80:83], a[16:19], v[228:231]
    ds_read_b64_tr_b16 a[68:69], v249 offset:8192
    v_cvt_pk_bf16_f32 v196, v132, v133
    v_mfma_f32_16x16x32_bf16 v[148:151], a[84:87], a[20:23], v[148:151]
    v_exp_f32 v134, v134
    v_mfma_f32_16x16x32_bf16 v[148:151], a[88:91], a[24:27], v[148:151]
    ds_read_b64_tr_b16 a[70:71], v249 offset:12288
    buffer_load_dwordx4 v245, s[44:47], s70 offen offset:2048 lds
    v_mfma_f32_16x16x32_bf16 v[148:151], a[92:95], a[28:31], v[148:151]
    v_exp_f32 v135, v135
    v_mfma_f32_16x16x32_bf16 v[152:155], a[80:83], a[32:35], v[232:235]
    ds_read_b64_tr_b16 a[72:73], v241 offset:8448
    v_cvt_pk_bf16_f32 v197, v134, v135
    v_mfma_f32_16x16x32_bf16 v[152:155], a[84:87], a[36:39], v[152:155]
    v_exp_f32 v136, v136
    v_mfma_f32_16x16x32_bf16 v[152:155], a[88:91], a[40:43], v[152:155]
    ds_read_b64_tr_b16 a[74:75], v241 offset:12544
    s_addk_i32 m0, 16
    v_mfma_f32_16x16x32_bf16 v[152:155], a[92:95], a[44:47], v[152:155]
    v_exp_f32 v137, v137
    v_mfma_f32_16x16x32_bf16 v[156:159], a[80:83], a[48:51], v[236:239]
    ds_read_b64_tr_b16 a[76:77], v249 offset:8448
    v_cvt_pk_bf16_f32 v200, v136, v137
    v_mfma_f32_16x16x32_bf16 v[156:159], a[84:87], a[52:55], v[156:159]
    v_exp_f32 v138, v138
    v_mfma_f32_16x16x32_bf16 v[156:159], a[88:91], a[56:59], v[156:159]
    s_waitcnt lgkmcnt(3)
    ds_read_b64_tr_b16 a[78:79], v249 offset:12544
    v_mfma_f32_16x16x32_bf16 v[156:159], a[92:95], a[60:63], v[156:159]
    v_exp_f32 v139, v139
    v_mfma_f32_16x16x32_bf16 v[0:3], a[64:67], v[208:211], v[0:3]
    ds_read_b64_tr_b16 a[80:81], v241 offset:8704
    v_cvt_pk_bf16_f32 v201, v138, v139
    v_mfma_f32_16x16x32_bf16 v[4:7], a[64:67], v[212:215], v[4:7]
    ds_read_b64_tr_b16 a[82:83], v241 offset:12800
    buffer_load_dwordx4 v245, s[44:47], s70 offen offset:3072 lds
    v_mfma_f32_16x16x32_bf16 v[8:11], a[64:67], v[216:219], v[8:11]
    v_exp_f32 v140, v140
    v_mfma_f32_16x16x32_bf16 v[12:15], a[64:67], v[220:223], v[12:15]
    ds_read_b64_tr_b16 a[84:85], v249 offset:8704
    v_mfma_f32_16x16x32_bf16 v[168:171], v[184:187], v[208:211], v[168:171]
    v_exp_f32 v141, v141
    v_mfma_f32_16x16x32_bf16 v[16:19], a[68:71], v[208:211], v[16:19]
    ds_read_b64_tr_b16 a[86:87], v249 offset:12800
    v_cvt_pk_bf16_f32 v204, v140, v141
    v_mfma_f32_16x16x32_bf16 v[20:23], a[68:71], v[212:215], v[20:23]
    v_exp_f32 v142, v142
    v_mfma_f32_16x16x32_bf16 v[24:27], a[68:71], v[216:219], v[24:27]
    s_waitcnt lgkmcnt(4)
    ds_read_b64_tr_b16 a[88:89], v241 offset:8960
    v_mfma_f32_16x16x32_bf16 v[28:31], a[68:71], v[220:223], v[28:31]
    v_exp_f32 v143, v143
    v_mfma_f32_16x16x32_bf16 v[32:35], a[72:75], v[208:211], v[32:35]
    ds_read_b64_tr_b16 a[90:91], v241 offset:13056
    v_cvt_pk_bf16_f32 v205, v142, v143
    v_mfma_f32_16x16x32_bf16 v[36:39], a[72:75], v[212:215], v[36:39]
    v_exp_f32 v144, v144
    v_mfma_f32_16x16x32_bf16 v[40:43], a[72:75], v[216:219], v[40:43]
    ds_read_b64_tr_b16 a[92:93], v249 offset:8960
    buffer_load_dword v242, v190, s[56:59], s97 offen offset:0
    v_mfma_f32_16x16x32_bf16 v[44:47], a[72:75], v[220:223], v[44:47]
    v_exp_f32 v145, v145
    v_mfma_f32_16x16x32_bf16 v[172:175], v[184:187], v[212:215], v[172:175]
    ds_read_b64_tr_b16 a[94:95], v249 offset:13056
    v_cvt_pk_bf16_f32 v194, v144, v145
    v_mfma_f32_16x16x32_bf16 v[48:51], a[76:79], v[208:211], v[48:51]
    v_exp_f32 v146, v146
    v_mfma_f32_16x16x32_bf16 v[52:55], a[76:79], v[212:215], v[52:55]
    ds_read_b128 a[64:67], v240 offset:8320
    buffer_load_dword v242, v190, s[56:59], s97 offen offset:2048
    v_mfma_f32_16x16x32_bf16 v[56:59], a[76:79], v[216:219], v[56:59]
    v_exp_f32 v147, v147
    v_mfma_f32_16x16x32_bf16 v[60:63], a[76:79], v[220:223], v[60:63]
    s_waitcnt lgkmcnt(5)
    ds_read_b128 a[68:71], v240 offset:8576
    v_mfma_f32_16x16x32_bf16 v[64:67], a[80:83], v[208:211], v[64:67]
    ds_read_b128 a[72:75], v240 offset:8832
    v_cvt_pk_bf16_f32 v195, v146, v147
    v_mfma_f32_16x16x32_bf16 v[68:71], a[80:83], v[212:215], v[68:71]
    v_exp_f32 v148, v148
    v_mfma_f32_16x16x32_bf16 v[72:75], a[80:83], v[216:219], v[72:75]
    ds_read_b128 a[76:79], v240 offset:9088
    v_mfma_f32_16x16x32_bf16 v[76:79], a[80:83], v[220:223], v[76:79]
    v_exp_f32 v149, v149
    v_mfma_f32_16x16x32_bf16 v[176:179], v[184:187], v[216:219], v[176:179]
    v_cvt_pk_bf16_f32 v198, v148, v149
    v_add_u32 v241, 99840, v244
    v_mfma_f32_16x16x32_bf16 v[80:83], a[84:87], v[208:211], v[80:83]
    v_exp_f32 v150, v150
    v_mfma_f32_16x16x32_bf16 v[84:87], a[84:87], v[212:215], v[84:87]
L_pad3:
    s_cbranch_execz L_pad4
    v_xor_b32 v249, 32, v241
    v_mfma_f32_16x16x32_bf16 v[88:91], a[84:87], v[216:219], v[88:91]
    v_exp_f32 v151, v151
    v_mfma_f32_16x16x32_bf16 v[92:95], a[84:87], v[220:223], v[92:95]
    s_waitcnt lgkmcnt(4)
    v_cvt_pk_bf16_f32 v199, v150, v151
    v_mfma_f32_16x16x32_bf16 v[96:99], a[88:91], v[208:211], v[96:99]
    v_exp_f32 v152, v152
    v_mfma_f32_16x16x32_bf16 v[100:103], a[88:91], v[212:215], v[100:103]
    v_mfma_f32_16x16x32_bf16 v[104:107], a[88:91], v[216:219], v[104:107]
    v_exp_f32 v153, v153
    v_mfma_f32_16x16x32_bf16 v[108:111], a[88:91], v[220:223], v[108:111]
    v_cvt_pk_bf16_f32 v202, v152, v153
    v_mfma_f32_16x16x32_bf16 v[180:183], v[184:187], v[220:223], v[180:183]
    v_exp_f32 v154, v154
    v_mfma_f32_16x16x32_bf16 v[112:115], a[92:95], v[208:211], v[112:115]
    v_mfma_f32_16x16x32_bf16 v[116:119], a[92:95], v[212:215], v[116:119]
    v_exp_f32 v155, v155
    v_mfma_f32_16x16x32_bf16 v[120:123], a[92:95], v[216:219], v[120:123]
    buffer_load_dwordx4 a[128:131], v248, s[52:55], s96 offen
    v_cvt_pk_bf16_f32 v203, v154, v155
    v_mfma_f32_16x16x32_bf16 v[124:127], a[92:95], v[220:223], v[124:127]
    s_waitcnt lgkmcnt(0)
    s_addk_i32 s96, 6144
    v_mfma_f32_16x16x32_bf16 v[128:131], a[64:67], a[0:3], v[224:227]
    v_exp_f32 v156, v156
    v_mfma_f32_16x16x32_bf16 v[128:131], a[68:71], a[4:7], v[128:131]
    ds_read_b128 a[80:83], v240 offset:12480
    buffer_load_dwordx4 a[96:99], v246, s[64:67], s72 offen offset:0
    v_mfma_f32_16x16x32_bf16 v[128:131], a[72:75], a[8:11], v[128:131]
    v_exp_f32 v157, v157
    v_mfma_f32_16x16x32_bf16 v[128:131], a[76:79], a[12:15], v[128:131]
    ds_read_b128 a[84:87], v240 offset:12736
    v_cvt_pk_bf16_f32 v206, v156, v157
    v_mfma_f32_16x16x32_bf16 v[132:135], a[64:67], a[16:19], v[228:231]
    v_exp_f32 v158, v158
    v_mfma_f32_16x16x32_bf16 v[132:135], a[68:71], a[20:23], v[132:135]
    ds_read_b128 a[88:91], v240 offset:12992
    v_mfma_f32_16x16x32_bf16 v[132:135], a[72:75], a[24:27], v[132:135]
    v_exp_f32 v159, v159
    v_mfma_f32_16x16x32_bf16 v[132:135], a[76:79], a[28:31], v[132:135]
    ds_read_b128 a[92:95], v240 offset:13248
    v_cvt_pk_bf16_f32 v207, v158, v159
    v_mfma_f32_16x16x32_bf16 v[136:139], a[64:67], a[32:35], v[232:235]
    v_exp_f32 v128, v128
    v_mfma_f32_16x16x32_bf16 v[136:139], a[68:71], a[36:39], v[136:139]
    v_mfma_f32_16x16x32_bf16 v[136:139], a[72:75], a[40:43], v[136:139]
    v_exp_f32 v129, v129
    v_mfma_f32_16x16x32_bf16 v[136:139], a[76:79], a[44:47], v[136:139]
    v_cvt_pk_bf16_f32 v208, v128, v129
    v_add_u32 v240, 0, v243
    v_mfma_f32_16x16x32_bf16 v[140:143], a[64:67], a[48:51], v[236:239]
    v_exp_f32 v130, v130
    v_mfma_f32_16x16x32_bf16 v[140:143], a[68:71], a[52:55], v[140:143]
    buffer_load_dwordx4 a[132:135], v248, s[52:55], s96 offen
    s_addk_i32 s96, 6144
    v_mfma_f32_16x16x32_bf16 v[140:143], a[72:75], a[56:59], v[140:143]
    v_exp_f32 v131, v131
    v_mfma_f32_16x16x32_bf16 v[140:143], a[76:79], a[60:63], v[140:143]
    s_waitcnt lgkmcnt(0)
    v_cvt_pk_bf16_f32 v209, v130, v131
    v_mfma_f32_16x16x32_bf16 v[144:147], a[80:83], a[0:3], v[224:227]
    ds_read_b64_tr_b16 a[64:65], v241 offset:0
    buffer_load_dwordx4 a[100:103], v246, s[64:67], s15 offen offset:64
    v_mfma_f32_16x16x32_bf16 v[144:147], a[84:87], a[4:7], v[144:147]
    v_exp_f32 v132, v132
    v_mfma_f32_16x16x32_bf16 v[144:147], a[88:91], a[8:11], v[144:147]
    ds_read_b64_tr_b16 a[66:67], v241 offset:4096
    v_mfma_f32_16x16x32_bf16 v[144:147], a[92:95], a[12:15], v[144:147]
    v_exp_f32 v133, v133
    v_mfma_f32_16x16x32_bf16 v[148:151], a[80:83], a[16:19], v[228:231]
    ds_read_b64_tr_b16 a[68:69], v249 offset:0
    v_cvt_pk_bf16_f32 v212, v132, v133
    v_mfma_f32_16x16x32_bf16 v[148:151], a[84:87], a[20:23], v[148:151]
    v_exp_f32 v134, v134
    v_mfma_f32_16x16x32_bf16 v[148:151], a[88:91], a[24:27], v[148:151]
    ds_read_b64_tr_b16 a[70:71], v249 offset:4096
    v_mfma_f32_16x16x32_bf16 v[148:151], a[92:95], a[28:31], v[148:151]
    v_exp_f32 v135, v135
    v_mfma_f32_16x16x32_bf16 v[152:155], a[80:83], a[32:35], v[232:235]
    ds_read_b64_tr_b16 a[72:73], v241 offset:256
    v_cvt_pk_bf16_f32 v213, v134, v135
    v_mfma_f32_16x16x32_bf16 v[152:155], a[84:87], a[36:39], v[152:155]
    v_exp_f32 v136, v136
    v_mfma_f32_16x16x32_bf16 v[152:155], a[88:91], a[40:43], v[152:155]
    ds_read_b64_tr_b16 a[74:75], v241 offset:4352
    buffer_load_dwordx4 a[136:139], v248, s[52:55], s96 offen
    v_mfma_f32_16x16x32_bf16 v[152:155], a[92:95], a[44:47], v[152:155]
    v_exp_f32 v137, v137
    v_mfma_f32_16x16x32_bf16 v[156:159], a[80:83], a[48:51], v[236:239]
    ds_read_b64_tr_b16 a[76:77], v249 offset:256
    v_cvt_pk_bf16_f32 v216, v136, v137
    v_mfma_f32_16x16x32_bf16 v[156:159], a[84:87], a[52:55], v[156:159]
    v_exp_f32 v138, v138
    v_mfma_f32_16x16x32_bf16 v[156:159], a[88:91], a[56:59], v[156:159]
    s_waitcnt lgkmcnt(3)
    ds_read_b64_tr_b16 a[78:79], v249 offset:4352
    v_mfma_f32_16x16x32_bf16 v[156:159], a[92:95], a[60:63], v[156:159]
    v_exp_f32 v139, v139
    v_mfma_f32_16x16x32_bf16 v[0:3], a[64:67], v[192:195], v[0:3]
    ds_read_b64_tr_b16 a[80:81], v241 offset:512
    v_cvt_pk_bf16_f32 v217, v138, v139
    v_mfma_f32_16x16x32_bf16 v[4:7], a[64:67], v[196:199], v[4:7]
    ds_read_b64_tr_b16 a[82:83], v241 offset:4608
    s_addk_i32 s96, 6144
    v_mfma_f32_16x16x32_bf16 v[8:11], a[64:67], v[200:203], v[8:11]
    v_exp_f32 v140, v140
    v_mfma_f32_16x16x32_bf16 v[12:15], a[64:67], v[204:207], v[12:15]
    ds_read_b64_tr_b16 a[84:85], v249 offset:512
    buffer_load_dwordx4 a[104:107], v246, s[64:67], s15 offen offset:128
    s_add_u32 s72, s72, 176128
    v_mfma_f32_16x16x32_bf16 v[168:171], v[184:187], v[192:195], v[168:171]
    s_or_b32 s15, s14, s72
    v_exp_f32 v141, v141
    v_mfma_f32_16x16x32_bf16 v[16:19], a[68:71], v[192:195], v[16:19]
    ds_read_b64_tr_b16 a[86:87], v249 offset:4608
    v_cvt_pk_bf16_f32 v220, v140, v141
    v_mfma_f32_16x16x32_bf16 v[20:23], a[68:71], v[196:199], v[20:23]
    v_exp_f32 v142, v142
    v_mfma_f32_16x16x32_bf16 v[24:27], a[68:71], v[200:203], v[24:27]
    s_waitcnt lgkmcnt(4)
    ds_read_b64_tr_b16 a[88:89], v241 offset:768
    v_mfma_f32_16x16x32_bf16 v[28:31], a[68:71], v[204:207], v[28:31]
    v_exp_f32 v143, v143
    v_mfma_f32_16x16x32_bf16 v[32:35], a[72:75], v[192:195], v[32:35]
    ds_read_b64_tr_b16 a[90:91], v241 offset:4864
    buffer_load_dwordx4 a[108:111], v246, s[64:67], s72 offen offset:0
    v_cvt_pk_bf16_f32 v221, v142, v143
    v_mfma_f32_16x16x32_bf16 v[36:39], a[72:75], v[196:199], v[36:39]
    v_exp_f32 v144, v144
    v_mfma_f32_16x16x32_bf16 v[40:43], a[72:75], v[200:203], v[40:43]
    ds_read_b64_tr_b16 a[92:93], v249 offset:768
    v_mfma_f32_16x16x32_bf16 v[44:47], a[72:75], v[204:207], v[44:47]
    v_exp_f32 v145, v145
    v_mfma_f32_16x16x32_bf16 v[172:175], v[184:187], v[196:199], v[172:175]
    ds_read_b64_tr_b16 a[94:95], v249 offset:4864
    v_cvt_pk_bf16_f32 v210, v144, v145
    v_mfma_f32_16x16x32_bf16 v[48:51], a[76:79], v[192:195], v[48:51]
    v_exp_f32 v146, v146
    v_mfma_f32_16x16x32_bf16 v[52:55], a[76:79], v[196:199], v[52:55]
    v_mfma_f32_16x16x32_bf16 v[56:59], a[76:79], v[200:203], v[56:59]
    v_exp_f32 v147, v147
    v_mfma_f32_16x16x32_bf16 v[60:63], a[76:79], v[204:207], v[60:63]
    s_waitcnt lgkmcnt(4)
    s_waitcnt vmcnt(23)
    s_barrier
    v_mfma_f32_16x16x32_bf16 v[64:67], a[80:83], v[192:195], v[64:67]
    ds_read_b128 a[64:67], v240 offset:0
    v_cvt_pk_bf16_f32 v211, v146, v147
    v_mfma_f32_16x16x32_bf16 v[68:71], a[80:83], v[196:199], v[68:71]
    v_exp_f32 v148, v148
    v_mfma_f32_16x16x32_bf16 v[72:75], a[80:83], v[200:203], v[72:75]
    ds_read_b128 a[68:71], v240 offset:256
    s_add_u32 m0, s39, 66560
    v_mfma_f32_16x16x32_bf16 v[76:79], a[80:83], v[204:207], v[76:79]
    v_exp_f32 v149, v149
    v_mfma_f32_16x16x32_bf16 v[176:179], v[184:187], v[200:203], v[176:179]
    ds_read_b128 a[72:75], v240 offset:512
    v_cvt_pk_bf16_f32 v214, v148, v149
    v_mfma_f32_16x16x32_bf16 v[80:83], a[84:87], v[192:195], v[80:83]
    v_exp_f32 v150, v150
    v_mfma_f32_16x16x32_bf16 v[84:87], a[84:87], v[196:199], v[84:87]
    ds_read_b128 a[76:79], v240 offset:768
    buffer_load_dwordx4 v245, s[48:51], s70 offen offset:0 lds
    v_mfma_f32_16x16x32_bf16 v[88:91], a[84:87], v[200:203], v[88:91]
    v_exp_f32 v151, v151
    v_mfma_f32_16x16x32_bf16 v[92:95], a[84:87], v[204:207], v[92:95]
    s_waitcnt lgkmcnt(4)
    v_cvt_pk_bf16_f32 v215, v150, v151
    v_mfma_f32_16x16x32_bf16 v[96:99], a[88:91], v[192:195], v[96:99]
    v_exp_f32 v152, v152
    v_mfma_f32_16x16x32_bf16 v[100:103], a[88:91], v[196:199], v[100:103]
    buffer_load_dwordx4 v250, s[48:51], s70 offen offset:1024 lds
    v_mfma_f32_16x16x32_bf16 v[104:107], a[88:91], v[200:203], v[104:107]
    v_exp_f32 v153, v153
    v_mfma_f32_16x16x32_bf16 v[108:111], a[88:91], v[204:207], v[108:111]
    v_cvt_pk_bf16_f32 v218, v152, v153
    v_mfma_f32_16x16x32_bf16 v[180:183], v[184:187], v[204:207], v[180:183]
    v_exp_f32 v154, v154
    v_mfma_f32_16x16x32_bf16 v[112:115], a[92:95], v[192:195], v[112:115]
    buffer_load_dwordx4 v245, s[48:51], s70 offen offset:2048 lds
    v_mfma_f32_16x16x32_bf16 v[116:119], a[92:95], v[196:199], v[116:119]
    v_exp_f32 v155, v155
    v_mfma_f32_16x16x32_bf16 v[120:123], a[92:95], v[200:203], v[120:123]
    v_cvt_pk_bf16_f32 v219, v154, v155
    v_mfma_f32_16x16x32_bf16 v[124:127], a[92:95], v[204:207], v[124:127]
    s_waitcnt lgkmcnt(0)
    v_mfma_f32_16x16x32_bf16 v[128:131], a[64:67], a[0:3], v[224:227]
    v_exp_f32 v156, v156
    v_mfma_f32_16x16x32_bf16 v[128:131], a[68:71], a[4:7], v[128:131]
    ds_read_b128 a[80:83], v240 offset:4160
    buffer_load_dwordx4 v250, s[48:51], s70 offen offset:3072 lds
    v_mfma_f32_16x16x32_bf16 v[128:131], a[72:75], a[8:11], v[128:131]
    v_exp_f32 v157, v157
    v_mfma_f32_16x16x32_bf16 v[128:131], a[76:79], a[12:15], v[128:131]
    ds_read_b128 a[84:87], v240 offset:4416
    v_cvt_pk_bf16_f32 v222, v156, v157
    v_mfma_f32_16x16x32_bf16 v[132:135], a[64:67], a[16:19], v[228:231]
    v_exp_f32 v158, v158
    v_mfma_f32_16x16x32_bf16 v[132:135], a[68:71], a[20:23], v[132:135]
    ds_read_b128 a[88:91], v240 offset:4672
    s_addk_i32 s70, 16384
    v_mfma_f32_16x16x32_bf16 v[132:135], a[72:75], a[24:27], v[132:135]
    v_exp_f32 v159, v159
    v_mfma_f32_16x16x32_bf16 v[132:135], a[76:79], a[28:31], v[132:135]
    ds_read_b128 a[92:95], v240 offset:4928
    v_cvt_pk_bf16_f32 v223, v158, v159
    v_mfma_f32_16x16x32_bf16 v[136:139], a[64:67], a[32:35], v[232:235]
    v_exp_f32 v128, v128
    v_mfma_f32_16x16x32_bf16 v[136:139], a[68:71], a[36:39], v[136:139]
    s_add_u32 m0, s3, 99840
    v_mfma_f32_16x16x32_bf16 v[136:139], a[72:75], a[40:43], v[136:139]
    v_exp_f32 v129, v129
    v_mfma_f32_16x16x32_bf16 v[136:139], a[76:79], a[44:47], v[136:139]
    buffer_load_dwordx4 v245, s[44:47], s70 offen offset:0 lds
    v_cvt_pk_bf16_f32 v192, v128, v129
    v_mfma_f32_16x16x32_bf16 v[140:143], a[64:67], a[48:51], v[236:239]
    v_exp_f32 v130, v130
    v_mfma_f32_16x16x32_bf16 v[140:143], a[68:71], a[52:55], v[140:143]
    s_addk_i32 m0, 16
    v_mfma_f32_16x16x32_bf16 v[140:143], a[72:75], a[56:59], v[140:143]
    v_exp_f32 v131, v131
    v_mfma_f32_16x16x32_bf16 v[140:143], a[76:79], a[60:63], v[140:143]
    s_waitcnt lgkmcnt(0)
    v_cvt_pk_bf16_f32 v193, v130, v131
    v_mfma_f32_16x16x32_bf16 v[144:147], a[80:83], a[0:3], v[224:227]
    ds_read_b64_tr_b16 a[64:65], v241 offset:8192
    buffer_load_dwordx4 v245, s[44:47], s70 offen offset:1024 lds
    v_mfma_f32_16x16x32_bf16 v[144:147], a[84:87], a[4:7], v[144:147]
    v_exp_f32 v132, v132
    v_mfma_f32_16x16x32_bf16 v[144:147], a[88:91], a[8:11], v[144:147]
    ds_read_b64_tr_b16 a[66:67], v241 offset:12288
    s_addk_i32 m0, 16
    v_mfma_f32_16x16x32_bf16 v[144:147], a[92:95], a[12:15], v[144:147]
    v_exp_f32 v133, v133
    v_mfma_f32_16x16x32_bf16 v[148:151], a[80:83], a[16:19], v[228:231]
    ds_read_b64_tr_b16 a[68:69], v249 offset:8192
    v_cvt_pk_bf16_f32 v196, v132, v133
    v_mfma_f32_16x16x32_bf16 v[148:151], a[84:87], a[20:23], v[148:151]
    v_exp_f32 v134, v134
    v_mfma_f32_16x16x32_bf16 v[148:151], a[88:91], a[24:27], v[148:151]
    ds_read_b64_tr_b16 a[70:71], v249 offset:12288
    buffer_load_dwordx4 v245, s[44:47], s70 offen offset:2048 lds
    v_mfma_f32_16x16x32_bf16 v[148:151], a[92:95], a[28:31], v[148:151]
    v_exp_f32 v135, v135
    v_mfma_f32_16x16x32_bf16 v[152:155], a[80:83], a[32:35], v[232:235]
    ds_read_b64_tr_b16 a[72:73], v241 offset:8448
    v_cvt_pk_bf16_f32 v197, v134, v135
    v_mfma_f32_16x16x32_bf16 v[152:155], a[84:87], a[36:39], v[152:155]
    v_exp_f32 v136, v136
    v_mfma_f32_16x16x32_bf16 v[152:155], a[88:91], a[40:43], v[152:155]
    ds_read_b64_tr_b16 a[74:75], v241 offset:12544
    s_addk_i32 m0, 16
    v_mfma_f32_16x16x32_bf16 v[152:155], a[92:95], a[44:47], v[152:155]
    v_exp_f32 v137, v137
    v_mfma_f32_16x16x32_bf16 v[156:159], a[80:83], a[48:51], v[236:239]
    ds_read_b64_tr_b16 a[76:77], v249 offset:8448
    v_cvt_pk_bf16_f32 v200, v136, v137
    v_mfma_f32_16x16x32_bf16 v[156:159], a[84:87], a[52:55], v[156:159]
    v_exp_f32 v138, v138
    v_mfma_f32_16x16x32_bf16 v[156:159], a[88:91], a[56:59], v[156:159]
    s_waitcnt lgkmcnt(3)
    ds_read_b64_tr_b16 a[78:79], v249 offset:12544
    v_mfma_f32_16x16x32_bf16 v[156:159], a[92:95], a[60:63], v[156:159]
    v_exp_f32 v139, v139
    v_mfma_f32_16x16x32_bf16 v[0:3], a[64:67], v[208:211], v[0:3]
    ds_read_b64_tr_b16 a[80:81], v241 offset:8704
    v_cvt_pk_bf16_f32 v201, v138, v139
    v_mfma_f32_16x16x32_bf16 v[4:7], a[64:67], v[212:215], v[4:7]
    ds_read_b64_tr_b16 a[82:83], v241 offset:12800
    buffer_load_dwordx4 v245, s[44:47], s70 offen offset:3072 lds
    v_mfma_f32_16x16x32_bf16 v[8:11], a[64:67], v[216:219], v[8:11]
    v_exp_f32 v140, v140
    v_mfma_f32_16x16x32_bf16 v[12:15], a[64:67], v[220:223], v[12:15]
    ds_read_b64_tr_b16 a[84:85], v249 offset:8704
    s_lshl_b32 s79, s37, 17
    v_mfma_f32_16x16x32_bf16 v[168:171], v[184:187], v[208:211], v[168:171]
    v_exp_f32 v141, v141
    v_mfma_f32_16x16x32_bf16 v[16:19], a[68:71], v[208:211], v[16:19]
    ds_read_b64_tr_b16 a[86:87], v249 offset:12800
    v_cvt_pk_bf16_f32 v204, v140, v141
    v_mfma_f32_16x16x32_bf16 v[20:23], a[68:71], v[212:215], v[20:23]
    v_exp_f32 v142, v142
    v_mfma_f32_16x16x32_bf16 v[24:27], a[68:71], v[216:219], v[24:27]
    s_waitcnt lgkmcnt(4)
    ds_read_b64_tr_b16 a[88:89], v241 offset:8960
    v_mfma_f32_16x16x32_bf16 v[28:31], a[68:71], v[220:223], v[28:31]
    v_exp_f32 v143, v143
    v_mfma_f32_16x16x32_bf16 v[32:35], a[72:75], v[208:211], v[32:35]
    ds_read_b64_tr_b16 a[90:91], v241 offset:13056
    v_cvt_pk_bf16_f32 v205, v142, v143
    v_mfma_f32_16x16x32_bf16 v[36:39], a[72:75], v[212:215], v[36:39]
    v_exp_f32 v144, v144
    v_mfma_f32_16x16x32_bf16 v[40:43], a[72:75], v[216:219], v[40:43]
    ds_read_b64_tr_b16 a[92:93], v249 offset:8960
    s_add_u32 s79, s79, s68
    v_mfma_f32_16x16x32_bf16 v[44:47], a[72:75], v[220:223], v[44:47]
    v_exp_f32 v145, v145
    v_mfma_f32_16x16x32_bf16 v[172:175], v[184:187], v[212:215], v[172:175]
    ds_read_b64_tr_b16 a[94:95], v249 offset:13056
    v_cvt_pk_bf16_f32 v194, v144, v145
    v_mfma_f32_16x16x32_bf16 v[48:51], a[76:79], v[208:211], v[48:51]
    v_exp_f32 v146, v146
    v_mfma_f32_16x16x32_bf16 v[52:55], a[76:79], v[212:215], v[52:55]
    ds_read_b128 a[64:67], v240 offset:8320
    s_add_u32 m0, s39, 116480
    v_mfma_f32_16x16x32_bf16 v[56:59], a[76:79], v[216:219], v[56:59]
    v_exp_f32 v147, v147
    v_mfma_f32_16x16x32_bf16 v[60:63], a[76:79], v[220:223], v[60:63]
    s_waitcnt lgkmcnt(5)
    ds_read_b128 a[68:71], v240 offset:8576
    v_mfma_f32_16x16x32_bf16 v[64:67], a[80:83], v[208:211], v[64:67]
    ds_read_b128 a[72:75], v240 offset:8832
    v_cvt_pk_bf16_f32 v195, v146, v147
    v_mfma_f32_16x16x32_bf16 v[68:71], a[80:83], v[212:215], v[68:71]
    v_exp_f32 v148, v148
    v_mfma_f32_16x16x32_bf16 v[72:75], a[80:83], v[216:219], v[72:75]
    ds_read_b128 a[76:79], v240 offset:9088
    buffer_load_dwordx4 v255, s[60:63], s79 offen offset:0 lds
    v_mfma_f32_16x16x32_bf16 v[76:79], a[80:83], v[220:223], v[76:79]
    v_exp_f32 v149, v149
    v_mfma_f32_16x16x32_bf16 v[176:179], v[184:187], v[216:219], v[176:179]
    v_cvt_pk_bf16_f32 v198, v148, v149
    v_add_u32 v241, 0, v244
    v_mfma_f32_16x16x32_bf16 v[80:83], a[84:87], v[208:211], v[80:83]
    v_exp_f32 v150, v150
    v_mfma_f32_16x16x32_bf16 v[84:87], a[84:87], v[212:215], v[84:87]
    v_xor_b32 v249, 32, v241
    v_mfma_f32_16x16x32_bf16 v[88:91], a[84:87], v[216:219], v[88:91]
    v_exp_f32 v151, v151
    v_mfma_f32_16x16x32_bf16 v[92:95], a[84:87], v[220:223], v[92:95]
    s_waitcnt lgkmcnt(4)
    v_cvt_pk_bf16_f32 v199, v150, v151
    v_mfma_f32_16x16x32_bf16 v[96:99], a[88:91], v[208:211], v[96:99]
    v_exp_f32 v152, v152
    v_mfma_f32_16x16x32_bf16 v[100:103], a[88:91], v[212:215], v[100:103]
    v_mfma_f32_16x16x32_bf16 v[104:107], a[88:91], v[216:219], v[104:107]
    v_exp_f32 v153, v153
    v_mfma_f32_16x16x32_bf16 v[108:111], a[88:91], v[220:223], v[108:111]
    buffer_load_dwordx4 v251, s[60:63], s79 offen offset:1024 lds
    v_cvt_pk_bf16_f32 v202, v152, v153
    v_mfma_f32_16x16x32_bf16 v[180:183], v[184:187], v[220:223], v[180:183]
    v_exp_f32 v154, v154
    v_mfma_f32_16x16x32_bf16 v[112:115], a[92:95], v[208:211], v[112:115]
    v_mfma_f32_16x16x32_bf16 v[116:119], a[92:95], v[212:215], v[116:119]
    v_exp_f32 v155, v155
    v_mfma_f32_16x16x32_bf16 v[120:123], a[92:95], v[216:219], v[120:123]
    buffer_load_dwordx4 a[140:143], v248, s[52:55], s96 offen
    v_cvt_pk_bf16_f32 v203, v154, v155
    v_mfma_f32_16x16x32_bf16 v[124:127], a[92:95], v[220:223], v[124:127]
    s_waitcnt lgkmcnt(0)
    s_addk_i32 s96, 6144
    v_mfma_f32_16x16x32_bf16 v[128:131], a[64:67], a[0:3], v[224:227]
    v_exp_f32 v156, v156
    v_mfma_f32_16x16x32_bf16 v[128:131], a[68:71], a[4:7], v[128:131]
    ds_read_b128 a[80:83], v240 offset:12480
    buffer_load_dwordx4 a[112:115], v246, s[64:67], s15 offen offset:64
    v_mfma_f32_16x16x32_bf16 v[128:131], a[72:75], a[8:11], v[128:131]
    v_exp_f32 v157, v157
    v_mfma_f32_16x16x32_bf16 v[128:131], a[76:79], a[12:15], v[128:131]
    ds_read_b128 a[84:87], v240 offset:12736
    v_cvt_pk_bf16_f32 v206, v156, v157
    v_mfma_f32_16x16x32_bf16 v[132:135], a[64:67], a[16:19], v[228:231]
    v_exp_f32 v158, v158
    v_mfma_f32_16x16x32_bf16 v[132:135], a[68:71], a[20:23], v[132:135]
    ds_read_b128 a[88:91], v240 offset:12992
    buffer_load_dwordx4 v252, s[60:63], s79 offen offset:2048 lds
    v_mfma_f32_16x16x32_bf16 v[132:135], a[72:75], a[24:27], v[132:135]
    v_exp_f32 v159, v159
    v_mfma_f32_16x16x32_bf16 v[132:135], a[76:79], a[28:31], v[132:135]
    ds_read_b128 a[92:95], v240 offset:13248
    v_cvt_pk_bf16_f32 v207, v158, v159
    v_mfma_f32_16x16x32_bf16 v[136:139], a[64:67], a[32:35], v[232:235]
    v_exp_f32 v128, v128
    v_mfma_f32_16x16x32_bf16 v[136:139], a[68:71], a[36:39], v[136:139]
    v_mfma_f32_16x16x32_bf16 v[136:139], a[72:75], a[40:43], v[136:139]
    v_exp_f32 v129, v129
    v_mfma_f32_16x16x32_bf16 v[136:139], a[76:79], a[44:47], v[136:139]
    v_cvt_pk_bf16_f32 v208, v128, v129
    v_add_u32 v240, 33280, v243
    v_mfma_f32_16x16x32_bf16 v[140:143], a[64:67], a[48:51], v[236:239]
    v_exp_f32 v130, v130
    v_mfma_f32_16x16x32_bf16 v[140:143], a[68:71], a[52:55], v[140:143]
    buffer_load_dwordx4 a[144:147], v248, s[52:55], s96 offen
    s_addk_i32 s96, 6144
    v_mfma_f32_16x16x32_bf16 v[140:143], a[72:75], a[56:59], v[140:143]
    v_exp_f32 v131, v131
    v_mfma_f32_16x16x32_bf16 v[140:143], a[76:79], a[60:63], v[140:143]
    s_waitcnt lgkmcnt(0)
    v_cvt_pk_bf16_f32 v209, v130, v131
    v_mfma_f32_16x16x32_bf16 v[144:147], a[80:83], a[0:3], v[224:227]
    ds_read_b64_tr_b16 a[64:65], v241 offset:0
    buffer_load_dwordx4 v253, s[60:63], s79 offen offset:3072 lds
    v_mfma_f32_16x16x32_bf16 v[144:147], a[84:87], a[4:7], v[144:147]
    v_exp_f32 v132, v132
    v_mfma_f32_16x16x32_bf16 v[144:147], a[88:91], a[8:11], v[144:147]
    ds_read_b64_tr_b16 a[66:67], v241 offset:4096
    buffer_load_dwordx4 a[116:119], v246, s[64:67], s15 offen offset:128
    v_mfma_f32_16x16x32_bf16 v[144:147], a[92:95], a[12:15], v[144:147]
    v_exp_f32 v133, v133
    v_mfma_f32_16x16x32_bf16 v[148:151], a[80:83], a[16:19], v[228:231]
    ds_read_b64_tr_b16 a[68:69], v249 offset:0
    v_cvt_pk_bf16_f32 v212, v132, v133
    v_mfma_f32_16x16x32_bf16 v[148:151], a[84:87], a[20:23], v[148:151]
    v_exp_f32 v134, v134
    v_mfma_f32_16x16x32_bf16 v[148:151], a[88:91], a[24:27], v[148:151]
    ds_read_b64_tr_b16 a[70:71], v249 offset:4096
    s_add_u32 s72, s72, 176128
    v_mfma_f32_16x16x32_bf16 v[148:151], a[92:95], a[28:31], v[148:151]
    v_exp_f32 v135, v135
    v_mfma_f32_16x16x32_bf16 v[152:155], a[80:83], a[32:35], v[232:235]
    ds_read_b64_tr_b16 a[72:73], v241 offset:256
    v_cvt_pk_bf16_f32 v213, v134, v135
    v_mfma_f32_16x16x32_bf16 v[152:155], a[84:87], a[36:39], v[152:155]
    v_exp_f32 v136, v136
    v_mfma_f32_16x16x32_bf16 v[152:155], a[88:91], a[40:43], v[152:155]
    ds_read_b64_tr_b16 a[74:75], v241 offset:4352
    buffer_load_dwordx4 a[148:151], v248, s[52:55], s96 offen
    v_mfma_f32_16x16x32_bf16 v[152:155], a[92:95], a[44:47], v[152:155]
    v_exp_f32 v137, v137
    v_mfma_f32_16x16x32_bf16 v[156:159], a[80:83], a[48:51], v[236:239]
    ds_read_b64_tr_b16 a[76:77], v249 offset:256
    v_cvt_pk_bf16_f32 v216, v136, v137
    v_mfma_f32_16x16x32_bf16 v[156:159], a[84:87], a[52:55], v[156:159]
    v_exp_f32 v138, v138
    v_mfma_f32_16x16x32_bf16 v[156:159], a[88:91], a[56:59], v[156:159]
    s_waitcnt lgkmcnt(3)
    ds_read_b64_tr_b16 a[78:79], v249 offset:4352
    v_mfma_f32_16x16x32_bf16 v[156:159], a[92:95], a[60:63], v[156:159]
    v_exp_f32 v139, v139
    v_mfma_f32_16x16x32_bf16 v[0:3], a[64:67], v[192:195], v[0:3]
    ds_read_b64_tr_b16 a[80:81], v241 offset:512
    v_cvt_pk_bf16_f32 v217, v138, v139
    v_mfma_f32_16x16x32_bf16 v[4:7], a[64:67], v[196:199], v[4:7]
    ds_read_b64_tr_b16 a[82:83], v241 offset:4608
    s_addk_i32 s96, 6144
    v_mfma_f32_16x16x32_bf16 v[8:11], a[64:67], v[200:203], v[8:11]
    v_exp_f32 v140, v140
    v_mfma_f32_16x16x32_bf16 v[12:15], a[64:67], v[204:207], v[12:15]
    ds_read_b64_tr_b16 a[84:85], v249 offset:512
    s_or_b32 s15, s14, s72
    buffer_load_dwordx4 a[120:123], v246, s[64:67], s72 offen offset:0
    v_mfma_f32_16x16x32_bf16 v[168:171], v[184:187], v[192:195], v[168:171]
    v_exp_f32 v141, v141
    v_mfma_f32_16x16x32_bf16 v[16:19], a[68:71], v[192:195], v[16:19]
    ds_read_b64_tr_b16 a[86:87], v249 offset:4608
    v_cvt_pk_bf16_f32 v220, v140, v141
    v_mfma_f32_16x16x32_bf16 v[20:23], a[68:71], v[196:199], v[20:23]
    v_exp_f32 v142, v142
    v_mfma_f32_16x16x32_bf16 v[24:27], a[68:71], v[200:203], v[24:27]
    s_waitcnt lgkmcnt(4)
    ds_read_b64_tr_b16 a[88:89], v241 offset:768
    v_mfma_f32_16x16x32_bf16 v[28:31], a[68:71], v[204:207], v[28:31]
    v_exp_f32 v143, v143
    v_mfma_f32_16x16x32_bf16 v[32:35], a[72:75], v[192:195], v[32:35]
    ds_read_b64_tr_b16 a[90:91], v241 offset:4864
    buffer_load_dwordx4 a[124:127], v246, s[64:67], s15 offen offset:64
    v_cvt_pk_bf16_f32 v221, v142, v143
    v_mfma_f32_16x16x32_bf16 v[36:39], a[72:75], v[196:199], v[36:39]
    v_exp_f32 v144, v144
    v_mfma_f32_16x16x32_bf16 v[40:43], a[72:75], v[200:203], v[40:43]
    ds_read_b64_tr_b16 a[92:93], v249 offset:768
    v_mfma_f32_16x16x32_bf16 v[44:47], a[72:75], v[204:207], v[44:47]
    v_exp_f32 v145, v145
    v_mfma_f32_16x16x32_bf16 v[172:175], v[184:187], v[196:199], v[172:175]
    ds_read_b64_tr_b16 a[94:95], v249 offset:4864
    v_cvt_pk_bf16_f32 v210, v144, v145
    v_mfma_f32_16x16x32_bf16 v[48:51], a[76:79], v[192:195], v[48:51]
    v_exp_f32 v146, v146
    v_mfma_f32_16x16x32_bf16 v[52:55], a[76:79], v[196:199], v[52:55]
    v_mfma_f32_16x16x32_bf16 v[56:59], a[76:79], v[200:203], v[56:59]
    v_exp_f32 v147, v147
    v_mfma_f32_16x16x32_bf16 v[60:63], a[76:79], v[204:207], v[60:63]
    s_waitcnt lgkmcnt(4)
    s_waitcnt vmcnt(32)
    s_barrier
    v_mfma_f32_16x16x32_bf16 v[64:67], a[80:83], v[192:195], v[64:67]
    ds_read_b128 a[64:67], v240 offset:0
    v_cvt_pk_bf16_f32 v211, v146, v147
    v_mfma_f32_16x16x32_bf16 v[68:71], a[80:83], v[196:199], v[68:71]
    v_exp_f32 v148, v148
    v_mfma_f32_16x16x32_bf16 v[72:75], a[80:83], v[200:203], v[72:75]
    ds_read_b128 a[68:71], v240 offset:256
    s_add_u32 m0, s39, 99840
    v_mfma_f32_16x16x32_bf16 v[76:79], a[80:83], v[204:207], v[76:79]
    v_exp_f32 v149, v149
    v_mfma_f32_16x16x32_bf16 v[176:179], v[184:187], v[200:203], v[176:179]
    ds_read_b128 a[72:75], v240 offset:512
    v_cvt_pk_bf16_f32 v214, v148, v149
    v_mfma_f32_16x16x32_bf16 v[80:83], a[84:87], v[192:195], v[80:83]
    v_exp_f32 v150, v150
    v_mfma_f32_16x16x32_bf16 v[84:87], a[84:87], v[196:199], v[84:87]
    ds_read_b128 a[76:79], v240 offset:768
    buffer_load_dwordx4 v245, s[48:51], s70 offen offset:0 lds
    v_mfma_f32_16x16x32_bf16 v[88:91], a[84:87], v[200:203], v[88:91]
    v_exp_f32 v151, v151
    v_mfma_f32_16x16x32_bf16 v[92:95], a[84:87], v[204:207], v[92:95]
    s_waitcnt lgkmcnt(4)
    v_cvt_pk_bf16_f32 v215, v150, v151
    v_mfma_f32_16x16x32_bf16 v[96:99], a[88:91], v[192:195], v[96:99]
    v_exp_f32 v152, v152
    v_mfma_f32_16x16x32_bf16 v[100:103], a[88:91], v[196:199], v[100:103]
    buffer_load_dwordx4 v250, s[48:51], s70 offen offset:1024 lds
    v_mfma_f32_16x16x32_bf16 v[104:107], a[88:91], v[200:203], v[104:107]
    v_exp_f32 v153, v153
    v_mfma_f32_16x16x32_bf16 v[108:111], a[88:91], v[204:207], v[108:111]
    v_cvt_pk_bf16_f32 v218, v152, v153
    v_mfma_f32_16x16x32_bf16 v[180:183], v[184:187], v[204:207], v[180:183]
    v_exp_f32 v154, v154
    v_mfma_f32_16x16x32_bf16 v[112:115], a[92:95], v[192:195], v[112:115]
    buffer_load_dwordx4 v245, s[48:51], s70 offen offset:2048 lds
    v_mfma_f32_16x16x32_bf16 v[116:119], a[92:95], v[196:199], v[116:119]
    v_exp_f32 v155, v155
    v_mfma_f32_16x16x32_bf16 v[120:123], a[92:95], v[200:203], v[120:123]
    v_cvt_pk_bf16_f32 v219, v154, v155
    v_mfma_f32_16x16x32_bf16 v[124:127], a[92:95], v[204:207], v[124:127]
    s_waitcnt lgkmcnt(0)
    v_mfma_f32_16x16x32_bf16 v[128:131], a[64:67], a[0:3], v[224:227]
    v_exp_f32 v156, v156
    v_mfma_f32_16x16x32_bf16 v[128:131], a[68:71], a[4:7], v[128:131]
    ds_read_b128 a[80:83], v240 offset:4160
    buffer_load_dwordx4 v250, s[48:51], s70 offen offset:3072 lds
    v_mfma_f32_16x16x32_bf16 v[128:131], a[72:75], a[8:11], v[128:131]
    v_exp_f32 v157, v157
    v_mfma_f32_16x16x32_bf16 v[128:131], a[76:79], a[12:15], v[128:131]
    ds_read_b128 a[84:87], v240 offset:4416
    v_cvt_pk_bf16_f32 v222, v156, v157
    v_mfma_f32_16x16x32_bf16 v[132:135], a[64:67], a[16:19], v[228:231]
    v_exp_f32 v158, v158
    v_mfma_f32_16x16x32_bf16 v[132:135], a[68:71], a[20:23], v[132:135]
    ds_read_b128 a[88:91], v240 offset:4672
    s_mov_b64 s[56:57], s[20:21]
    v_mfma_f32_16x16x32_bf16 v[132:135], a[72:75], a[24:27], v[132:135]
    v_exp_f32 v159, v159
    v_mfma_f32_16x16x32_bf16 v[132:135], a[76:79], a[28:31], v[132:135]
    ds_read_b128 a[92:95], v240 offset:4928
    v_cvt_pk_bf16_f32 v223, v158, v159
    v_mfma_f32_16x16x32_bf16 v[136:139], a[64:67], a[32:35], v[232:235]
    v_exp_f32 v128, v128
    v_mfma_f32_16x16x32_bf16 v[136:139], a[68:71], a[36:39], v[136:139]
    s_cmp_eq_u32 s37, 0
    s_cselect_b32 s79, 262144, s71
    v_mfma_f32_16x16x32_bf16 v[136:139], a[72:75], a[40:43], v[136:139]
    v_exp_f32 v129, v129
    v_mfma_f32_16x16x32_bf16 v[136:139], a[76:79], a[44:47], v[136:139]
    s_add_u32 s69, s69, s79
    v_cvt_pk_bf16_f32 v192, v128, v129
    v_mfma_f32_16x16x32_bf16 v[140:143], a[64:67], a[48:51], v[236:239]
    v_exp_f32 v130, v130
    v_mfma_f32_16x16x32_bf16 v[140:143], a[68:71], a[52:55], v[140:143]
    s_sub_u32 m0, s39, 16640
    s_mov_b32 s58, 1409024
    v_mfma_f32_16x16x32_bf16 v[140:143], a[72:75], a[56:59], v[140:143]
    v_exp_f32 v131, v131
    v_mfma_f32_16x16x32_bf16 v[140:143], a[76:79], a[60:63], v[140:143]
    s_waitcnt lgkmcnt(0)
    v_cvt_pk_bf16_f32 v193, v130, v131
    v_mfma_f32_16x16x32_bf16 v[144:147], a[80:83], a[0:3], v[224:227]
    ds_read_b64_tr_b16 a[64:65], v241 offset:8192
    buffer_load_dwordx4 v255, s[60:63], s69 offen offset:0 lds
    v_mfma_f32_16x16x32_bf16 v[144:147], a[84:87], a[4:7], v[144:147]
    v_exp_f32 v132, v132
    v_mfma_f32_16x16x32_bf16 v[144:147], a[88:91], a[8:11], v[144:147]
    ds_read_b64_tr_b16 a[66:67], v241 offset:12288
    buffer_load_dword v242, v188, s[56:59], 0 offen offset:0
    v_mfma_f32_16x16x32_bf16 v[144:147], a[92:95], a[12:15], v[144:147]
    v_exp_f32 v133, v133
    v_mfma_f32_16x16x32_bf16 v[148:151], a[80:83], a[16:19], v[228:231]
    ds_read_b64_tr_b16 a[68:69], v249 offset:8192
    v_cvt_pk_bf16_f32 v196, v132, v133
    v_mfma_f32_16x16x32_bf16 v[148:151], a[84:87], a[20:23], v[148:151]
    v_exp_f32 v134, v134
    v_mfma_f32_16x16x32_bf16 v[148:151], a[88:91], a[24:27], v[148:151]
    ds_read_b64_tr_b16 a[70:71], v249 offset:12288
    buffer_load_dword v242, v191, s[40:43], 0 offen sc1
    v_mfma_f32_16x16x32_bf16 v[148:151], a[92:95], a[28:31], v[148:151]
    v_exp_f32 v135, v135
    v_mfma_f32_16x16x32_bf16 v[152:155], a[80:83], a[32:35], v[232:235]
    ds_read_b64_tr_b16 a[72:73], v241 offset:8448
    v_cvt_pk_bf16_f32 v197, v134, v135
    v_mfma_f32_16x16x32_bf16 v[152:155], a[84:87], a[36:39], v[152:155]
    v_exp_f32 v136, v136
    v_mfma_f32_16x16x32_bf16 v[152:155], a[88:91], a[40:43], v[152:155]
    ds_read_b64_tr_b16 a[74:75], v241 offset:12544
    buffer_load_dwordx4 v251, s[60:63], s69 offen offset:1024 lds
    v_mfma_f32_16x16x32_bf16 v[152:155], a[92:95], a[44:47], v[152:155]
    v_exp_f32 v137, v137
    v_mfma_f32_16x16x32_bf16 v[156:159], a[80:83], a[48:51], v[236:239]
    ds_read_b64_tr_b16 a[76:77], v249 offset:8448
    v_cvt_pk_bf16_f32 v200, v136, v137
    v_mfma_f32_16x16x32_bf16 v[156:159], a[84:87], a[52:55], v[156:159]
    v_exp_f32 v138, v138
    v_mfma_f32_16x16x32_bf16 v[156:159], a[88:91], a[56:59], v[156:159]
L_pad4:
    s_cbranch_execz L_pad5
    s_waitcnt lgkmcnt(3)
    ds_read_b64_tr_b16 a[78:79], v249 offset:12544
    v_mfma_f32_16x16x32_bf16 v[156:159], a[92:95], a[60:63], v[156:159]
    v_exp_f32 v139, v139
    v_mfma_f32_16x16x32_bf16 v[0:3], a[64:67], v[208:211], v[0:3]
    ds_read_b64_tr_b16 a[80:81], v241 offset:8704
    v_cvt_pk_bf16_f32 v201, v138, v139
    v_mfma_f32_16x16x32_bf16 v[4:7], a[64:67], v[212:215], v[4:7]
    ds_read_b64_tr_b16 a[82:83], v241 offset:12800
    s_mov_b64 s[56:57], s[18:19]
    v_mfma_f32_16x16x32_bf16 v[8:11], a[64:67], v[216:219], v[8:11]
    v_exp_f32 v140, v140
    v_mfma_f32_16x16x32_bf16 v[12:15], a[64:67], v[220:223], v[12:15]
    ds_read_b64_tr_b16 a[84:85], v249 offset:8704
    buffer_load_dwordx4 v252, s[60:63], s69 offen offset:2048 lds
    v_mfma_f32_16x16x32_bf16 v[168:171], v[184:187], v[208:211], v[168:171]
    v_exp_f32 v141, v141
    v_mfma_f32_16x16x32_bf16 v[16:19], a[68:71], v[208:211], v[16:19]
    ds_read_b64_tr_b16 a[86:87], v249 offset:12800
    v_cvt_pk_bf16_f32 v204, v140, v141
    v_mfma_f32_16x16x32_bf16 v[20:23], a[68:71], v[212:215], v[20:23]
    v_exp_f32 v142, v142
    v_mfma_f32_16x16x32_bf16 v[24:27], a[68:71], v[216:219], v[24:27]
    s_waitcnt lgkmcnt(4)
    ds_read_b64_tr_b16 a[88:89], v241 offset:8960
    v_mfma_f32_16x16x32_bf16 v[28:31], a[68:71], v[220:223], v[28:31]
    v_exp_f32 v143, v143
    v_mfma_f32_16x16x32_bf16 v[32:35], a[72:75], v[208:211], v[32:35]
    ds_read_b64_tr_b16 a[90:91], v241 offset:13056
    v_cvt_pk_bf16_f32 v205, v142, v143
    v_mfma_f32_16x16x32_bf16 v[36:39], a[72:75], v[212:215], v[36:39]
    v_exp_f32 v144, v144
    v_mfma_f32_16x16x32_bf16 v[40:43], a[72:75], v[216:219], v[40:43]
    ds_read_b64_tr_b16 a[92:93], v249 offset:8960
    s_mov_b32 s58, 2752
    v_mfma_f32_16x16x32_bf16 v[44:47], a[72:75], v[220:223], v[44:47]
    v_exp_f32 v145, v145
    v_mfma_f32_16x16x32_bf16 v[172:175], v[184:187], v[212:215], v[172:175]
    ds_read_b64_tr_b16 a[94:95], v249 offset:13056
    v_cvt_pk_bf16_f32 v194, v144, v145
    v_mfma_f32_16x16x32_bf16 v[48:51], a[76:79], v[208:211], v[48:51]
    v_exp_f32 v146, v146
    v_mfma_f32_16x16x32_bf16 v[52:55], a[76:79], v[212:215], v[52:55]
    ds_read_b128 a[64:67], v240 offset:8320
    buffer_load_dwordx4 v253, s[60:63], s69 offen offset:3072 lds
    v_mfma_f32_16x16x32_bf16 v[56:59], a[76:79], v[216:219], v[56:59]
    v_exp_f32 v147, v147
    v_mfma_f32_16x16x32_bf16 v[60:63], a[76:79], v[220:223], v[60:63]
    s_waitcnt lgkmcnt(5)
    ds_read_b128 a[68:71], v240 offset:8576
    v_mfma_f32_16x16x32_bf16 v[64:67], a[80:83], v[208:211], v[64:67]
    ds_read_b128 a[72:75], v240 offset:8832
    v_cvt_pk_bf16_f32 v195, v146, v147
    v_mfma_f32_16x16x32_bf16 v[68:71], a[80:83], v[212:215], v[68:71]
    v_exp_f32 v148, v148
    v_mfma_f32_16x16x32_bf16 v[72:75], a[80:83], v[216:219], v[72:75]
    ds_read_b128 a[76:79], v240 offset:9088
    buffer_load_dword v242, v188, s[56:59], 0 offen offset:0
    v_mfma_f32_16x16x32_bf16 v[76:79], a[80:83], v[220:223], v[76:79]
    v_exp_f32 v149, v149
    v_mfma_f32_16x16x32_bf16 v[176:179], v[184:187], v[216:219], v[176:179]
    v_cvt_pk_bf16_f32 v198, v148, v149
    v_add_u32 v241, 33280, v244
    v_mfma_f32_16x16x32_bf16 v[80:83], a[84:87], v[208:211], v[80:83]
    v_exp_f32 v150, v150
    v_mfma_f32_16x16x32_bf16 v[84:87], a[84:87], v[212:215], v[84:87]
    s_mov_b64 s[56:57], s[22:23]
    v_xor_b32 v249, 32, v241
    v_mfma_f32_16x16x32_bf16 v[88:91], a[84:87], v[216:219], v[88:91]
    v_exp_f32 v151, v151
    v_mfma_f32_16x16x32_bf16 v[92:95], a[84:87], v[220:223], v[92:95]
    s_waitcnt lgkmcnt(4)
    v_cvt_pk_bf16_f32 v199, v150, v151
    v_mfma_f32_16x16x32_bf16 v[96:99], a[88:91], v[208:211], v[96:99]
    v_exp_f32 v152, v152
    v_mfma_f32_16x16x32_bf16 v[100:103], a[88:91], v[212:215], v[100:103]
    s_mov_b32 s58, 1024
    buffer_load_dword v242, v188, s[56:59], 0 offen offset:0
    v_mfma_f32_16x16x32_bf16 v[104:107], a[88:91], v[216:219], v[104:107]
    v_exp_f32 v153, v153
    v_mfma_f32_16x16x32_bf16 v[108:111], a[88:91], v[220:223], v[108:111]
    s_mov_b64 s[56:57], s[0:1]
    v_cvt_pk_bf16_f32 v202, v152, v153
    v_mfma_f32_16x16x32_bf16 v[180:183], v[184:187], v[220:223], v[180:183]
    v_exp_f32 v154, v154
    v_mfma_f32_16x16x32_bf16 v[112:115], a[92:95], v[208:211], v[112:115]
    s_mov_b32 s58, 327680
    buffer_load_dwordx4 a[152:155], v248, s[52:55], s96 offen
    v_mfma_f32_16x16x32_bf16 v[116:119], a[92:95], v[212:215], v[116:119]
    v_exp_f32 v155, v155
    v_mfma_f32_16x16x32_bf16 v[120:123], a[92:95], v[216:219], v[120:123]
    s_addk_i32 s96, 6144
    v_cvt_pk_bf16_f32 v203, v154, v155
    v_mfma_f32_16x16x32_bf16 v[124:127], a[92:95], v[220:223], v[124:127]
    s_waitcnt lgkmcnt(0)
    buffer_load_dwordx4 a[192:195], v246, s[64:67], s15 offen offset:128
    v_mfma_f32_16x16x32_bf16 v[128:131], a[64:67], a[0:3], v[224:227]
    v_exp_f32 v156, v156
    v_mfma_f32_16x16x32_bf16 v[128:131], a[68:71], a[4:7], v[128:131]
    ds_read_b128 a[80:83], v240 offset:12480
    s_add_u32 s72, s72, 176128
    v_mfma_f32_16x16x32_bf16 v[128:131], a[72:75], a[8:11], v[128:131]
    v_exp_f32 v157, v157
    v_mfma_f32_16x16x32_bf16 v[128:131], a[76:79], a[12:15], v[128:131]
    ds_read_b128 a[84:87], v240 offset:12736
    v_cvt_pk_bf16_f32 v206, v156, v157
    v_mfma_f32_16x16x32_bf16 v[132:135], a[64:67], a[16:19], v[228:231]
    v_exp_f32 v158, v158
    v_mfma_f32_16x16x32_bf16 v[132:135], a[68:71], a[20:23], v[132:135]
    ds_read_b128 a[88:91], v240 offset:12992
    s_or_b32 s15, s14, s72
    v_mfma_f32_16x16x32_bf16 v[132:135], a[72:75], a[24:27], v[132:135]
    v_exp_f32 v159, v159
    v_mfma_f32_16x16x32_bf16 v[132:135], a[76:79], a[28:31], v[132:135]
    ds_read_b128 a[92:95], v240 offset:13248
    v_cvt_pk_bf16_f32 v207, v158, v159
    v_mfma_f32_16x16x32_bf16 v[136:139], a[64:67], a[32:35], v[232:235]
    v_exp_f32 v128, v128
    v_mfma_f32_16x16x32_bf16 v[136:139], a[68:71], a[36:39], v[136:139]
    v_mfma_f32_16x16x32_bf16 v[136:139], a[72:75], a[40:43], v[136:139]
    v_exp_f32 v129, v129
    v_mfma_f32_16x16x32_bf16 v[136:139], a[76:79], a[44:47], v[136:139]
    v_cvt_pk_bf16_f32 v208, v128, v129
    v_add_u32 v240, 66560, v243
    v_mfma_f32_16x16x32_bf16 v[140:143], a[64:67], a[48:51], v[236:239]
    v_exp_f32 v130, v130
    v_mfma_f32_16x16x32_bf16 v[140:143], a[68:71], a[52:55], v[140:143]
    v_mfma_f32_16x16x32_bf16 v[140:143], a[72:75], a[56:59], v[140:143]
    v_exp_f32 v131, v131
    v_mfma_f32_16x16x32_bf16 v[140:143], a[76:79], a[60:63], v[140:143]
    s_waitcnt lgkmcnt(0)
    v_cvt_pk_bf16_f32 v209, v130, v131
    v_mfma_f32_16x16x32_bf16 v[144:147], a[80:83], a[0:3], v[224:227]
    ds_read_b64_tr_b16 a[64:65], v241 offset:0
    buffer_load_dwordx4 a[156:159], v248, s[52:55], s96 offen
    v_mfma_f32_16x16x32_bf16 v[144:147], a[84:87], a[4:7], v[144:147]
    v_exp_f32 v132, v132
    v_mfma_f32_16x16x32_bf16 v[144:147], a[88:91], a[8:11], v[144:147]
    ds_read_b64_tr_b16 a[66:67], v241 offset:4096
    s_addk_i32 s96, 6144
    v_mfma_f32_16x16x32_bf16 v[144:147], a[92:95], a[12:15], v[144:147]
    v_exp_f32 v133, v133
    v_mfma_f32_16x16x32_bf16 v[148:151], a[80:83], a[16:19], v[228:231]
    ds_read_b64_tr_b16 a[68:69], v249 offset:0
    v_cvt_pk_bf16_f32 v212, v132, v133
    v_mfma_f32_16x16x32_bf16 v[148:151], a[84:87], a[20:23], v[148:151]
    v_exp_f32 v134, v134
    v_mfma_f32_16x16x32_bf16 v[148:151], a[88:91], a[24:27], v[148:151]
    ds_read_b64_tr_b16 a[70:71], v249 offset:4096
    buffer_load_dwordx4 a[196:199], v246, s[64:67], s72 offen offset:0
    v_mfma_f32_16x16x32_bf16 v[148:151], a[92:95], a[28:31], v[148:151]
    v_exp_f32 v135, v135
    v_mfma_f32_16x16x32_bf16 v[152:155], a[80:83], a[32:35], v[232:235]
    ds_read_b64_tr_b16 a[72:73], v241 offset:256
    v_cvt_pk_bf16_f32 v213, v134, v135
    v_mfma_f32_16x16x32_bf16 v[152:155], a[84:87], a[36:39], v[152:155]
    v_exp_f32 v136, v136
    v_mfma_f32_16x16x32_bf16 v[152:155], a[88:91], a[40:43], v[152:155]
    ds_read_b64_tr_b16 a[74:75], v241 offset:4352
    v_mfma_f32_16x16x32_bf16 v[152:155], a[92:95], a[44:47], v[152:155]
    v_exp_f32 v137, v137
    v_mfma_f32_16x16x32_bf16 v[156:159], a[80:83], a[48:51], v[236:239]
    ds_read_b64_tr_b16 a[76:77], v249 offset:256
    v_cvt_pk_bf16_f32 v216, v136, v137
    v_mfma_f32_16x16x32_bf16 v[156:159], a[84:87], a[52:55], v[156:159]
    v_exp_f32 v138, v138
    v_mfma_f32_16x16x32_bf16 v[156:159], a[88:91], a[56:59], v[156:159]
    s_waitcnt lgkmcnt(3)
    ds_read_b64_tr_b16 a[78:79], v249 offset:4352
    v_mfma_f32_16x16x32_bf16 v[156:159], a[92:95], a[60:63], v[156:159]
    v_exp_f32 v139, v139
    v_mfma_f32_16x16x32_bf16 v[0:3], a[64:67], v[192:195], v[0:3]
    ds_read_b64_tr_b16 a[80:81], v241 offset:512
    v_cvt_pk_bf16_f32 v217, v138, v139
    v_mfma_f32_16x16x32_bf16 v[4:7], a[64:67], v[196:199], v[4:7]
    ds_read_b64_tr_b16 a[82:83], v241 offset:4608
    v_mfma_f32_16x16x32_bf16 v[8:11], a[64:67], v[200:203], v[8:11]
    v_exp_f32 v140, v140
    v_mfma_f32_16x16x32_bf16 v[12:15], a[64:67], v[204:207], v[12:15]
    ds_read_b64_tr_b16 a[84:85], v249 offset:512
    buffer_load_dwordx4 a[160:163], v248, s[52:55], s96 offen
    s_addk_i32 s96, 6144
    v_mfma_f32_16x16x32_bf16 v[168:171], v[184:187], v[192:195], v[168:171]
    v_exp_f32 v141, v141
    v_mfma_f32_16x16x32_bf16 v[16:19], a[68:71], v[192:195], v[16:19]
    ds_read_b64_tr_b16 a[86:87], v249 offset:4608
    v_cvt_pk_bf16_f32 v220, v140, v141
    v_mfma_f32_16x16x32_bf16 v[20:23], a[68:71], v[196:199], v[20:23]
    v_exp_f32 v142, v142
    v_mfma_f32_16x16x32_bf16 v[24:27], a[68:71], v[200:203], v[24:27]
    s_waitcnt lgkmcnt(4)
    ds_read_b64_tr_b16 a[88:89], v241 offset:768
    v_mfma_f32_16x16x32_bf16 v[28:31], a[68:71], v[204:207], v[28:31]
    v_exp_f32 v143, v143
    v_mfma_f32_16x16x32_bf16 v[32:35], a[72:75], v[192:195], v[32:35]
    ds_read_b64_tr_b16 a[90:91], v241 offset:4864
    buffer_load_dwordx4 a[164:167], v248, s[52:55], s96 offen
    s_addk_i32 s96, 6144
    buffer_load_dwordx4 a[168:171], v248, s[52:55], s96 offen
    s_addk_i32 s96, 6144
    buffer_load_dwordx4 a[200:203], v246, s[64:67], s15 offen offset:64
    buffer_load_dwordx4 a[204:207], v246, s[64:67], s15 offen offset:128
    s_add_u32 s72, s72, 176128
    s_or_b32 s15, s14, s72
    v_cvt_pk_bf16_f32 v221, v142, v143
    v_mfma_f32_16x16x32_bf16 v[36:39], a[72:75], v[196:199], v[36:39]
    v_exp_f32 v144, v144
    v_mfma_f32_16x16x32_bf16 v[40:43], a[72:75], v[200:203], v[40:43]
    ds_read_b64_tr_b16 a[92:93], v249 offset:768
    v_mfma_f32_16x16x32_bf16 v[44:47], a[72:75], v[204:207], v[44:47]
    v_exp_f32 v145, v145
    v_mfma_f32_16x16x32_bf16 v[172:175], v[184:187], v[196:199], v[172:175]
    ds_read_b64_tr_b16 a[94:95], v249 offset:4864
    v_cvt_pk_bf16_f32 v210, v144, v145
    v_mfma_f32_16x16x32_bf16 v[48:51], a[76:79], v[192:195], v[48:51]
    v_exp_f32 v146, v146
    v_mfma_f32_16x16x32_bf16 v[52:55], a[76:79], v[196:199], v[52:55]
    v_mfma_f32_16x16x32_bf16 v[56:59], a[76:79], v[200:203], v[56:59]
    v_exp_f32 v147, v147
    v_mfma_f32_16x16x32_bf16 v[60:63], a[76:79], v[204:207], v[60:63]
    s_waitcnt lgkmcnt(4)
    s_waitcnt vmcnt(36)
    s_barrier
    v_mfma_f32_16x16x32_bf16 v[64:67], a[80:83], v[192:195], v[64:67]
    ds_read_b128 a[64:67], v240 offset:0
    v_cvt_pk_bf16_f32 v211, v146, v147
    v_mfma_f32_16x16x32_bf16 v[68:71], a[80:83], v[196:199], v[68:71]
    v_exp_f32 v148, v148
    v_mfma_f32_16x16x32_bf16 v[72:75], a[80:83], v[200:203], v[72:75]
    ds_read_b128 a[68:71], v240 offset:256
    v_mfma_f32_16x16x32_bf16 v[76:79], a[80:83], v[204:207], v[76:79]
    v_exp_f32 v149, v149
    v_mfma_f32_16x16x32_bf16 v[176:179], v[184:187], v[200:203], v[176:179]
    ds_read_b128 a[72:75], v240 offset:512
    v_cvt_pk_bf16_f32 v214, v148, v149
    v_mfma_f32_16x16x32_bf16 v[80:83], a[84:87], v[192:195], v[80:83]
    v_exp_f32 v150, v150
    v_mfma_f32_16x16x32_bf16 v[84:87], a[84:87], v[196:199], v[84:87]
    ds_read_b128 a[76:79], v240 offset:768
    v_mfma_f32_16x16x32_bf16 v[88:91], a[84:87], v[200:203], v[88:91]
    v_exp_f32 v151, v151
    v_mfma_f32_16x16x32_bf16 v[92:95], a[84:87], v[204:207], v[92:95]
    s_waitcnt lgkmcnt(4)
    v_cvt_pk_bf16_f32 v215, v150, v151
    v_mfma_f32_16x16x32_bf16 v[96:99], a[88:91], v[192:195], v[96:99]
    v_exp_f32 v152, v152
    v_mfma_f32_16x16x32_bf16 v[100:103], a[88:91], v[196:199], v[100:103]
    s_cmp_eq_u32 s37, 1
    s_cselect_b32 s79, 262144, s71
    v_mfma_f32_16x16x32_bf16 v[104:107], a[88:91], v[200:203], v[104:107]
    v_exp_f32 v153, v153
    v_mfma_f32_16x16x32_bf16 v[108:111], a[88:91], v[204:207], v[108:111]
    s_add_u32 s69, s69, s79
    v_cvt_pk_bf16_f32 v218, v152, v153
    v_mfma_f32_16x16x32_bf16 v[180:183], v[184:187], v[204:207], v[180:183]
    v_exp_f32 v154, v154
    v_mfma_f32_16x16x32_bf16 v[112:115], a[92:95], v[192:195], v[112:115]
    s_add_u32 m0, s39, 0
    v_mfma_f32_16x16x32_bf16 v[116:119], a[92:95], v[196:199], v[116:119]
    v_exp_f32 v155, v155
    v_mfma_f32_16x16x32_bf16 v[120:123], a[92:95], v[200:203], v[120:123]
    buffer_load_dwordx4 v255, s[60:63], s69 offen offset:0 lds
    v_cvt_pk_bf16_f32 v219, v154, v155
    v_mfma_f32_16x16x32_bf16 v[124:127], a[92:95], v[204:207], v[124:127]
    s_waitcnt lgkmcnt(0)
    v_mfma_f32_16x16x32_bf16 v[128:131], a[64:67], a[0:3], v[224:227]
    v_exp_f32 v156, v156
    v_mfma_f32_16x16x32_bf16 v[128:131], a[68:71], a[4:7], v[128:131]
    ds_read_b128 a[80:83], v240 offset:4160
    v_mfma_f32_16x16x32_bf16 v[128:131], a[72:75], a[8:11], v[128:131]
    v_exp_f32 v157, v157
    v_mfma_f32_16x16x32_bf16 v[128:131], a[76:79], a[12:15], v[128:131]
    ds_read_b128 a[84:87], v240 offset:4416
    v_cvt_pk_bf16_f32 v222, v156, v157
    v_mfma_f32_16x16x32_bf16 v[132:135], a[64:67], a[16:19], v[228:231]
    v_exp_f32 v158, v158
    v_mfma_f32_16x16x32_bf16 v[132:135], a[68:71], a[20:23], v[132:135]
    ds_read_b128 a[88:91], v240 offset:4672
    v_mfma_f32_16x16x32_bf16 v[132:135], a[72:75], a[24:27], v[132:135]
    v_exp_f32 v159, v159
    v_mfma_f32_16x16x32_bf16 v[132:135], a[76:79], a[28:31], v[132:135]
    ds_read_b128 a[92:95], v240 offset:4928
    v_cvt_pk_bf16_f32 v223, v158, v159
    v_mfma_f32_16x16x32_bf16 v[136:139], a[64:67], a[32:35], v[232:235]
    v_exp_f32 v128, v128
    v_mfma_f32_16x16x32_bf16 v[136:139], a[68:71], a[36:39], v[136:139]
    buffer_load_dwordx4 v251, s[60:63], s69 offen offset:1024 lds
    v_mfma_f32_16x16x32_bf16 v[136:139], a[72:75], a[40:43], v[136:139]
    v_exp_f32 v129, v129
    v_mfma_f32_16x16x32_bf16 v[136:139], a[76:79], a[44:47], v[136:139]
    buffer_load_dwordx4 a[172:175], v248, s[52:55], s96 offen
    v_cvt_pk_bf16_f32 v192, v128, v129
    v_mfma_f32_16x16x32_bf16 v[140:143], a[64:67], a[48:51], v[236:239]
    v_exp_f32 v130, v130
    v_mfma_f32_16x16x32_bf16 v[140:143], a[68:71], a[52:55], v[140:143]
    s_addk_i32 s96, 6144
    v_mfma_f32_16x16x32_bf16 v[140:143], a[72:75], a[56:59], v[140:143]
    v_exp_f32 v131, v131
    v_mfma_f32_16x16x32_bf16 v[140:143], a[76:79], a[60:63], v[140:143]
    s_waitcnt lgkmcnt(0)
    v_cvt_pk_bf16_f32 v193, v130, v131
    v_mfma_f32_16x16x32_bf16 v[144:147], a[80:83], a[0:3], v[224:227]
    ds_read_b64_tr_b16 a[64:65], v241 offset:8192
    buffer_load_dwordx4 a[208:211], v246, s[64:67], s72 offen offset:0
    v_mfma_f32_16x16x32_bf16 v[144:147], a[84:87], a[4:7], v[144:147]
    v_exp_f32 v132, v132
    v_mfma_f32_16x16x32_bf16 v[144:147], a[88:91], a[8:11], v[144:147]
    ds_read_b64_tr_b16 a[66:67], v241 offset:12288
    buffer_load_dwordx4 v252, s[60:63], s69 offen offset:2048 lds
    v_mfma_f32_16x16x32_bf16 v[144:147], a[92:95], a[12:15], v[144:147]
    v_exp_f32 v133, v133
    v_mfma_f32_16x16x32_bf16 v[148:151], a[80:83], a[16:19], v[228:231]
    ds_read_b64_tr_b16 a[68:69], v249 offset:8192
    v_cvt_pk_bf16_f32 v196, v132, v133
    v_mfma_f32_16x16x32_bf16 v[148:151], a[84:87], a[20:23], v[148:151]
    v_exp_f32 v134, v134
    v_mfma_f32_16x16x32_bf16 v[148:151], a[88:91], a[24:27], v[148:151]
    ds_read_b64_tr_b16 a[70:71], v249 offset:12288
    v_mfma_f32_16x16x32_bf16 v[148:151], a[92:95], a[28:31], v[148:151]
    v_exp_f32 v135, v135
    v_mfma_f32_16x16x32_bf16 v[152:155], a[80:83], a[32:35], v[232:235]
    ds_read_b64_tr_b16 a[72:73], v241 offset:8448
    v_cvt_pk_bf16_f32 v197, v134, v135
    v_mfma_f32_16x16x32_bf16 v[152:155], a[84:87], a[36:39], v[152:155]
    v_exp_f32 v136, v136
    v_mfma_f32_16x16x32_bf16 v[152:155], a[88:91], a[40:43], v[152:155]
    ds_read_b64_tr_b16 a[74:75], v241 offset:12544
    v_mfma_f32_16x16x32_bf16 v[152:155], a[92:95], a[44:47], v[152:155]
    v_exp_f32 v137, v137
    v_mfma_f32_16x16x32_bf16 v[156:159], a[80:83], a[48:51], v[236:239]
    ds_read_b64_tr_b16 a[76:77], v249 offset:8448
    v_cvt_pk_bf16_f32 v200, v136, v137
    v_mfma_f32_16x16x32_bf16 v[156:159], a[84:87], a[52:55], v[156:159]
    v_exp_f32 v138, v138
    v_mfma_f32_16x16x32_bf16 v[156:159], a[88:91], a[56:59], v[156:159]
    s_waitcnt lgkmcnt(3)
    ds_read_b64_tr_b16 a[78:79], v249 offset:12544
    v_mfma_f32_16x16x32_bf16 v[156:159], a[92:95], a[60:63], v[156:159]
    v_exp_f32 v139, v139
    v_mfma_f32_16x16x32_bf16 v[0:3], a[64:67], v[208:211], v[0:3]
    ds_read_b64_tr_b16 a[80:81], v241 offset:8704
    v_cvt_pk_bf16_f32 v201, v138, v139
    v_mfma_f32_16x16x32_bf16 v[4:7], a[64:67], v[212:215], v[4:7]
    ds_read_b64_tr_b16 a[82:83], v241 offset:12800
    buffer_load_dwordx4 v253, s[60:63], s69 offen offset:3072 lds
    v_mfma_f32_16x16x32_bf16 v[8:11], a[64:67], v[216:219], v[8:11]
    v_exp_f32 v140, v140
    v_mfma_f32_16x16x32_bf16 v[12:15], a[64:67], v[220:223], v[12:15]
    ds_read_b64_tr_b16 a[84:85], v249 offset:8704
    buffer_load_dwordx4 a[176:179], v248, s[52:55], s96 offen
    v_mfma_f32_16x16x32_bf16 v[168:171], v[184:187], v[208:211], v[168:171]
    v_exp_f32 v141, v141
    v_mfma_f32_16x16x32_bf16 v[16:19], a[68:71], v[208:211], v[16:19]
    ds_read_b64_tr_b16 a[86:87], v249 offset:12800
    v_cvt_pk_bf16_f32 v204, v140, v141
    v_mfma_f32_16x16x32_bf16 v[20:23], a[68:71], v[212:215], v[20:23]
    v_exp_f32 v142, v142
    v_mfma_f32_16x16x32_bf16 v[24:27], a[68:71], v[216:219], v[24:27]
    s_waitcnt lgkmcnt(4)
    ds_read_b64_tr_b16 a[88:89], v241 offset:8960
    v_mfma_f32_16x16x32_bf16 v[28:31], a[68:71], v[220:223], v[28:31]
    v_exp_f32 v143, v143
    v_mfma_f32_16x16x32_bf16 v[32:35], a[72:75], v[208:211], v[32:35]
    ds_read_b64_tr_b16 a[90:91], v241 offset:13056
    v_cvt_pk_bf16_f32 v205, v142, v143
    v_mfma_f32_16x16x32_bf16 v[36:39], a[72:75], v[212:215], v[36:39]
    v_exp_f32 v144, v144
    v_mfma_f32_16x16x32_bf16 v[40:43], a[72:75], v[216:219], v[40:43]
    ds_read_b64_tr_b16 a[92:93], v249 offset:8960
    s_addk_i32 s96, 6144
    v_mfma_f32_16x16x32_bf16 v[44:47], a[72:75], v[220:223], v[44:47]
    v_exp_f32 v145, v145
    v_mfma_f32_16x16x32_bf16 v[172:175], v[184:187], v[212:215], v[172:175]
    ds_read_b64_tr_b16 a[94:95], v249 offset:13056
    v_cvt_pk_bf16_f32 v194, v144, v145
    v_mfma_f32_16x16x32_bf16 v[48:51], a[76:79], v[208:211], v[48:51]
    v_exp_f32 v146, v146
    v_mfma_f32_16x16x32_bf16 v[52:55], a[76:79], v[212:215], v[52:55]
    ds_read_b128 a[64:67], v240 offset:8320
    buffer_load_dwordx4 a[212:215], v246, s[64:67], s15 offen offset:64
    v_mfma_f32_16x16x32_bf16 v[56:59], a[76:79], v[216:219], v[56:59]
    v_exp_f32 v147, v147
    v_mfma_f32_16x16x32_bf16 v[60:63], a[76:79], v[220:223], v[60:63]
    s_waitcnt lgkmcnt(5)
    ds_read_b128 a[68:71], v240 offset:8576
    v_mfma_f32_16x16x32_bf16 v[64:67], a[80:83], v[208:211], v[64:67]
    ds_read_b128 a[72:75], v240 offset:8832
    v_cvt_pk_bf16_f32 v195, v146, v147
    v_mfma_f32_16x16x32_bf16 v[68:71], a[80:83], v[212:215], v[68:71]
    v_exp_f32 v148, v148
    v_mfma_f32_16x16x32_bf16 v[72:75], a[80:83], v[216:219], v[72:75]
    ds_read_b128 a[76:79], v240 offset:9088
    v_mfma_f32_16x16x32_bf16 v[76:79], a[80:83], v[220:223], v[76:79]
    v_exp_f32 v149, v149
    v_mfma_f32_16x16x32_bf16 v[176:179], v[184:187], v[216:219], v[176:179]
    v_cvt_pk_bf16_f32 v198, v148, v149
    v_add_u32 v241, 66560, v244
    v_mfma_f32_16x16x32_bf16 v[80:83], a[84:87], v[208:211], v[80:83]
    v_exp_f32 v150, v150
    v_mfma_f32_16x16x32_bf16 v[84:87], a[84:87], v[212:215], v[84:87]
    buffer_load_dwordx4 a[180:183], v248, s[52:55], s96 offen
    v_xor_b32 v249, 32, v241
    v_mfma_f32_16x16x32_bf16 v[88:91], a[84:87], v[216:219], v[88:91]
    v_exp_f32 v151, v151
    v_mfma_f32_16x16x32_bf16 v[92:95], a[84:87], v[220:223], v[92:95]
    s_waitcnt lgkmcnt(4)
    v_cvt_pk_bf16_f32 v199, v150, v151
    v_mfma_f32_16x16x32_bf16 v[96:99], a[88:91], v[208:211], v[96:99]
    v_exp_f32 v152, v152
    v_mfma_f32_16x16x32_bf16 v[100:103], a[88:91], v[212:215], v[100:103]
    s_cmp_eq_u32 s37, 2
    s_cselect_b32 s79, 262144, s71
    v_mfma_f32_16x16x32_bf16 v[104:107], a[88:91], v[216:219], v[104:107]
    v_exp_f32 v153, v153
    v_mfma_f32_16x16x32_bf16 v[108:111], a[88:91], v[220:223], v[108:111]
    s_add_u32 s69, s69, s79
    v_cvt_pk_bf16_f32 v202, v152, v153
    v_mfma_f32_16x16x32_bf16 v[180:183], v[184:187], v[220:223], v[180:183]
    v_exp_f32 v154, v154
    v_mfma_f32_16x16x32_bf16 v[112:115], a[92:95], v[208:211], v[112:115]
    s_add_u32 m0, s39, 16640
    s_addk_i32 s96, 6144
    v_mfma_f32_16x16x32_bf16 v[116:119], a[92:95], v[212:215], v[116:119]
    v_exp_f32 v155, v155
    v_mfma_f32_16x16x32_bf16 v[120:123], a[92:95], v[216:219], v[120:123]
    buffer_load_dwordx4 v255, s[60:63], s69 offen offset:0 lds
    v_cvt_pk_bf16_f32 v203, v154, v155
    v_mfma_f32_16x16x32_bf16 v[124:127], a[92:95], v[220:223], v[124:127]
    s_waitcnt lgkmcnt(0)
    buffer_load_dwordx4 a[216:219], v246, s[64:67], s15 offen offset:128
    v_mfma_f32_16x16x32_bf16 v[128:131], a[64:67], a[0:3], v[224:227]
    v_exp_f32 v156, v156
    v_mfma_f32_16x16x32_bf16 v[128:131], a[68:71], a[4:7], v[128:131]
    ds_read_b128 a[80:83], v240 offset:12480
    s_add_u32 s72, s72, 176128
    v_mfma_f32_16x16x32_bf16 v[128:131], a[72:75], a[8:11], v[128:131]
    v_exp_f32 v157, v157
    v_mfma_f32_16x16x32_bf16 v[128:131], a[76:79], a[12:15], v[128:131]
    ds_read_b128 a[84:87], v240 offset:12736
    v_cvt_pk_bf16_f32 v206, v156, v157
    v_mfma_f32_16x16x32_bf16 v[132:135], a[64:67], a[16:19], v[228:231]
    v_exp_f32 v158, v158
    v_mfma_f32_16x16x32_bf16 v[132:135], a[68:71], a[20:23], v[132:135]
    ds_read_b128 a[88:91], v240 offset:12992
    s_or_b32 s15, s14, s72
    v_mfma_f32_16x16x32_bf16 v[132:135], a[72:75], a[24:27], v[132:135]
    v_exp_f32 v159, v159
    v_mfma_f32_16x16x32_bf16 v[132:135], a[76:79], a[28:31], v[132:135]
    ds_read_b128 a[92:95], v240 offset:13248
    v_cvt_pk_bf16_f32 v207, v158, v159
    v_mfma_f32_16x16x32_bf16 v[136:139], a[64:67], a[32:35], v[232:235]
    v_exp_f32 v128, v128
    v_mfma_f32_16x16x32_bf16 v[136:139], a[68:71], a[36:39], v[136:139]
    buffer_load_dwordx4 v251, s[60:63], s69 offen offset:1024 lds
    buffer_load_dwordx4 a[184:187], v248, s[52:55], s96 offen
    v_mfma_f32_16x16x32_bf16 v[136:139], a[72:75], a[40:43], v[136:139]
    v_exp_f32 v129, v129
    v_mfma_f32_16x16x32_bf16 v[136:139], a[76:79], a[44:47], v[136:139]
    v_cvt_pk_bf16_f32 v208, v128, v129
    v_add_u32 v240, 99840, v243
    v_mfma_f32_16x16x32_bf16 v[140:143], a[64:67], a[48:51], v[236:239]
    v_exp_f32 v130, v130
    v_mfma_f32_16x16x32_bf16 v[140:143], a[68:71], a[52:55], v[140:143]
    s_addk_i32 s96, 6144
    v_mfma_f32_16x16x32_bf16 v[140:143], a[72:75], a[56:59], v[140:143]
    v_exp_f32 v131, v131
    v_mfma_f32_16x16x32_bf16 v[140:143], a[76:79], a[60:63], v[140:143]
    s_waitcnt lgkmcnt(0)
    v_cvt_pk_bf16_f32 v209, v130, v131
    v_mfma_f32_16x16x32_bf16 v[144:147], a[80:83], a[0:3], v[224:227]
    ds_read_b64_tr_b16 a[64:65], v241 offset:0
    v_mfma_f32_16x16x32_bf16 v[144:147], a[84:87], a[4:7], v[144:147]
    v_exp_f32 v132, v132
    v_mfma_f32_16x16x32_bf16 v[144:147], a[88:91], a[8:11], v[144:147]
    ds_read_b64_tr_b16 a[66:67], v241 offset:4096
    buffer_load_dwordx4 v252, s[60:63], s69 offen offset:2048 lds
    v_mfma_f32_16x16x32_bf16 v[144:147], a[92:95], a[12:15], v[144:147]
    v_exp_f32 v133, v133
    v_mfma_f32_16x16x32_bf16 v[148:151], a[80:83], a[16:19], v[228:231]
    ds_read_b64_tr_b16 a[68:69], v249 offset:0
    v_cvt_pk_bf16_f32 v212, v132, v133
    v_mfma_f32_16x16x32_bf16 v[148:151], a[84:87], a[20:23], v[148:151]
    v_exp_f32 v134, v134
    v_mfma_f32_16x16x32_bf16 v[148:151], a[88:91], a[24:27], v[148:151]
    ds_read_b64_tr_b16 a[70:71], v249 offset:4096
    buffer_load_dwordx4 a[220:223], v246, s[64:67], s72 offen offset:0
    v_mfma_f32_16x16x32_bf16 v[148:151], a[92:95], a[28:31], v[148:151]
    v_exp_f32 v135, v135
    v_mfma_f32_16x16x32_bf16 v[152:155], a[80:83], a[32:35], v[232:235]
    ds_read_b64_tr_b16 a[72:73], v241 offset:256
    v_cvt_pk_bf16_f32 v213, v134, v135
    v_mfma_f32_16x16x32_bf16 v[152:155], a[84:87], a[36:39], v[152:155]
    v_exp_f32 v136, v136
    v_mfma_f32_16x16x32_bf16 v[152:155], a[88:91], a[40:43], v[152:155]
    ds_read_b64_tr_b16 a[74:75], v241 offset:4352
    v_mfma_f32_16x16x32_bf16 v[152:155], a[92:95], a[44:47], v[152:155]
    v_exp_f32 v137, v137
    v_mfma_f32_16x16x32_bf16 v[156:159], a[80:83], a[48:51], v[236:239]
    ds_read_b64_tr_b16 a[76:77], v249 offset:256
    v_cvt_pk_bf16_f32 v216, v136, v137
    v_mfma_f32_16x16x32_bf16 v[156:159], a[84:87], a[52:55], v[156:159]
    v_exp_f32 v138, v138
    v_mfma_f32_16x16x32_bf16 v[156:159], a[88:91], a[56:59], v[156:159]
    s_waitcnt lgkmcnt(3)
    ds_read_b64_tr_b16 a[78:79], v249 offset:4352
    v_mfma_f32_16x16x32_bf16 v[156:159], a[92:95], a[60:63], v[156:159]
    v_exp_f32 v139, v139
    v_mfma_f32_16x16x32_bf16 v[0:3], a[64:67], v[192:195], v[0:3]
    ds_read_b64_tr_b16 a[80:81], v241 offset:512
    v_cvt_pk_bf16_f32 v217, v138, v139
    v_mfma_f32_16x16x32_bf16 v[4:7], a[64:67], v[196:199], v[4:7]
    ds_read_b64_tr_b16 a[82:83], v241 offset:4608
    buffer_load_dwordx4 v253, s[60:63], s69 offen offset:3072 lds
    v_mfma_f32_16x16x32_bf16 v[8:11], a[64:67], v[200:203], v[8:11]
    v_exp_f32 v140, v140
    v_mfma_f32_16x16x32_bf16 v[12:15], a[64:67], v[204:207], v[12:15]
    ds_read_b64_tr_b16 a[84:85], v249 offset:512
    buffer_load_dwordx4 a[188:191], v248, s[52:55], s96 offen
    v_mfma_f32_16x16x32_bf16 v[168:171], v[184:187], v[192:195], v[168:171]
    v_exp_f32 v141, v141
    v_mfma_f32_16x16x32_bf16 v[16:19], a[68:71], v[192:195], v[16:19]
    ds_read_b64_tr_b16 a[86:87], v249 offset:4608
    v_cvt_pk_bf16_f32 v220, v140, v141
    v_mfma_f32_16x16x32_bf16 v[20:23], a[68:71], v[196:199], v[20:23]
    v_exp_f32 v142, v142
    v_mfma_f32_16x16x32_bf16 v[24:27], a[68:71], v[200:203], v[24:27]
    s_waitcnt lgkmcnt(4)
    ds_read_b64_tr_b16 a[88:89], v241 offset:768
    v_mfma_f32_16x16x32_bf16 v[28:31], a[68:71], v[204:207], v[28:31]
    buffer_load_dwordx4 a[224:227], v246, s[64:67], s15 offen offset:64
    v_exp_f32 v143, v143
    v_mfma_f32_16x16x32_bf16 v[32:35], a[72:75], v[192:195], v[32:35]
    ds_read_b64_tr_b16 a[90:91], v241 offset:4864
    v_cvt_pk_bf16_f32 v221, v142, v143
    v_mfma_f32_16x16x32_bf16 v[36:39], a[72:75], v[196:199], v[36:39]
    v_exp_f32 v144, v144
    v_mfma_f32_16x16x32_bf16 v[40:43], a[72:75], v[200:203], v[40:43]
    ds_read_b64_tr_b16 a[92:93], v249 offset:768
    s_waitcnt vmcnt(27)
    s_lshr_b32 s96, s2, 3
    s_lshl_b32 s97, s34, 5
    s_add_u32 s96, s96, s97
    s_sub_u32 s96, s96, 64
    s_cmp_lt_u32 s96, (L_end-L_tail+8191)/8192
    s_cbranch_scc0 L_nocode3
    s_lshl_b32 s96, s96, 13
    v_lshl_add_u32 v247, v254, 3, s96
    v_min_u32 v247, L_end-L_tail-4, v247
    s_getpc_b64 s[96:97]
L_pc3:
    s_add_u32 s96, s96, (L_tail-L_pc3)&0xffffffff
    s_addc_u32 s97, s97, (L_tail-L_pc3)>>32
    global_load_dword v247, v247, s[96:97]
L_nocode3:
    v_mfma_f32_16x16x32_bf16 v[44:47], a[72:75], v[204:207], v[44:47]
    v_exp_f32 v145, v145
    v_mfma_f32_16x16x32_bf16 v[172:175], v[184:187], v[196:199], v[172:175]
    ds_read_b64_tr_b16 a[94:95], v249 offset:4864
    v_cvt_pk_bf16_f32 v210, v144, v145
    v_mfma_f32_16x16x32_bf16 v[48:51], a[76:79], v[192:195], v[48:51]
    v_exp_f32 v146, v146
    v_mfma_f32_16x16x32_bf16 v[52:55], a[76:79], v[196:199], v[52:55]
    v_mfma_f32_16x16x32_bf16 v[56:59], a[76:79], v[200:203], v[56:59]
    v_exp_f32 v147, v147
    v_mfma_f32_16x16x32_bf16 v[60:63], a[76:79], v[204:207], v[60:63]
    s_waitcnt lgkmcnt(4)
    s_barrier
    v_mfma_f32_16x16x32_bf16 v[64:67], a[80:83], v[192:195], v[64:67]
    ds_read_b128 a[64:67], v240 offset:0
    v_cvt_pk_bf16_f32 v211, v146, v147
    v_mfma_f32_16x16x32_bf16 v[68:71], a[80:83], v[196:199], v[68:71]
    v_exp_f32 v148, v148
    v_mfma_f32_16x16x32_bf16 v[72:75], a[80:83], v[200:203], v[72:75]
    ds_read_b128 a[68:71], v240 offset:256
    v_mfma_f32_16x16x32_bf16 v[76:79], a[80:83], v[204:207], v[76:79]
    v_exp_f32 v149, v149
    v_mfma_f32_16x16x32_bf16 v[176:179], v[184:187], v[200:203], v[176:179]
    ds_read_b128 a[72:75], v240 offset:512
    v_cvt_pk_bf16_f32 v214, v148, v149
    v_mfma_f32_16x16x32_bf16 v[80:83], a[84:87], v[192:195], v[80:83]
    v_exp_f32 v150, v150
    v_mfma_f32_16x16x32_bf16 v[84:87], a[84:87], v[196:199], v[84:87]
    ds_read_b128 a[76:79], v240 offset:768
    v_mfma_f32_16x16x32_bf16 v[88:91], a[84:87], v[200:203], v[88:91]
    v_exp_f32 v151, v151
    v_mfma_f32_16x16x32_bf16 v[92:95], a[84:87], v[204:207], v[92:95]
    s_waitcnt lgkmcnt(4)
    v_cvt_pk_bf16_f32 v215, v150, v151
    v_mfma_f32_16x16x32_bf16 v[96:99], a[88:91], v[192:195], v[96:99]
    v_exp_f32 v152, v152
    v_mfma_f32_16x16x32_bf16 v[100:103], a[88:91], v[196:199], v[100:103]
    s_cmp_eq_u32 s37, 3
    s_cselect_b32 s79, 262144, s71
    v_mfma_f32_16x16x32_bf16 v[104:107], a[88:91], v[200:203], v[104:107]
    v_exp_f32 v153, v153
    v_mfma_f32_16x16x32_bf16 v[108:111], a[88:91], v[204:207], v[108:111]
    s_add_u32 s69, s69, s79
L_pad5:
    s_cbranch_execz L_warmed1
    v_cvt_pk_bf16_f32 v218, v152, v153
    v_mfma_f32_16x16x32_bf16 v[180:183], v[184:187], v[204:207], v[180:183]
    v_exp_f32 v154, v154
    v_mfma_f32_16x16x32_bf16 v[112:115], a[92:95], v[192:195], v[112:115]
    s_add_u32 m0, s39, 33280
    v_mfma_f32_16x16x32_bf16 v[116:119], a[92:95], v[196:199], v[116:119]
    v_exp_f32 v155, v155
    v_mfma_f32_16x16x32_bf16 v[120:123], a[92:95], v[200:203], v[120:123]
    buffer_load_dwordx4 v255, s[60:63], s69 offen offset:0 lds
    v_cvt_pk_bf16_f32 v219, v154, v155
    v_mfma_f32_16x16x32_bf16 v[124:127], a[92:95], v[204:207], v[124:127]
    s_waitcnt lgkmcnt(0)
    v_mfma_f32_16x16x32_bf16 v[128:131], a[64:67], a[0:3], v[224:227]
    v_exp_f32 v156, v156
    v_mfma_f32_16x16x32_bf16 v[128:131], a[68:71], a[4:7], v[128:131]
    ds_read_b128 a[80:83], v240 offset:4160
    v_mfma_f32_16x16x32_bf16 v[128:131], a[72:75], a[8:11], v[128:131]
    v_exp_f32 v157, v157
    v_mfma_f32_16x16x32_bf16 v[128:131], a[76:79], a[12:15], v[128:131]
    ds_read_b128 a[84:87], v240 offset:4416
    v_cvt_pk_bf16_f32 v222, v156, v157
    v_mfma_f32_16x16x32_bf16 v[132:135], a[64:67], a[16:19], v[228:231]
    v_exp_f32 v158, v158
    v_mfma_f32_16x16x32_bf16 v[132:135], a[68:71], a[20:23], v[132:135]
    ds_read_b128 a[88:91], v240 offset:4672
    buffer_load_dwordx4 v251, s[60:63], s69 offen offset:1024 lds
    v_mfma_f32_16x16x32_bf16 v[132:135], a[72:75], a[24:27], v[132:135]
    v_exp_f32 v159, v159
    v_mfma_f32_16x16x32_bf16 v[132:135], a[76:79], a[28:31], v[132:135]
    ds_read_b128 a[92:95], v240 offset:4928
    v_cvt_pk_bf16_f32 v223, v158, v159
    v_mfma_f32_16x16x32_bf16 v[136:139], a[64:67], a[32:35], v[232:235]
    v_exp_f32 v128, v128
    v_mfma_f32_16x16x32_bf16 v[136:139], a[68:71], a[36:39], v[136:139]
    v_mfma_f32_16x16x32_bf16 v[136:139], a[72:75], a[40:43], v[136:139]
    v_exp_f32 v129, v129
    v_mfma_f32_16x16x32_bf16 v[136:139], a[76:79], a[44:47], v[136:139]
    v_cvt_pk_bf16_f32 v192, v128, v129
    v_mfma_f32_16x16x32_bf16 v[140:143], a[64:67], a[48:51], v[236:239]
    v_exp_f32 v130, v130
    v_mfma_f32_16x16x32_bf16 v[140:143], a[68:71], a[52:55], v[140:143]
    buffer_load_dwordx4 v252, s[60:63], s69 offen offset:2048 lds
    v_mfma_f32_16x16x32_bf16 v[140:143], a[72:75], a[56:59], v[140:143]
    v_exp_f32 v131, v131
    v_mfma_f32_16x16x32_bf16 v[140:143], a[76:79], a[60:63], v[140:143]
    s_waitcnt lgkmcnt(0)
    v_cvt_pk_bf16_f32 v193, v130, v131
    v_mfma_f32_16x16x32_bf16 v[144:147], a[80:83], a[0:3], v[224:227]
    ds_read_b64_tr_b16 a[64:65], v241 offset:8192
    buffer_load_dwordx4 a[228:231], v246, s[64:67], s15 offen offset:128
    v_mfma_f32_16x16x32_bf16 v[144:147], a[84:87], a[4:7], v[144:147]
    v_exp_f32 v132, v132
    v_mfma_f32_16x16x32_bf16 v[144:147], a[88:91], a[8:11], v[144:147]
    ds_read_b64_tr_b16 a[66:67], v241 offset:12288
    s_add_u32 s72, s72, 176128
    v_mfma_f32_16x16x32_bf16 v[144:147], a[92:95], a[12:15], v[144:147]
    v_exp_f32 v133, v133
    v_mfma_f32_16x16x32_bf16 v[148:151], a[80:83], a[16:19], v[228:231]
    ds_read_b64_tr_b16 a[68:69], v249 offset:8192
    v_cvt_pk_bf16_f32 v196, v132, v133
    v_mfma_f32_16x16x32_bf16 v[148:151], a[84:87], a[20:23], v[148:151]
    v_exp_f32 v134, v134
    v_mfma_f32_16x16x32_bf16 v[148:151], a[88:91], a[24:27], v[148:151]
    ds_read_b64_tr_b16 a[70:71], v249 offset:12288
    buffer_load_dwordx4 v253, s[60:63], s69 offen offset:3072 lds
    v_mfma_f32_16x16x32_bf16 v[148:151], a[92:95], a[28:31], v[148:151]
    v_exp_f32 v135, v135
    v_mfma_f32_16x16x32_bf16 v[152:155], a[80:83], a[32:35], v[232:235]
    ds_read_b64_tr_b16 a[72:73], v241 offset:8448
    v_cvt_pk_bf16_f32 v197, v134, v135
    v_mfma_f32_16x16x32_bf16 v[152:155], a[84:87], a[36:39], v[152:155]
    v_exp_f32 v136, v136
    v_mfma_f32_16x16x32_bf16 v[152:155], a[88:91], a[40:43], v[152:155]
    ds_read_b64_tr_b16 a[74:75], v241 offset:12544
    s_or_b32 s15, s14, s72
    v_mfma_f32_16x16x32_bf16 v[152:155], a[92:95], a[44:47], v[152:155]
    v_exp_f32 v137, v137
    v_mfma_f32_16x16x32_bf16 v[156:159], a[80:83], a[48:51], v[236:239]
    ds_read_b64_tr_b16 a[76:77], v249 offset:8448
    v_cvt_pk_bf16_f32 v200, v136, v137
    v_mfma_f32_16x16x32_bf16 v[156:159], a[84:87], a[52:55], v[156:159]
    v_exp_f32 v138, v138
    v_mfma_f32_16x16x32_bf16 v[156:159], a[88:91], a[56:59], v[156:159]
    s_waitcnt lgkmcnt(3)
    ds_read_b64_tr_b16 a[78:79], v249 offset:12544
    v_mfma_f32_16x16x32_bf16 v[156:159], a[92:95], a[60:63], v[156:159]
    v_exp_f32 v139, v139
    v_mfma_f32_16x16x32_bf16 v[0:3], a[64:67], v[208:211], v[0:3]
    ds_read_b64_tr_b16 a[80:81], v241 offset:8704
    v_cvt_pk_bf16_f32 v201, v138, v139
    v_mfma_f32_16x16x32_bf16 v[4:7], a[64:67], v[212:215], v[4:7]
    ds_read_b64_tr_b16 a[82:83], v241 offset:12800
    buffer_load_dwordx4 a[232:235], v246, s[64:67], s72 offen offset:0
    v_mfma_f32_16x16x32_bf16 v[8:11], a[64:67], v[216:219], v[8:11]
    v_exp_f32 v140, v140
    v_mfma_f32_16x16x32_bf16 v[12:15], a[64:67], v[220:223], v[12:15]
    ds_read_b64_tr_b16 a[84:85], v249 offset:8704
    v_mfma_f32_16x16x32_bf16 v[168:171], v[184:187], v[208:211], v[168:171]
    v_exp_f32 v141, v141
    v_mfma_f32_16x16x32_bf16 v[16:19], a[68:71], v[208:211], v[16:19]
    ds_read_b64_tr_b16 a[86:87], v249 offset:12800
    v_cvt_pk_bf16_f32 v204, v140, v141
    v_mfma_f32_16x16x32_bf16 v[20:23], a[68:71], v[212:215], v[20:23]
    v_exp_f32 v142, v142
    v_mfma_f32_16x16x32_bf16 v[24:27], a[68:71], v[216:219], v[24:27]
    s_waitcnt lgkmcnt(4)
    ds_read_b64_tr_b16 a[88:89], v241 offset:8960
    v_mfma_f32_16x16x32_bf16 v[28:31], a[68:71], v[220:223], v[28:31]
    v_exp_f32 v143, v143
    v_mfma_f32_16x16x32_bf16 v[32:35], a[72:75], v[208:211], v[32:35]
    ds_read_b64_tr_b16 a[90:91], v241 offset:13056
    v_cvt_pk_bf16_f32 v205, v142, v143
    v_mfma_f32_16x16x32_bf16 v[36:39], a[72:75], v[212:215], v[36:39]
    v_exp_f32 v144, v144
    v_mfma_f32_16x16x32_bf16 v[40:43], a[72:75], v[216:219], v[40:43]
    ds_read_b64_tr_b16 a[92:93], v249 offset:8960
    buffer_load_dwordx4 a[236:239], v246, s[64:67], s15 offen offset:64
    v_mfma_f32_16x16x32_bf16 v[44:47], a[72:75], v[220:223], v[44:47]
    v_exp_f32 v145, v145
    v_mfma_f32_16x16x32_bf16 v[172:175], v[184:187], v[212:215], v[172:175]
    ds_read_b64_tr_b16 a[94:95], v249 offset:13056
    v_cvt_pk_bf16_f32 v194, v144, v145
    v_mfma_f32_16x16x32_bf16 v[48:51], a[76:79], v[208:211], v[48:51]
    v_exp_f32 v146, v146
    v_mfma_f32_16x16x32_bf16 v[52:55], a[76:79], v[212:215], v[52:55]
    ds_read_b128 a[64:67], v240 offset:8320
    v_mfma_f32_16x16x32_bf16 v[56:59], a[76:79], v[216:219], v[56:59]
    v_exp_f32 v147, v147
    v_mfma_f32_16x16x32_bf16 v[60:63], a[76:79], v[220:223], v[60:63]
    s_waitcnt lgkmcnt(5)
    ds_read_b128 a[68:71], v240 offset:8576
    v_mfma_f32_16x16x32_bf16 v[64:67], a[80:83], v[208:211], v[64:67]
    ds_read_b128 a[72:75], v240 offset:8832
    v_cvt_pk_bf16_f32 v195, v146, v147
    v_mfma_f32_16x16x32_bf16 v[68:71], a[80:83], v[212:215], v[68:71]
    v_exp_f32 v148, v148
    v_mfma_f32_16x16x32_bf16 v[72:75], a[80:83], v[216:219], v[72:75]
    ds_read_b128 a[76:79], v240 offset:9088
    v_mfma_f32_16x16x32_bf16 v[76:79], a[80:83], v[220:223], v[76:79]
    v_exp_f32 v149, v149
    v_mfma_f32_16x16x32_bf16 v[176:179], v[184:187], v[216:219], v[176:179]
    v_cvt_pk_bf16_f32 v198, v148, v149
    v_add_u32 v241, 99840, v244
    v_mfma_f32_16x16x32_bf16 v[80:83], a[84:87], v[208:211], v[80:83]
    v_exp_f32 v150, v150
    v_mfma_f32_16x16x32_bf16 v[84:87], a[84:87], v[212:215], v[84:87]
    buffer_load_dwordx4 a[240:243], v246, s[64:67], s15 offen offset:128
    v_xor_b32 v249, 32, v241
    v_mfma_f32_16x16x32_bf16 v[88:91], a[84:87], v[216:219], v[88:91]
    v_exp_f32 v151, v151
    v_mfma_f32_16x16x32_bf16 v[92:95], a[84:87], v[220:223], v[92:95]
    s_waitcnt lgkmcnt(4)
    v_cvt_pk_bf16_f32 v199, v150, v151
    v_mfma_f32_16x16x32_bf16 v[96:99], a[88:91], v[208:211], v[96:99]
    v_exp_f32 v152, v152
    v_mfma_f32_16x16x32_bf16 v[100:103], a[88:91], v[212:215], v[100:103]
    s_cmp_eq_u32 s37, 4
    s_cselect_b32 s79, 262144, s71
    v_mfma_f32_16x16x32_bf16 v[104:107], a[88:91], v[216:219], v[104:107]
    v_exp_f32 v153, v153
    v_mfma_f32_16x16x32_bf16 v[108:111], a[88:91], v[220:223], v[108:111]
    s_add_u32 s69, s69, s79
    v_cvt_pk_bf16_f32 v202, v152, v153
    v_mfma_f32_16x16x32_bf16 v[180:183], v[184:187], v[220:223], v[180:183]
    v_exp_f32 v154, v154
    v_mfma_f32_16x16x32_bf16 v[112:115], a[92:95], v[208:211], v[112:115]
    s_add_u32 m0, s39, 49920
    s_add_u32 s72, s72, 176128
    v_mfma_f32_16x16x32_bf16 v[116:119], a[92:95], v[212:215], v[116:119]
    v_exp_f32 v155, v155
    v_mfma_f32_16x16x32_bf16 v[120:123], a[92:95], v[216:219], v[120:123]
    buffer_load_dwordx4 v255, s[60:63], s69 offen offset:0 lds
    v_cvt_pk_bf16_f32 v203, v154, v155
    v_mfma_f32_16x16x32_bf16 v[124:127], a[92:95], v[220:223], v[124:127]
    s_waitcnt lgkmcnt(0)
    s_or_b32 s15, s14, s72
    v_mfma_f32_16x16x32_bf16 v[128:131], a[64:67], a[0:3], v[224:227]
    v_exp_f32 v156, v156
    v_mfma_f32_16x16x32_bf16 v[128:131], a[68:71], a[4:7], v[128:131]
    ds_read_b128 a[80:83], v240 offset:12480
    buffer_load_dwordx4 a[244:247], v246, s[64:67], s72 offen offset:0
    v_mfma_f32_16x16x32_bf16 v[128:131], a[72:75], a[8:11], v[128:131]
    v_exp_f32 v157, v157
    v_mfma_f32_16x16x32_bf16 v[128:131], a[76:79], a[12:15], v[128:131]
    ds_read_b128 a[84:87], v240 offset:12736
    v_cvt_pk_bf16_f32 v206, v156, v157
    v_mfma_f32_16x16x32_bf16 v[132:135], a[64:67], a[16:19], v[228:231]
    v_exp_f32 v158, v158
    v_mfma_f32_16x16x32_bf16 v[132:135], a[68:71], a[20:23], v[132:135]
    ds_read_b128 a[88:91], v240 offset:12992
    buffer_load_dwordx4 v251, s[60:63], s69 offen offset:1024 lds
    v_mfma_f32_16x16x32_bf16 v[132:135], a[72:75], a[24:27], v[132:135]
    v_exp_f32 v159, v159
    v_mfma_f32_16x16x32_bf16 v[132:135], a[76:79], a[28:31], v[132:135]
    ds_read_b128 a[92:95], v240 offset:13248
    v_cvt_pk_bf16_f32 v207, v158, v159
    v_mfma_f32_16x16x32_bf16 v[136:139], a[64:67], a[32:35], v[232:235]
    v_exp_f32 v128, v128
    v_mfma_f32_16x16x32_bf16 v[136:139], a[68:71], a[36:39], v[136:139]
    v_exp_f32 v129, v129
    v_mfma_f32_16x16x32_bf16 v[136:139], a[72:75], a[40:43], v[136:139]
    v_exp_f32 v130, v130
    v_mfma_f32_16x16x32_bf16 v[136:139], a[76:79], a[44:47], v[136:139]
    buffer_load_dwordx4 a[248:251], v246, s[64:67], s15 offen offset:64
    v_exp_f32 v131, v131
    v_mfma_f32_16x16x32_bf16 v[140:143], a[64:67], a[48:51], v[236:239]
    v_exp_f32 v132, v132
    v_mfma_f32_16x16x32_bf16 v[140:143], a[68:71], a[52:55], v[140:143]
    v_exp_f32 v133, v133
    v_mfma_f32_16x16x32_bf16 v[140:143], a[72:75], a[56:59], v[140:143]
    v_exp_f32 v134, v134
    v_mfma_f32_16x16x32_bf16 v[140:143], a[76:79], a[60:63], v[140:143]
    s_waitcnt lgkmcnt(0)
    v_cvt_pk_bf16_f32 v208, v128, v129
    v_mfma_f32_16x16x32_bf16 v[144:147], a[80:83], a[0:3], v[224:227]
    ds_read_b64_tr_b16 a[64:65], v241 offset:0
    v_cvt_pk_bf16_f32 v209, v130, v131
    v_mfma_f32_16x16x32_bf16 v[144:147], a[84:87], a[4:7], v[144:147]
    v_exp_f32 v135, v135
    v_mfma_f32_16x16x32_bf16 v[144:147], a[88:91], a[8:11], v[144:147]
    ds_read_b64_tr_b16 a[66:67], v241 offset:4096
    v_cvt_pk_bf16_f32 v212, v132, v133
    v_mfma_f32_16x16x32_bf16 v[144:147], a[92:95], a[12:15], v[144:147]
    v_exp_f32 v136, v136
    v_mfma_f32_16x16x32_bf16 v[148:151], a[80:83], a[16:19], v[228:231]
    ds_read_b64_tr_b16 a[68:69], v249 offset:0
    v_cvt_pk_bf16_f32 v213, v134, v135
    v_mfma_f32_16x16x32_bf16 v[148:151], a[84:87], a[20:23], v[148:151]
    buffer_load_dwordx4 a[252:255], v246, s[64:67], s15 offen offset:128
    v_exp_f32 v137, v137
    v_mfma_f32_16x16x32_bf16 v[148:151], a[88:91], a[24:27], v[148:151]
    ds_read_b64_tr_b16 a[70:71], v249 offset:4096
    v_cvt_pk_bf16_f32 v216, v136, v137
    v_mfma_f32_16x16x32_bf16 v[148:151], a[92:95], a[28:31], v[148:151]
    v_exp_f32 v138, v138
    v_mfma_f32_16x16x32_bf16 v[152:155], a[80:83], a[32:35], v[232:235]
    ds_read_b64_tr_b16 a[72:73], v241 offset:256
    buffer_load_dwordx4 v252, s[60:63], s69 offen offset:2048 lds
    v_mfma_f32_16x16x32_bf16 v[152:155], a[84:87], a[36:39], v[152:155]
    v_exp_f32 v139, v139
    v_mfma_f32_16x16x32_bf16 v[152:155], a[88:91], a[40:43], v[152:155]
    ds_read_b64_tr_b16 a[74:75], v241 offset:4352
    v_cvt_pk_bf16_f32 v217, v138, v139
    v_mfma_f32_16x16x32_bf16 v[152:155], a[92:95], a[44:47], v[152:155]
    v_exp_f32 v140, v140
    v_mfma_f32_16x16x32_bf16 v[156:159], a[80:83], a[48:51], v[236:239]
    ds_read_b64_tr_b16 a[76:77], v249 offset:256
    v_lshrrev_b32 v242, 8, v254
    v_mfma_f32_16x16x32_bf16 v[156:159], a[84:87], a[52:55], v[156:159]
    v_exp_f32 v141, v141
    v_mfma_f32_16x16x32_bf16 v[156:159], a[88:91], a[56:59], v[156:159]
    s_waitcnt lgkmcnt(3)
    ds_read_b64_tr_b16 a[78:79], v249 offset:4352
    buffer_load_dwordx4 v253, s[60:63], s69 offen offset:3072 lds
    v_mfma_f32_16x16x32_bf16 v[156:159], a[92:95], a[60:63], v[156:159]
    v_exp_f32 v142, v142
    v_mfma_f32_16x16x32_bf16 v[0:3], a[64:67], v[192:195], v[0:3]
    ds_read_b64_tr_b16 a[80:81], v241 offset:512
    s_barrier
    v_cvt_pk_bf16_f32 v220, v140, v141
    v_mfma_f32_16x16x32_bf16 v[4:7], a[64:67], v[196:199], v[4:7]
    ds_read_b64_tr_b16 a[82:83], v241 offset:4608
    v_lshlrev_b32 v240, 9, v242
    v_mfma_f32_16x16x32_bf16 v[8:11], a[64:67], v[200:203], v[8:11]
    v_exp_f32 v143, v143
    v_mfma_f32_16x16x32_bf16 v[12:15], a[64:67], v[204:207], v[12:15]
    ds_read_b64_tr_b16 a[84:85], v249 offset:512
    v_cvt_pk_bf16_f32 v221, v142, v143
    v_mfma_f32_16x16x32_bf16 v[168:171], v[184:187], v[192:195], v[168:171]
    v_exp_f32 v144, v144
    v_mfma_f32_16x16x32_bf16 v[16:19], a[68:71], v[192:195], v[16:19]
    ds_read_b64_tr_b16 a[86:87], v249 offset:4608
    v_and_b32 v242, 1, v242
    v_mfma_f32_16x16x32_bf16 v[20:23], a[68:71], v[196:199], v[20:23]
    v_exp_f32 v145, v145
    v_mfma_f32_16x16x32_bf16 v[24:27], a[68:71], v[200:203], v[24:27]
    s_waitcnt lgkmcnt(4)
    ds_read_b64_tr_b16 a[88:89], v241 offset:768
    v_mfma_f32_16x16x32_bf16 v[28:31], a[68:71], v[204:207], v[28:31]
    v_exp_f32 v146, v146
    v_mfma_f32_16x16x32_bf16 v[32:35], a[72:75], v[192:195], v[32:35]
    ds_read_b64_tr_b16 a[90:91], v241 offset:4864
    v_cvt_pk_bf16_f32 v210, v144, v145
    v_mfma_f32_16x16x32_bf16 v[36:39], a[72:75], v[196:199], v[36:39]
    v_exp_f32 v147, v147
    v_mfma_f32_16x16x32_bf16 v[40:43], a[72:75], v[200:203], v[40:43]
    ds_read_b64_tr_b16 a[92:93], v249 offset:768
    v_cvt_pk_bf16_f32 v211, v146, v147
    v_mfma_f32_16x16x32_bf16 v[44:47], a[72:75], v[204:207], v[44:47]
    v_exp_f32 v148, v148
    v_mfma_f32_16x16x32_bf16 v[172:175], v[184:187], v[196:199], v[172:175]
    ds_read_b64_tr_b16 a[94:95], v249 offset:4864
    v_lshl_add_u32 v240, v242, 5, v240
    v_mfma_f32_16x16x32_bf16 v[48:51], a[76:79], v[192:195], v[48:51]
    v_exp_f32 v149, v149
    v_mfma_f32_16x16x32_bf16 v[52:55], a[76:79], v[196:199], v[52:55]
    ds_read_b64_tr_b16 a[64:65], v241 offset:8192
    v_cvt_pk_bf16_f32 v214, v148, v149
    v_mfma_f32_16x16x32_bf16 v[56:59], a[76:79], v[200:203], v[56:59]
    v_exp_f32 v150, v150
    v_mfma_f32_16x16x32_bf16 v[60:63], a[76:79], v[204:207], v[60:63]
    s_waitcnt lgkmcnt(5)
    ds_read_b64_tr_b16 a[66:67], v241 offset:12288
    v_mfma_f32_16x16x32_bf16 v[64:67], a[80:83], v[192:195], v[64:67]
    ds_read_b64_tr_b16 a[68:69], v249 offset:8192
    v_and_b32 v242, 0xd8, v244
    v_mfma_f32_16x16x32_bf16 v[68:71], a[80:83], v[196:199], v[68:71]
    v_exp_f32 v151, v151
    v_mfma_f32_16x16x32_bf16 v[72:75], a[80:83], v[200:203], v[72:75]
    ds_read_b64_tr_b16 a[70:71], v249 offset:12288
    v_cvt_pk_bf16_f32 v215, v150, v151
    v_mfma_f32_16x16x32_bf16 v[76:79], a[80:83], v[204:207], v[76:79]
    v_exp_f32 v152, v152
    v_mfma_f32_16x16x32_bf16 v[176:179], v[184:187], v[200:203], v[176:179]
    ds_read_b64_tr_b16 a[72:73], v241 offset:8448
    v_add_u32 v240, v240, v242
    v_mfma_f32_16x16x32_bf16 v[80:83], a[84:87], v[192:195], v[80:83]
    v_exp_f32 v153, v153
    v_mfma_f32_16x16x32_bf16 v[84:87], a[84:87], v[196:199], v[84:87]
    ds_read_b64_tr_b16 a[74:75], v241 offset:12544
    v_cvt_pk_bf16_f32 v218, v152, v153
    v_mfma_f32_16x16x32_bf16 v[88:91], a[84:87], v[200:203], v[88:91]
    v_exp_f32 v154, v154
    v_mfma_f32_16x16x32_bf16 v[92:95], a[84:87], v[204:207], v[92:95]
    s_waitcnt lgkmcnt(6)
    ds_read_b64_tr_b16 a[76:77], v249 offset:8448
    v_mfma_f32_16x16x32_bf16 v[96:99], a[88:91], v[192:195], v[96:99]
    v_exp_f32 v155, v155
    v_mfma_f32_16x16x32_bf16 v[100:103], a[88:91], v[196:199], v[100:103]
    ds_read_b64_tr_b16 a[78:79], v249 offset:12544
    v_cvt_pk_bf16_f32 v219, v154, v155
    v_mfma_f32_16x16x32_bf16 v[104:107], a[88:91], v[200:203], v[104:107]
    v_exp_f32 v156, v156
    v_mfma_f32_16x16x32_bf16 v[108:111], a[88:91], v[204:207], v[108:111]
    ds_read_b64_tr_b16 a[80:81], v241 offset:8704
    v_add_u32 v240, 133120, v240
    v_mfma_f32_16x16x32_bf16 v[180:183], v[184:187], v[204:207], v[180:183]
    v_exp_f32 v157, v157
    v_mfma_f32_16x16x32_bf16 v[112:115], a[92:95], v[192:195], v[112:115]
    ds_read_b64_tr_b16 a[82:83], v241 offset:12800
    v_exp_f32 v158, v158
    v_mfma_f32_16x16x32_bf16 v[116:119], a[92:95], v[196:199], v[116:119]
    v_exp_f32 v159, v159
    v_mfma_f32_16x16x32_bf16 v[120:123], a[92:95], v[200:203], v[120:123]
    ds_read_b64_tr_b16 a[84:85], v249 offset:8704
    v_cvt_pk_bf16_f32 v222, v156, v157
    v_mfma_f32_16x16x32_bf16 v[124:127], a[92:95], v[204:207], v[124:127]
    ds_read_b64_tr_b16 a[86:87], v249 offset:12800
    v_cvt_pk_bf16_f32 v223, v158, v159
    v_mfma_f32_16x16x32_bf16 v[168:171], v[184:187], v[208:211], v[168:171]
    ds_read_b64_tr_b16 a[88:89], v241 offset:8960
    v_xor_b32 v242, 32, v240
    v_mfma_f32_16x16x32_bf16 v[172:175], v[184:187], v[212:215], v[172:175]
    ds_read_b64_tr_b16 a[90:91], v241 offset:13056
    v_mfma_f32_16x16x32_bf16 v[176:179], v[184:187], v[216:219], v[176:179]
    ds_read_b64_tr_b16 a[92:93], v249 offset:8960
    v_mfma_f32_16x16x32_bf16 v[180:183], v[184:187], v[220:223], v[180:183]
    s_waitcnt lgkmcnt(11)
    ds_read_b64_tr_b16 a[94:95], v249 offset:13056
    v_mfma_f32_16x16x32_bf16 v[0:3], a[64:67], v[208:211], v[0:3]
    s_cmp_eq_u32 s37, 5
    s_cselect_b32 s79, 262144, s71
    v_mfma_f32_16x16x32_bf16 v[4:7], a[64:67], v[212:215], v[4:7]
    s_add_u32 s69, s69, s79
    s_add_u32 m0, s39, 66560
    v_mfma_f32_16x16x32_bf16 v[8:11], a[64:67], v[216:219], v[8:11]
    buffer_load_dwordx4 v255, s[60:63], s69 offen offset:0 lds
    buffer_load_dwordx4 v251, s[60:63], s69 offen offset:1024 lds
    buffer_load_dwordx4 v252, s[60:63], s69 offen offset:2048 lds
    buffer_load_dwordx4 v253, s[60:63], s69 offen offset:3072 lds
    s_cmp_eq_u32 s37, 6
    s_cselect_b32 s79, 262144, s71
    s_add_u32 s69, s69, s79
    s_add_u32 m0, s39, 83200
    s_nop 0
    buffer_load_dwordx4 v255, s[60:63], s69 offen offset:0 lds
    buffer_load_dwordx4 v251, s[60:63], s69 offen offset:1024 lds
    buffer_load_dwordx4 v252, s[60:63], s69 offen offset:2048 lds
    buffer_load_dwordx4 v253, s[60:63], s69 offen offset:3072 lds
    v_mfma_f32_16x16x32_bf16 v[12:15], a[64:67], v[220:223], v[12:15]
    v_mfma_f32_16x16x32_bf16 v[16:19], a[68:71], v[208:211], v[16:19]
    v_rcp_f32 v224, v168
    v_mfma_f32_16x16x32_bf16 v[20:23], a[68:71], v[212:215], v[20:23]
    v_rcp_f32 v226, v172
    v_mfma_f32_16x16x32_bf16 v[24:27], a[68:71], v[216:219], v[24:27]
    v_rcp_f32 v228, v176
    v_mfma_f32_16x16x32_bf16 v[28:31], a[68:71], v[220:223], v[28:31]
    s_waitcnt lgkmcnt(8)
    v_rcp_f32 v230, v180
    v_mfma_f32_16x16x32_bf16 v[32:35], a[72:75], v[208:211], v[32:35]
    v_mfma_f32_16x16x32_bf16 v[36:39], a[72:75], v[212:215], v[36:39]
    v_mfma_f32_16x16x32_bf16 v[40:43], a[72:75], v[216:219], v[40:43]
    s_nop 2
    v_pk_mul_f32 v[0:1], v[0:1], v[224:225] op_sel_hi:[1,0]
    v_pk_mul_f32 v[2:3], v[2:3], v[224:225] op_sel_hi:[1,0]
    v_pk_mul_f32 v[16:17], v[16:17], v[224:225] op_sel_hi:[1,0]
    v_pk_mul_f32 v[18:19], v[18:19], v[224:225] op_sel_hi:[1,0]
    v_cvt_pk_bf16_f32 v128, v0, v1
    v_cvt_pk_bf16_f32 v129, v2, v3
    v_cvt_pk_bf16_f32 v130, v16, v17
    v_cvt_pk_bf16_f32 v131, v18, v19
    buffer_store_dwordx4 v[128:131], v254, s[56:59], s74 offen offset:0 sc1
    v_pk_mul_f32 v[4:5], v[4:5], v[226:227] op_sel_hi:[1,0]
    v_pk_mul_f32 v[6:7], v[6:7], v[226:227] op_sel_hi:[1,0]
    v_pk_mul_f32 v[20:21], v[20:21], v[226:227] op_sel_hi:[1,0]
    v_pk_mul_f32 v[22:23], v[22:23], v[226:227] op_sel_hi:[1,0]
    v_cvt_pk_bf16_f32 v132, v4, v5
    v_cvt_pk_bf16_f32 v133, v6, v7
    v_cvt_pk_bf16_f32 v134, v20, v21
    v_cvt_pk_bf16_f32 v135, v22, v23
    buffer_store_dwordx4 v[132:135], v254, s[56:59], s74 offen offset:1024 sc1
    v_pk_mul_f32 v[8:9], v[8:9], v[228:229] op_sel_hi:[1,0]
    v_pk_mul_f32 v[10:11], v[10:11], v[228:229] op_sel_hi:[1,0]
    v_pk_mul_f32 v[24:25], v[24:25], v[228:229] op_sel_hi:[1,0]
    v_pk_mul_f32 v[26:27], v[26:27], v[228:229] op_sel_hi:[1,0]
    v_cvt_pk_bf16_f32 v136, v8, v9
    v_cvt_pk_bf16_f32 v137, v10, v11
    v_cvt_pk_bf16_f32 v138, v24, v25
    v_cvt_pk_bf16_f32 v139, v26, v27
    buffer_store_dwordx4 v[136:139], v254, s[56:59], s76 offen offset:0 sc1
    v_pk_mul_f32 v[12:13], v[12:13], v[230:231] op_sel_hi:[1,0]
    v_pk_mul_f32 v[14:15], v[14:15], v[230:231] op_sel_hi:[1,0]
    v_pk_mul_f32 v[28:29], v[28:29], v[230:231] op_sel_hi:[1,0]
    v_pk_mul_f32 v[30:31], v[30:31], v[230:231] op_sel_hi:[1,0]
    v_cvt_pk_bf16_f32 v140, v12, v13
    v_cvt_pk_bf16_f32 v141, v14, v15
    v_cvt_pk_bf16_f32 v142, v28, v29
    v_cvt_pk_bf16_f32 v143, v30, v31
    buffer_store_dwordx4 v[140:143], v254, s[56:59], s76 offen offset:1024 sc1
    v_mfma_f32_16x16x32_bf16 v[44:47], a[72:75], v[220:223], v[44:47]
    v_mfma_f32_16x16x32_bf16 v[48:51], a[76:79], v[208:211], v[48:51]
    v_min3_f32 v192, v168, v172, v176
    v_add_f32 v193, v168, v172
    v_min_f32 v192, v192, v180
    v_add_f32 v194, v176, v180
    v_cmp_lt_f32 vcc, 0x2b800000, v192
    v_add_f32 v193, v193, v194
    s_mov_b32 s72, 0x5f800000
    v_cmp_gt_f32 s[96:97], s72, v193
    s_lshl_b32 s78, s34, 2
    s_add_u32 s78, s78, 160512
    v_mov_b32 v194, s78
    v_mov_b32 v195, 160512
    s_and_b64 s[96:97], s[96:97], vcc
    s_cmp_eq_u64 s[96:97], -1
    s_cselect_b32 s78, 0, 1
    v_mov_b32 v192, s78
    ds_write_b32 v194, v192
    v_mfma_f32_16x16x32_bf16 v[52:55], a[76:79], v[212:215], v[52:55]
    v_mfma_f32_16x16x32_bf16 v[56:59], a[76:79], v[216:219], v[56:59]
    v_mfma_f32_16x16x32_bf16 v[60:63], a[76:79], v[220:223], v[60:63]
    s_waitcnt lgkmcnt(5)
    v_mfma_f32_16x16x32_bf16 v[64:67], a[80:83], v[208:211], v[64:67]
    v_mfma_f32_16x16x32_bf16 v[68:71], a[80:83], v[212:215], v[68:71]
    s_waitcnt vmcnt(12)
    s_waitcnt lgkmcnt(0)
    s_barrier
    ds_read_b128 v[196:199], v195
    v_mfma_f32_16x16x32_bf16 v[72:75], a[80:83], v[216:219], v[72:75]
    ds_read_b64_tr_b16 a[64:65], v240 offset:0
    s_nop 2
    v_pk_mul_f32 v[32:33], v[32:33], v[224:225] op_sel_hi:[1,0]
    v_pk_mul_f32 v[34:35], v[34:35], v[224:225] op_sel_hi:[1,0]
    v_pk_mul_f32 v[48:49], v[48:49], v[224:225] op_sel_hi:[1,0]
    v_pk_mul_f32 v[50:51], v[50:51], v[224:225] op_sel_hi:[1,0]
    v_cvt_pk_bf16_f32 v144, v32, v33
    v_cvt_pk_bf16_f32 v145, v34, v35
    v_cvt_pk_bf16_f32 v146, v48, v49
    v_cvt_pk_bf16_f32 v147, v50, v51
    buffer_store_dwordx4 v[144:147], v254, s[56:59], s74 offen offset:2048 sc1
    v_pk_mul_f32 v[36:37], v[36:37], v[226:227] op_sel_hi:[1,0]
    v_pk_mul_f32 v[38:39], v[38:39], v[226:227] op_sel_hi:[1,0]
    v_pk_mul_f32 v[52:53], v[52:53], v[226:227] op_sel_hi:[1,0]
    v_pk_mul_f32 v[54:55], v[54:55], v[226:227] op_sel_hi:[1,0]
    v_cvt_pk_bf16_f32 v148, v36, v37
    v_cvt_pk_bf16_f32 v149, v38, v39
    v_cvt_pk_bf16_f32 v150, v52, v53
    v_cvt_pk_bf16_f32 v151, v54, v55
    buffer_store_dwordx4 v[148:151], v254, s[56:59], s74 offen offset:3072 sc1
    v_pk_mul_f32 v[40:41], v[40:41], v[228:229] op_sel_hi:[1,0]
    v_pk_mul_f32 v[42:43], v[42:43], v[228:229] op_sel_hi:[1,0]
    v_pk_mul_f32 v[56:57], v[56:57], v[228:229] op_sel_hi:[1,0]
    v_pk_mul_f32 v[58:59], v[58:59], v[228:229] op_sel_hi:[1,0]
    v_cvt_pk_bf16_f32 v152, v40, v41
    v_cvt_pk_bf16_f32 v153, v42, v43
    v_cvt_pk_bf16_f32 v154, v56, v57
    v_cvt_pk_bf16_f32 v155, v58, v59
    buffer_store_dwordx4 v[152:155], v254, s[56:59], s76 offen offset:2048 sc1
    v_pk_mul_f32 v[44:45], v[44:45], v[230:231] op_sel_hi:[1,0]
    v_pk_mul_f32 v[46:47], v[46:47], v[230:231] op_sel_hi:[1,0]
    v_pk_mul_f32 v[60:61], v[60:61], v[230:231] op_sel_hi:[1,0]
    v_pk_mul_f32 v[62:63], v[62:63], v[230:231] op_sel_hi:[1,0]
    v_cvt_pk_bf16_f32 v156, v44, v45
    v_cvt_pk_bf16_f32 v157, v46, v47
    v_cvt_pk_bf16_f32 v158, v60, v61
    v_cvt_pk_bf16_f32 v159, v62, v63
    buffer_store_dwordx4 v[156:159], v254, s[56:59], s76 offen offset:3072 sc1
    v_mfma_f32_16x16x32_bf16 v[76:79], a[80:83], v[220:223], v[76:79]
    ds_read_b64_tr_b16 a[66:67], v240 offset:2048
    v_mfma_f32_16x16x32_bf16 v[80:83], a[84:87], v[208:211], v[80:83]
    v_mfma_f32_16x16x32_bf16 v[84:87], a[84:87], v[212:215], v[84:87]
    ds_read_b64_tr_b16 a[68:69], v240 offset:4096
    v_mfma_f32_16x16x32_bf16 v[88:91], a[84:87], v[216:219], v[88:91]
    ds_read_b64_tr_b16 a[70:71], v240 offset:6144
    v_mfma_f32_16x16x32_bf16 v[92:95], a[84:87], v[220:223], v[92:95]
    s_waitcnt lgkmcnt(4)
    v_or_b32 v196, v196, v197
    v_mfma_f32_16x16x32_bf16 v[96:99], a[88:91], v[208:211], v[96:99]
    ds_read_b64_tr_b16 a[72:73], v242 offset:0
    v_or3_b32 v196, v196, v198, v199
    v_mfma_f32_16x16x32_bf16 v[100:103], a[88:91], v[212:215], v[100:103]
    ds_read_b64_tr_b16 a[74:75], v242 offset:2048
    v_readfirstlane_b32 s78, v196
    v_mfma_f32_16x16x32_bf16 v[104:107], a[88:91], v[216:219], v[104:107]
    v_mfma_f32_16x16x32_bf16 v[108:111], a[88:91], v[220:223], v[108:111]
    ds_read_b64_tr_b16 a[76:77], v242 offset:4096
    s_andn2_b32 s78, s78, s73
    s_cbranch_scc1 L1_fallback
    v_mfma_f32_16x16x32_bf16 v[112:115], a[92:95], v[208:211], v[112:115]
    ds_read_b64_tr_b16 a[78:79], v242 offset:6144
    v_mfma_f32_16x16x32_bf16 v[116:119], a[92:95], v[212:215], v[116:119]
    v_pk_mul_f32 v[64:65], v[64:65], v[224:225] op_sel_hi:[1,0]
    v_pk_mul_f32 v[66:67], v[66:67], v[224:225] op_sel_hi:[1,0]
    v_pk_mul_f32 v[80:81], v[80:81], v[224:225] op_sel_hi:[1,0]
    v_pk_mul_f32 v[82:83], v[82:83], v[224:225] op_sel_hi:[1,0]
    v_cvt_pk_bf16_f32 v160, v64, v65
    v_cvt_pk_bf16_f32 v161, v66, v67
    v_cvt_pk_bf16_f32 v162, v80, v81
    v_cvt_pk_bf16_f32 v163, v82, v83
    v_pk_mul_f32 v[68:69], v[68:69], v[226:227] op_sel_hi:[1,0]
    v_pk_mul_f32 v[70:71], v[70:71], v[226:227] op_sel_hi:[1,0]
    v_pk_mul_f32 v[84:85], v[84:85], v[226:227] op_sel_hi:[1,0]
    v_pk_mul_f32 v[86:87], v[86:87], v[226:227] op_sel_hi:[1,0]
    v_cvt_pk_bf16_f32 v164, v68, v69
    v_cvt_pk_bf16_f32 v165, v70, v71
    v_cvt_pk_bf16_f32 v166, v84, v85
    v_cvt_pk_bf16_f32 v167, v86, v87
    v_pk_mul_f32 v[72:73], v[72:73], v[228:229] op_sel_hi:[1,0]
    v_pk_mul_f32 v[74:75], v[74:75], v[228:229] op_sel_hi:[1,0]
    v_pk_mul_f32 v[88:89], v[88:89], v[228:229] op_sel_hi:[1,0]
    v_pk_mul_f32 v[90:91], v[90:91], v[228:229] op_sel_hi:[1,0]
    v_cvt_pk_bf16_f32 v168, v72, v73
    v_cvt_pk_bf16_f32 v169, v74, v75
    v_cvt_pk_bf16_f32 v170, v88, v89
    v_cvt_pk_bf16_f32 v171, v90, v91
    v_pk_mul_f32 v[76:77], v[76:77], v[230:231] op_sel_hi:[1,0]
    v_pk_mul_f32 v[78:79], v[78:79], v[230:231] op_sel_hi:[1,0]
    v_pk_mul_f32 v[92:93], v[92:93], v[230:231] op_sel_hi:[1,0]
    v_pk_mul_f32 v[94:95], v[94:95], v[230:231] op_sel_hi:[1,0]
    v_cvt_pk_bf16_f32 v172, v76, v77
    v_cvt_pk_bf16_f32 v173, v78, v79
    v_cvt_pk_bf16_f32 v174, v92, v93
    v_cvt_pk_bf16_f32 v175, v94, v95
    v_mfma_f32_16x16x32_bf16 v[120:123], a[92:95], v[216:219], v[120:123]
    v_mfma_f32_16x16x32_bf16 v[124:127], a[92:95], v[220:223], v[124:127]
    s_waitcnt lgkmcnt(4)
    v_mfma_f32_16x16x32_bf16 v[0:3], a[64:67], v[128:131], 0
    ds_read_b64_tr_b16 a[80:81], v240 offset:256
    v_mfma_f32_16x16x32_bf16 v[0:3], a[68:71], v[144:147], v[0:3]
    v_mfma_f32_16x16x32_bf16 v[4:7], a[64:67], v[132:135], 0
    ds_read_b64_tr_b16 a[82:83], v240 offset:2304
    v_mfma_f32_16x16x32_bf16 v[4:7], a[68:71], v[148:151], v[4:7]
    v_mfma_f32_16x16x32_bf16 v[16:19], a[64:67], v[136:139], 0
    ds_read_b64_tr_b16 a[84:85], v240 offset:4352
    v_mfma_f32_16x16x32_bf16 v[16:19], a[68:71], v[152:155], v[16:19]
    v_mfma_f32_16x16x32_bf16 v[20:23], a[64:67], v[140:143], 0
    ds_read_b64_tr_b16 a[86:87], v240 offset:6400
    v_mfma_f32_16x16x32_bf16 v[20:23], a[68:71], v[156:159], v[20:23]
    v_pk_mul_f32 v[96:97], v[96:97], v[224:225] op_sel_hi:[1,0]
    v_pk_mul_f32 v[98:99], v[98:99], v[224:225] op_sel_hi:[1,0]
    v_pk_mul_f32 v[112:113], v[112:113], v[224:225] op_sel_hi:[1,0]
    v_pk_mul_f32 v[114:115], v[114:115], v[224:225] op_sel_hi:[1,0]
    v_cvt_pk_bf16_f32 v176, v96, v97
    v_cvt_pk_bf16_f32 v177, v98, v99
    v_cvt_pk_bf16_f32 v178, v112, v113
L_pad6:
    s_cbranch_execz L_pad7
    v_cvt_pk_bf16_f32 v179, v114, v115
    v_pk_mul_f32 v[100:101], v[100:101], v[226:227] op_sel_hi:[1,0]
    v_pk_mul_f32 v[102:103], v[102:103], v[226:227] op_sel_hi:[1,0]
    v_pk_mul_f32 v[116:117], v[116:117], v[226:227] op_sel_hi:[1,0]
    v_pk_mul_f32 v[118:119], v[118:119], v[226:227] op_sel_hi:[1,0]
    v_cvt_pk_bf16_f32 v180, v100, v101
    v_cvt_pk_bf16_f32 v181, v102, v103
    v_cvt_pk_bf16_f32 v182, v116, v117
    v_cvt_pk_bf16_f32 v183, v118, v119
    v_pk_mul_f32 v[104:105], v[104:105], v[228:229] op_sel_hi:[1,0]
    v_pk_mul_f32 v[106:107], v[106:107], v[228:229] op_sel_hi:[1,0]
    v_pk_mul_f32 v[120:121], v[120:121], v[228:229] op_sel_hi:[1,0]
    v_pk_mul_f32 v[122:123], v[122:123], v[228:229] op_sel_hi:[1,0]
    v_cvt_pk_bf16_f32 v184, v104, v105
    v_cvt_pk_bf16_f32 v185, v106, v107
    v_cvt_pk_bf16_f32 v186, v120, v121
    v_cvt_pk_bf16_f32 v187, v122, v123
    v_pk_mul_f32 v[108:109], v[108:109], v[230:231] op_sel_hi:[1,0]
    v_pk_mul_f32 v[110:111], v[110:111], v[230:231] op_sel_hi:[1,0]
    v_pk_mul_f32 v[124:125], v[124:125], v[230:231] op_sel_hi:[1,0]
    v_pk_mul_f32 v[126:127], v[126:127], v[230:231] op_sel_hi:[1,0]
    v_cvt_pk_bf16_f32 v188, v108, v109
    v_cvt_pk_bf16_f32 v189, v110, v111
    v_cvt_pk_bf16_f32 v190, v124, v125
    v_cvt_pk_bf16_f32 v191, v126, v127
    s_waitcnt lgkmcnt(4)
    v_mfma_f32_16x16x32_bf16 v[8:11], a[72:75], v[128:131], 0
    ds_read_b64_tr_b16 a[88:89], v242 offset:256
    s_lshl_b32 s73, s35, 13
    v_mfma_f32_16x16x32_bf16 v[8:11], a[76:79], v[144:147], v[8:11]
    s_lshl_b32 s74, s36, 11
    s_add_u32 s74, s74, s73
    v_mfma_f32_16x16x32_bf16 v[12:15], a[72:75], v[132:135], 0
    ds_read_b64_tr_b16 a[90:91], v242 offset:2304
    v_mbcnt_lo_u32_b32 v235, -1, 0
    v_mfma_f32_16x16x32_bf16 v[12:15], a[76:79], v[148:151], v[12:15]
    v_mov_b32 v234, 1
    v_lshlrev_b32 v235, 8, v235
    v_mfma_f32_16x16x32_bf16 v[24:27], a[72:75], v[136:139], 0
    ds_read_b64_tr_b16 a[92:93], v242 offset:4352
    s_lshl_b32 s71, s37, 13
    v_mfma_f32_16x16x32_bf16 v[24:27], a[76:79], v[152:155], v[24:27]
    v_add_u32 v236, 4294950656, v244
    v_add_u32 v237, 33280, v244
    v_mfma_f32_16x16x32_bf16 v[28:31], a[72:75], v[140:143], 0
    ds_read_b64_tr_b16 a[94:95], v242 offset:6400
    v_add_u32 v238, 83200, v244
    v_mfma_f32_16x16x32_bf16 v[28:31], a[76:79], v[156:159], v[28:31]
    v_lshrrev_b32 v239, 4, v254
    s_waitcnt lgkmcnt(4)
    v_mfma_f32_16x16x32_bf16 v[32:35], a[80:83], v[128:131], 0
    ds_read_b64_tr_b16 a[64:65], v240 offset:8192
    v_mfma_f32_16x16x32_bf16 v[32:35], a[84:87], v[144:147], v[32:35]
    s_cmp_eq_u32 s37, 0
    s_cselect_b32 s68, 8192, 0
    v_mfma_f32_16x16x32_bf16 v[36:39], a[80:83], v[132:135], 0
    ds_read_b64_tr_b16 a[66:67], v240 offset:10240
    v_mfma_f32_16x16x32_bf16 v[36:39], a[84:87], v[148:151], v[36:39]
    v_mfma_f32_16x16x32_bf16 v[48:51], a[80:83], v[136:139], 0
    ds_read_b64_tr_b16 a[68:69], v240 offset:12288
    v_mfma_f32_16x16x32_bf16 v[48:51], a[84:87], v[152:155], v[48:51]
    v_mfma_f32_16x16x32_bf16 v[52:55], a[80:83], v[140:143], 0
    ds_read_b64_tr_b16 a[70:71], v240 offset:14336
    v_mfma_f32_16x16x32_bf16 v[52:55], a[84:87], v[156:159], v[52:55]
    s_waitcnt lgkmcnt(4)
    v_mfma_f32_16x16x32_bf16 v[40:43], a[88:91], v[128:131], 0
    ds_read_b64_tr_b16 a[72:73], v242 offset:8192
    v_mfma_f32_16x16x32_bf16 v[40:43], a[92:95], v[144:147], v[40:43]
    v_mfma_f32_16x16x32_bf16 v[44:47], a[88:91], v[132:135], 0
    ds_read_b64_tr_b16 a[74:75], v242 offset:10240
    v_mfma_f32_16x16x32_bf16 v[44:47], a[92:95], v[148:151], v[44:47]
    v_mfma_f32_16x16x32_bf16 v[56:59], a[88:91], v[136:139], 0
    ds_read_b64_tr_b16 a[76:77], v242 offset:12288
    v_mfma_f32_16x16x32_bf16 v[56:59], a[92:95], v[152:155], v[56:59]
    v_mfma_f32_16x16x32_bf16 v[60:63], a[88:91], v[140:143], 0
    ds_read_b64_tr_b16 a[78:79], v242 offset:14336
    v_mfma_f32_16x16x32_bf16 v[60:63], a[92:95], v[156:159], v[60:63]
    s_waitcnt lgkmcnt(4)
    v_mfma_f32_16x16x32_bf16 v[0:3], a[64:67], v[160:163], v[0:3]
    ds_read_b64_tr_b16 a[80:81], v240 offset:8448
    v_mfma_f32_16x16x32_bf16 v[0:3], a[68:71], v[176:179], v[0:3]
    v_mfma_f32_16x16x32_bf16 v[4:7], a[64:67], v[164:167], v[4:7]
    ds_read_b64_tr_b16 a[82:83], v240 offset:10496
    v_mfma_f32_16x16x32_bf16 v[4:7], a[68:71], v[180:183], v[4:7]
    v_mfma_f32_16x16x32_bf16 v[16:19], a[64:67], v[168:171], v[16:19]
    ds_read_b64_tr_b16 a[84:85], v240 offset:12544
    v_mfma_f32_16x16x32_bf16 v[16:19], a[68:71], v[184:187], v[16:19]
    v_mfma_f32_16x16x32_bf16 v[20:23], a[64:67], v[172:175], v[20:23]
    ds_read_b64_tr_b16 a[86:87], v240 offset:14592
    v_mfma_f32_16x16x32_bf16 v[20:23], a[68:71], v[188:191], v[20:23]
    s_waitcnt lgkmcnt(4)
    v_mfma_f32_16x16x32_bf16 v[8:11], a[72:75], v[160:163], v[8:11]
    ds_read_b64_tr_b16 a[88:89], v242 offset:8448
    v_mfma_f32_16x16x32_bf16 v[8:11], a[76:79], v[176:179], v[8:11]
    v_mfma_f32_16x16x32_bf16 v[12:15], a[72:75], v[164:167], v[12:15]
    ds_read_b64_tr_b16 a[90:91], v242 offset:10496
    v_mfma_f32_16x16x32_bf16 v[12:15], a[76:79], v[180:183], v[12:15]
    v_mfma_f32_16x16x32_bf16 v[24:27], a[72:75], v[168:171], v[24:27]
    ds_read_b64_tr_b16 a[92:93], v242 offset:12544
    v_mfma_f32_16x16x32_bf16 v[24:27], a[76:79], v[184:187], v[24:27]
    v_mfma_f32_16x16x32_bf16 v[28:31], a[72:75], v[172:175], v[28:31]
    ds_read_b64_tr_b16 a[94:95], v242 offset:14592
    v_mfma_f32_16x16x32_bf16 v[28:31], a[76:79], v[188:191], v[28:31]
    s_waitcnt lgkmcnt(4)
    v_mfma_f32_16x16x32_bf16 v[32:35], a[80:83], v[160:163], v[32:35]
    v_mfma_f32_16x16x32_bf16 v[32:35], a[84:87], v[176:179], v[32:35]
    s_waitcnt vmcnt(0)
    s_barrier
    s_cmp_lg_u32 s34, 0
    s_cbranch_scc1 L_nsig4
    s_mov_b64 exec, 0xff
    buffer_atomic_add v234, v235, s[40:43], s74 offen offset:4 sc1
    s_mov_b64 exec, -1
L_nsig4:
    v_mfma_f32_16x16x32_bf16 v[36:39], a[80:83], v[164:167], v[36:39]
    buffer_store_dwordx4 v[160:163], v254, s[56:59], s75 offen offset:0 sc1
    v_mfma_f32_16x16x32_bf16 v[36:39], a[84:87], v[180:183], v[36:39]
    v_mfma_f32_16x16x32_bf16 v[48:51], a[80:83], v[168:171], v[48:51]
    buffer_store_dwordx4 v[164:167], v254, s[56:59], s75 offen offset:1024 sc1
    v_mfma_f32_16x16x32_bf16 v[48:51], a[84:87], v[184:187], v[48:51]
    v_mfma_f32_16x16x32_bf16 v[52:55], a[80:83], v[172:175], v[52:55]
    buffer_store_dwordx4 v[168:171], v254, s[56:59], s77 offen offset:0 sc1
    v_mfma_f32_16x16x32_bf16 v[52:55], a[84:87], v[188:191], v[52:55]
    s_waitcnt lgkmcnt(0)
    v_mfma_f32_16x16x32_bf16 v[40:43], a[88:91], v[160:163], v[40:43]
    buffer_store_dwordx4 v[172:175], v254, s[56:59], s77 offen offset:1024 sc1
    v_mfma_f32_16x16x32_bf16 v[40:43], a[92:95], v[176:179], v[40:43]
    v_mfma_f32_16x16x32_bf16 v[44:47], a[88:91], v[164:167], v[44:47]
    buffer_store_dwordx4 v[176:179], v254, s[56:59], s75 offen offset:2048 sc1
    v_mfma_f32_16x16x32_bf16 v[44:47], a[92:95], v[180:183], v[44:47]
    v_mfma_f32_16x16x32_bf16 v[56:59], a[88:91], v[168:171], v[56:59]
    buffer_store_dwordx4 v[180:183], v254, s[56:59], s75 offen offset:3072 sc1
    v_mfma_f32_16x16x32_bf16 v[56:59], a[92:95], v[184:187], v[56:59]
    v_mfma_f32_16x16x32_bf16 v[60:63], a[88:91], v[172:175], v[60:63]
    buffer_store_dwordx4 v[184:187], v254, s[56:59], s77 offen offset:2048 sc1
    v_mfma_f32_16x16x32_bf16 v[60:63], a[92:95], v[188:191], v[60:63]
    buffer_store_dwordx4 v[188:191], v254, s[56:59], s77 offen offset:3072 sc1
L_tail:
    v_lshrrev_b32 v96, 4, v239
    v_and_b32 v97, 15, v239
    v_lshlrev_b32 v97, 4, v97
    v_lshl_add_u32 v97, v96, 9, v97
    s_and_b32 s64, s37, 1
    s_lshl_b32 s64, s64, 11
    v_mov_b32 v249, v97
    v_add_u32 v245, s64, v254
    v_add_u32 v246, 262144, v245
    v_xor_b32 v247, 2048, v245
    v_xor_b32 v248, 2048, v246
    v_lshlrev_b32 v97, 9, v96
    v_and_b32 v96, 1, v96
    v_lshl_add_u32 v97, v96, 5, v97
    v_bfe_u32 v96, v239, 2, 2
    v_lshl_add_u32 v97, v96, 6, v97
    v_and_b32 v96, 3, v239
    v_lshl_add_u32 v236, v96, 3, v97
    v_add_u32 v237, 49920, v236
    v_add_u32 v238, 99840, v236
    v_xor_b32 v241, 32, v236
    v_xor_b32 v242, 32, v237
    v_xor_b32 v243, 32, v238
    s_lshl_b32 s64, s34, 9
    s_add_u32 s64, s64, 149760
    v_lshrrev_b32 v198, 4, v239
    v_lshl_add_u32 v198, v198, 7, s64
    v_and_b32 v199, 8, v239
    v_lshl_add_u32 v198, v199, 2, v198
    s_lshl_b32 s64, s34, 11
    s_add_u32 s64, s64, 151808
    v_lshl_add_u32 v199, v239, 5, s64
    ds_read_b128 v[152:155], v199
    ds_read_b128 v[156:159], v199 offset:16
    ds_read_b128 v[200:203], v198
    ds_read_b128 v[204:207], v198 offset:16
    v_mov_b32 v216, 0
    v_mov_b32 v217, 0
    v_mov_b32 v218, 0
    v_mov_b32 v219, 0
    v_mov_b32 v220, 0
    v_mov_b32 v221, 0
    v_mov_b32 v222, 0
    v_mov_b32 v223, 0
    ds_read_b64_tr_b16 v[64:65], v236 offset:0
    ds_read_b64_tr_b16 v[66:67], v236 offset:2048
    ds_read_b64_tr_b16 v[68:69], v236 offset:4096
    ds_read_b64_tr_b16 v[70:71], v236 offset:6144
    ds_read_b64_tr_b16 v[72:73], v241 offset:0
    ds_read_b64_tr_b16 v[74:75], v241 offset:2048
    ds_read_b64_tr_b16 v[76:77], v241 offset:4096
    ds_read_b64_tr_b16 v[78:79], v241 offset:6144
    s_waitcnt lgkmcnt(0)
    v_accvgpr_read_b32 v112, a128
    v_accvgpr_read_b32 v113, a129
    v_accvgpr_read_b32 v114, a130
    v_accvgpr_read_b32 v115, a131
    v_accvgpr_read_b32 v116, a132
    v_accvgpr_read_b32 v117, a133
    v_accvgpr_read_b32 v118, a134
    v_accvgpr_read_b32 v119, a135
    v_and_b32 v224, 0xffff, v200
    v_lshlrev_b32 v225, 16, v200
    v_lshrrev_b32 v226, 16, v200
    v_and_b32 v227, 0xffff0000, v200
    v_dot2c_f32_bf16 v216, v224, v112
    v_dot2c_f32_bf16 v217, v225, v112
    v_dot2c_f32_bf16 v218, v224, v113
    v_dot2c_f32_bf16 v219, v225, v113
    v_dot2c_f32_bf16 v220, v224, v114
    v_dot2c_f32_bf16 v221, v225, v114
    v_dot2c_f32_bf16 v222, v224, v115
    v_dot2c_f32_bf16 v223, v225, v115
    v_dot2c_f32_bf16 v216, v226, v116
    v_dot2c_f32_bf16 v217, v227, v116
    v_dot2c_f32_bf16 v218, v226, v117
    v_dot2c_f32_bf16 v219, v227, v117
    v_dot2c_f32_bf16 v220, v226, v118
    v_dot2c_f32_bf16 v221, v227, v118
    v_dot2c_f32_bf16 v222, v226, v119
    v_dot2c_f32_bf16 v223, v227, v119
    v_accvgpr_read_b32 v112, a136
    v_accvgpr_read_b32 v113, a137
    v_accvgpr_read_b32 v114, a138
    v_accvgpr_read_b32 v115, a139
    v_accvgpr_read_b32 v116, a140
    v_accvgpr_read_b32 v117, a141
    v_accvgpr_read_b32 v118, a142
    v_accvgpr_read_b32 v119, a143
    v_and_b32 v224, 0xffff, v201
    v_lshlrev_b32 v225, 16, v201
    v_lshrrev_b32 v226, 16, v201
    v_and_b32 v227, 0xffff0000, v201
    v_dot2c_f32_bf16 v216, v224, v112
    v_dot2c_f32_bf16 v217, v225, v112
    v_dot2c_f32_bf16 v218, v224, v113
    v_dot2c_f32_bf16 v219, v225, v113
    v_dot2c_f32_bf16 v220, v224, v114
    v_dot2c_f32_bf16 v221, v225, v114
    v_dot2c_f32_bf16 v222, v224, v115
    v_dot2c_f32_bf16 v223, v225, v115
    v_dot2c_f32_bf16 v216, v226, v116
    v_dot2c_f32_bf16 v217, v227, v116
    v_dot2c_f32_bf16 v218, v226, v117
    v_dot2c_f32_bf16 v219, v227, v117
    v_dot2c_f32_bf16 v220, v226, v118
    v_dot2c_f32_bf16 v221, v227, v118
    v_dot2c_f32_bf16 v222, v226, v119
    v_dot2c_f32_bf16 v223, v227, v119
    s_load_dword s96, s[98:99], 4 glc
    v_accvgpr_read_b32 v112, a144
    v_accvgpr_read_b32 v113, a145
    v_accvgpr_read_b32 v114, a146
    v_accvgpr_read_b32 v115, a147
    v_accvgpr_read_b32 v116, a148
    v_accvgpr_read_b32 v117, a149
    v_accvgpr_read_b32 v118, a150
    v_accvgpr_read_b32 v119, a151
    v_and_b32 v224, 0xffff, v202
    v_lshlrev_b32 v225, 16, v202
    v_lshrrev_b32 v226, 16, v202
    v_and_b32 v227, 0xffff0000, v202
    v_dot2c_f32_bf16 v216, v224, v112
    v_dot2c_f32_bf16 v217, v225, v112
    v_dot2c_f32_bf16 v218, v224, v113
    v_dot2c_f32_bf16 v219, v225, v113
    v_dot2c_f32_bf16 v220, v224, v114
    v_dot2c_f32_bf16 v221, v225, v114
    v_dot2c_f32_bf16 v222, v224, v115
    v_dot2c_f32_bf16 v223, v225, v115
    v_dot2c_f32_bf16 v216, v226, v116
    v_dot2c_f32_bf16 v217, v227, v116
    v_dot2c_f32_bf16 v218, v226, v117
    v_dot2c_f32_bf16 v219, v227, v117
    v_dot2c_f32_bf16 v220, v226, v118
    v_dot2c_f32_bf16 v221, v227, v118
    v_dot2c_f32_bf16 v222, v226, v119
    v_dot2c_f32_bf16 v223, v227, v119
    v_accvgpr_read_b32 v112, a152
    v_accvgpr_read_b32 v113, a153
    v_accvgpr_read_b32 v114, a154
    v_accvgpr_read_b32 v115, a155
    v_accvgpr_read_b32 v116, a156
    v_accvgpr_read_b32 v117, a157
    v_accvgpr_read_b32 v118, a158
    v_accvgpr_read_b32 v119, a159
    v_and_b32 v224, 0xffff, v203
    v_lshlrev_b32 v225, 16, v203
    v_lshrrev_b32 v226, 16, v203
    v_and_b32 v227, 0xffff0000, v203
    v_dot2c_f32_bf16 v216, v224, v112
    v_dot2c_f32_bf16 v217, v225, v112
    v_dot2c_f32_bf16 v218, v224, v113
    v_dot2c_f32_bf16 v219, v225, v113
    v_dot2c_f32_bf16 v220, v224, v114
    v_dot2c_f32_bf16 v221, v225, v114
    v_dot2c_f32_bf16 v222, v224, v115
    v_dot2c_f32_bf16 v223, v225, v115
    v_dot2c_f32_bf16 v216, v226, v116
    v_dot2c_f32_bf16 v217, v227, v116
    v_dot2c_f32_bf16 v218, v226, v117
    v_dot2c_f32_bf16 v219, v227, v117
    v_dot2c_f32_bf16 v220, v226, v118
    v_dot2c_f32_bf16 v221, v227, v118
    v_dot2c_f32_bf16 v222, v226, v119
    v_dot2c_f32_bf16 v223, v227, v119
    s_waitcnt lgkmcnt(0)
    s_cmp_ge_u32 s96, 8
    s_cbranch_scc1 L_pk8
    s_mov_b32 s97, 0
L_poll9:
    s_load_dword s96, s[98:99], 4 glc
    s_add_u32 s97, s97, 1
    s_cmp_gt_u32 s97, 200000
    s_cbranch_scc1 L_pout9
    s_waitcnt lgkmcnt(0)
    s_cmp_lt_u32 s96, 8
    s_cbranch_scc1 L_poll9
L_pout9:
    s_waitcnt lgkmcnt(0)
L_pk8:
    buffer_load_dwordx4 a[0:3], v245, s[56:59], s68 offen offset:0 sc1
    buffer_load_dwordx4 a[4:7], v247, s[56:59], s68 offen offset:0 sc1
    buffer_load_dwordx4 a[8:11], v245, s[56:59], s68 offen offset:1024 sc1
    buffer_load_dwordx4 a[12:15], v247, s[56:59], s68 offen offset:1024 sc1
    buffer_load_dwordx4 a[16:19], v246, s[56:59], s68 offen offset:0 sc1
    buffer_load_dwordx4 a[20:23], v248, s[56:59], s68 offen offset:0 sc1
    buffer_load_dwordx4 a[24:27], v246, s[56:59], s68 offen offset:1024 sc1
    buffer_load_dwordx4 a[28:31], v248, s[56:59], s68 offen offset:1024 sc1
    s_add_u32 s68, s68, 8192
    s_cmp_eq_u32 s68, s71
    s_cselect_b32 s76, 8192, 0
    s_add_u32 s68, s68, s76
    buffer_load_dwordx4 a[32:35], v245, s[56:59], s68 offen offset:0 sc1
    buffer_load_dwordx4 a[36:39], v247, s[56:59], s68 offen offset:0 sc1
    buffer_load_dwordx4 a[40:43], v245, s[56:59], s68 offen offset:1024 sc1
    buffer_load_dwordx4 a[44:47], v247, s[56:59], s68 offen offset:1024 sc1
    v_accvgpr_read_b32 v112, a160
    v_accvgpr_read_b32 v113, a161
    v_accvgpr_read_b32 v114, a162
    v_accvgpr_read_b32 v115, a163
    v_accvgpr_read_b32 v116, a164
    v_accvgpr_read_b32 v117, a165
    v_accvgpr_read_b32 v118, a166
    v_accvgpr_read_b32 v119, a167
    v_and_b32 v224, 0xffff, v204
    v_lshlrev_b32 v225, 16, v204
    v_lshrrev_b32 v226, 16, v204
    v_and_b32 v227, 0xffff0000, v204
    v_dot2c_f32_bf16 v216, v224, v112
    v_dot2c_f32_bf16 v217, v225, v112
    v_dot2c_f32_bf16 v218, v224, v113
    v_dot2c_f32_bf16 v219, v225, v113
    v_dot2c_f32_bf16 v220, v224, v114
    v_dot2c_f32_bf16 v221, v225, v114
    v_dot2c_f32_bf16 v222, v224, v115
    v_dot2c_f32_bf16 v223, v225, v115
    v_dot2c_f32_bf16 v216, v226, v116
    v_dot2c_f32_bf16 v217, v227, v116
    v_dot2c_f32_bf16 v218, v226, v117
    v_dot2c_f32_bf16 v219, v227, v117
    v_dot2c_f32_bf16 v220, v226, v118
    v_dot2c_f32_bf16 v221, v227, v118
    v_dot2c_f32_bf16 v222, v226, v119
    v_dot2c_f32_bf16 v223, v227, v119
    v_accvgpr_read_b32 v112, a168
    v_accvgpr_read_b32 v113, a169
    v_accvgpr_read_b32 v114, a170
    v_accvgpr_read_b32 v115, a171
    v_accvgpr_read_b32 v116, a172
    v_accvgpr_read_b32 v117, a173
    v_accvgpr_read_b32 v118, a174
    v_accvgpr_read_b32 v119, a175
    v_and_b32 v224, 0xffff, v205
    v_lshlrev_b32 v225, 16, v205
    v_lshrrev_b32 v226, 16, v205
    v_and_b32 v227, 0xffff0000, v205
    v_dot2c_f32_bf16 v216, v224, v112
    v_dot2c_f32_bf16 v217, v225, v112
    v_dot2c_f32_bf16 v218, v224, v113
    v_dot2c_f32_bf16 v219, v225, v113
    v_dot2c_f32_bf16 v220, v224, v114
    v_dot2c_f32_bf16 v221, v225, v114
    v_dot2c_f32_bf16 v222, v224, v115
    v_dot2c_f32_bf16 v223, v225, v115
    v_dot2c_f32_bf16 v216, v226, v116
    v_dot2c_f32_bf16 v217, v227, v116
    v_dot2c_f32_bf16 v218, v226, v117
    v_dot2c_f32_bf16 v219, v227, v117
    v_dot2c_f32_bf16 v220, v226, v118
    v_dot2c_f32_bf16 v221, v227, v118
    v_dot2c_f32_bf16 v222, v226, v119
    v_dot2c_f32_bf16 v223, v227, v119
    v_accvgpr_read_b32 v112, a176
    v_accvgpr_read_b32 v113, a177
    v_accvgpr_read_b32 v114, a178
    v_accvgpr_read_b32 v115, a179
    v_accvgpr_read_b32 v116, a180
    v_accvgpr_read_b32 v117, a181
    v_accvgpr_read_b32 v118, a182
    v_accvgpr_read_b32 v119, a183
    v_and_b32 v224, 0xffff, v206
    v_lshlrev_b32 v225, 16, v206
    v_lshrrev_b32 v226, 16, v206
    v_and_b32 v227, 0xffff0000, v206
    v_dot2c_f32_bf16 v216, v224, v112
    v_dot2c_f32_bf16 v217, v225, v112
    v_dot2c_f32_bf16 v218, v224, v113
    v_dot2c_f32_bf16 v219, v225, v113
    v_dot2c_f32_bf16 v220, v224, v114
    v_dot2c_f32_bf16 v221, v225, v114
    v_dot2c_f32_bf16 v222, v224, v115
    v_dot2c_f32_bf16 v223, v225, v115
    v_dot2c_f32_bf16 v216, v226, v116
    v_dot2c_f32_bf16 v217, v227, v116
    v_dot2c_f32_bf16 v218, v226, v117
    v_dot2c_f32_bf16 v219, v227, v117
    v_dot2c_f32_bf16 v220, v226, v118
    v_dot2c_f32_bf16 v221, v227, v118
    v_dot2c_f32_bf16 v222, v226, v119
    v_dot2c_f32_bf16 v223, v227, v119
    v_accvgpr_read_b32 v112, a184
    v_accvgpr_read_b32 v113, a185
    v_accvgpr_read_b32 v114, a186
    v_accvgpr_read_b32 v115, a187
    v_accvgpr_read_b32 v116, a188
    v_accvgpr_read_b32 v117, a189
    v_accvgpr_read_b32 v118, a190
    v_accvgpr_read_b32 v119, a191
    v_and_b32 v224, 0xffff, v207
    v_lshlrev_b32 v225, 16, v207
    v_lshrrev_b32 v226, 16, v207
    v_and_b32 v227, 0xffff0000, v207
    v_dot2c_f32_bf16 v216, v224, v112
    v_dot2c_f32_bf16 v217, v225, v112
    v_dot2c_f32_bf16 v218, v224, v113
    v_dot2c_f32_bf16 v219, v225, v113
    v_dot2c_f32_bf16 v220, v224, v114
    v_dot2c_f32_bf16 v221, v225, v114
    v_dot2c_f32_bf16 v222, v224, v115
    v_dot2c_f32_bf16 v223, v225, v115
    v_dot2c_f32_bf16 v216, v226, v116
    v_dot2c_f32_bf16 v217, v227, v116
    v_dot2c_f32_bf16 v218, v226, v117
    v_dot2c_f32_bf16 v219, v227, v117
    v_dot2c_f32_bf16 v220, v226, v118
    v_dot2c_f32_bf16 v221, v227, v118
    v_dot2c_f32_bf16 v222, v226, v119
    v_dot2c_f32_bf16 v223, v227, v119
    s_waitcnt vmcnt(10) lgkmcnt(4)
    v_mfma_f32_16x16x32_bf16 v[0:3], v[64:67], a[0:3], v[0:3]
    ds_read_b64_tr_b16 v[80:81], v236 offset:256
    buffer_load_dwordx4 a[48:51], v246, s[56:59], s68 offen offset:0 sc1
    v_mfma_f32_16x16x32_bf16 v[0:3], v[68:71], a[4:7], v[0:3]
    s_waitcnt vmcnt(9)
    v_mfma_f32_16x16x32_bf16 v[4:7], v[64:67], a[8:11], v[4:7]
    ds_read_b64_tr_b16 v[82:83], v236 offset:2304
    buffer_load_dwordx4 a[52:55], v248, s[56:59], s68 offen offset:0 sc1
    v_mfma_f32_16x16x32_bf16 v[4:7], v[68:71], a[12:15], v[4:7]
    s_barrier
    s_cmp_lg_u32 s34, 0
    s_cbranch_scc1 L_nsig5
    s_mov_b64 exec, 0xff
    buffer_atomic_add v234, v235, s[40:43], s74 offen offset:20 sc1
    s_mov_b64 exec, -1
L_nsig5:
    s_waitcnt vmcnt(8)
    v_mfma_f32_16x16x32_bf16 v[16:19], v[64:67], a[16:19], v[16:19]
    ds_read_b64_tr_b16 v[84:85], v236 offset:4352
    v_mfma_f32_16x16x32_bf16 v[16:19], v[68:71], a[20:23], v[16:19]
    s_waitcnt vmcnt(6)
    v_mfma_f32_16x16x32_bf16 v[20:23], v[64:67], a[24:27], v[20:23]
    ds_read_b64_tr_b16 v[86:87], v236 offset:6400
    buffer_load_dwordx4 a[56:59], v246, s[56:59], s68 offen offset:1024 sc1
    v_mfma_f32_16x16x32_bf16 v[20:23], v[68:71], a[28:31], v[20:23]
    s_lshl_b32 s64, s34, 11
    s_waitcnt lgkmcnt(4)
    v_mfma_f32_16x16x32_bf16 v[8:11], v[72:75], a[0:3], v[8:11]
    ds_read_b64_tr_b16 v[88:89], v241 offset:256
    buffer_load_dwordx4 a[60:63], v248, s[56:59], s68 offen offset:1024 sc1
    v_mfma_f32_16x16x32_bf16 v[8:11], v[76:79], a[4:7], v[8:11]
    s_add_u32 s64, s64, 151808
    v_lshl_add_u32 v96, v239, 5, s64
    v_mfma_f32_16x16x32_bf16 v[12:15], v[72:75], a[8:11], v[12:15]
    ds_read_b64_tr_b16 v[90:91], v241 offset:2304
    s_add_u32 s68, s68, 8192
    v_mfma_f32_16x16x32_bf16 v[12:15], v[76:79], a[12:15], v[12:15]
    s_cmp_eq_u32 s68, s71
    s_cselect_b32 s76, 8192, 0
    s_add_u32 s68, s68, s76
    ds_write_b128 v96, v[216:219]
    v_mfma_f32_16x16x32_bf16 v[24:27], v[72:75], a[16:19], v[24:27]
    ds_read_b64_tr_b16 v[92:93], v241 offset:4352
    buffer_load_dwordx4 a[64:67], v245, s[56:59], s68 offen offset:0 sc1
    v_mfma_f32_16x16x32_bf16 v[24:27], v[76:79], a[20:23], v[24:27]
    v_mfma_f32_16x16x32_bf16 v[28:31], v[72:75], a[24:27], v[28:31]
    ds_read_b64_tr_b16 v[94:95], v241 offset:6400
    buffer_load_dwordx4 a[68:71], v247, s[56:59], s68 offen offset:0 sc1
    v_mfma_f32_16x16x32_bf16 v[28:31], v[76:79], a[28:31], v[28:31]
    ds_write_b128 v96, v[220:223] offset:16
    s_waitcnt lgkmcnt(6)
    v_mfma_f32_16x16x32_bf16 v[32:35], v[80:83], a[0:3], v[32:35]
    ds_read_b64_tr_b16 v[64:65], v236 offset:16640
    v_and_b32 v97, 15, v239
    v_mfma_f32_16x16x32_bf16 v[32:35], v[84:87], a[4:7], v[32:35]
    v_lshlrev_b32 v210, 1, v97
    v_lshrrev_b32 v96, 4, v239
    v_mfma_f32_16x16x32_bf16 v[36:39], v[80:83], a[8:11], v[36:39]
    ds_read_b64_tr_b16 v[66:67], v236 offset:18688
    buffer_load_dwordx4 a[72:75], v245, s[56:59], s68 offen offset:1024 sc1
    v_mfma_f32_16x16x32_bf16 v[36:39], v[84:87], a[12:15], v[36:39]
    v_lshlrev_b32 v96, 11, v96
    v_lshl_add_u32 v96, v97, 2, v96
    v_mfma_f32_16x16x32_bf16 v[48:51], v[80:83], a[16:19], v[48:51]
    ds_read_b64_tr_b16 v[68:69], v236 offset:20736
    buffer_load_dwordx4 a[76:79], v247, s[56:59], s68 offen offset:1024 sc1
    v_mfma_f32_16x16x32_bf16 v[48:51], v[84:87], a[20:23], v[48:51]
    s_lshl_b32 s64, s34, 6
    s_add_u32 s64, s64, 151808
    v_mfma_f32_16x16x32_bf16 v[52:55], v[80:83], a[24:27], v[52:55]
    ds_read_b64_tr_b16 v[70:71], v236 offset:22784
    v_add_u32 v96, s64, v96
    v_mfma_f32_16x16x32_bf16 v[52:55], v[84:87], a[28:31], v[52:55]
    s_waitcnt lgkmcnt(5)
    v_mfma_f32_16x16x32_bf16 v[40:43], v[88:91], a[0:3], v[40:43]
    ds_read_b64_tr_b16 v[72:73], v241 offset:16640
    buffer_load_dwordx4 a[80:83], v246, s[56:59], s68 offen offset:0 sc1
    v_mfma_f32_16x16x32_bf16 v[40:43], v[92:95], a[4:7], v[40:43]
    v_mfma_f32_16x16x32_bf16 v[44:47], v[88:91], a[8:11], v[44:47]
    ds_read_b64_tr_b16 v[74:75], v241 offset:18688
    buffer_load_dwordx4 a[84:87], v248, s[56:59], s68 offen offset:0 sc1
    v_mfma_f32_16x16x32_bf16 v[44:47], v[92:95], a[12:15], v[44:47]
    v_mfma_f32_16x16x32_bf16 v[56:59], v[88:91], a[16:19], v[56:59]
    ds_read_b64_tr_b16 v[76:77], v241 offset:20736
    v_mfma_f32_16x16x32_bf16 v[56:59], v[92:95], a[20:23], v[56:59]
    v_mfma_f32_16x16x32_bf16 v[60:63], v[88:91], a[24:27], v[60:63]
    ds_read_b64_tr_b16 v[78:79], v241 offset:22784
    buffer_load_dwordx4 a[88:91], v246, s[56:59], s68 offen offset:1024 sc1
    v_mfma_f32_16x16x32_bf16 v[60:63], v[92:95], a[28:31], v[60:63]
    s_waitcnt vmcnt(13) lgkmcnt(4)
    v_mfma_f32_16x16x32_bf16 v[0:3], v[64:67], a[32:35], v[0:3]
    ds_read_b64_tr_b16 v[80:81], v236 offset:16896
    buffer_load_dwordx4 a[92:95], v248, s[56:59], s68 offen offset:1024 sc1
    v_mfma_f32_16x16x32_bf16 v[0:3], v[68:71], a[36:39], v[0:3]
    s_waitcnt vmcnt(12)
    v_mfma_f32_16x16x32_bf16 v[4:7], v[64:67], a[40:43], v[4:7]
    ds_read_b64_tr_b16 v[82:83], v236 offset:18944
    s_add_u32 s68, s68, 8192
    v_mfma_f32_16x16x32_bf16 v[4:7], v[68:71], a[44:47], v[4:7]
    s_cmp_eq_u32 s68, s71
    s_cselect_b32 s76, 8192, 0
    s_add_u32 s68, s68, s76
    s_barrier
    s_waitcnt vmcnt(10)
    v_mfma_f32_16x16x32_bf16 v[16:19], v[64:67], a[48:51], v[16:19]
    ds_read_b64_tr_b16 v[84:85], v236 offset:20992
    buffer_load_dwordx4 a[0:3], v245, s[56:59], s68 offen offset:0 sc1
    v_mfma_f32_16x16x32_bf16 v[16:19], v[68:71], a[52:55], v[16:19]
    ds_read_b32 v100, v96 offset:0
    s_waitcnt vmcnt(9)
    v_mfma_f32_16x16x32_bf16 v[20:23], v[64:67], a[56:59], v[20:23]
    ds_read_b64_tr_b16 v[86:87], v236 offset:23040
    buffer_load_dwordx4 a[4:7], v247, s[56:59], s68 offen offset:0 sc1
    v_mfma_f32_16x16x32_bf16 v[20:23], v[68:71], a[60:63], v[20:23]
    ds_read_b32 v101, v96 offset:256
    s_waitcnt lgkmcnt(6)
    v_mfma_f32_16x16x32_bf16 v[8:11], v[72:75], a[32:35], v[8:11]
    ds_read_b64_tr_b16 v[88:89], v241 offset:16896
    ds_read_b32 v102, v96 offset:512
    v_mfma_f32_16x16x32_bf16 v[8:11], v[76:79], a[36:39], v[8:11]
    s_lshl_b32 s72, s35, 5
    s_add_u32 s72, s72, s38
    v_mfma_f32_16x16x32_bf16 v[12:15], v[72:75], a[40:43], v[12:15]
    ds_read_b64_tr_b16 v[90:91], v241 offset:18944
    buffer_load_dwordx4 a[8:11], v245, s[56:59], s68 offen offset:1024 sc1
    v_mfma_f32_16x16x32_bf16 v[12:15], v[76:79], a[44:47], v[12:15]
    ds_read_b32 v103, v96 offset:768
    s_lshl_b32 s72, s72, 2
    v_mfma_f32_16x16x32_bf16 v[24:27], v[72:75], a[48:51], v[24:27]
    ds_read_b64_tr_b16 v[92:93], v241 offset:20992
    buffer_load_dwordx4 a[12:15], v247, s[56:59], s68 offen offset:1024 sc1
    v_mfma_f32_16x16x32_bf16 v[24:27], v[76:79], a[52:55], v[24:27]
    ds_read_b32 v104, v96 offset:1024
    s_add_u32 s72, s72, s34
    v_mfma_f32_16x16x32_bf16 v[28:31], v[72:75], a[56:59], v[28:31]
    ds_read_b64_tr_b16 v[94:95], v241 offset:23040
    ds_read_b32 v105, v96 offset:1280
    v_mfma_f32_16x16x32_bf16 v[28:31], v[76:79], a[60:63], v[28:31]
    s_lshl_b32 s72, s72, 5
    s_waitcnt lgkmcnt(9)
    v_mfma_f32_16x16x32_bf16 v[32:35], v[80:83], a[32:35], v[32:35]
    ds_read_b64_tr_b16 v[64:65], v236 offset:33280
    buffer_load_dwordx4 a[16:19], v246, s[56:59], s68 offen offset:0 sc1
    v_mfma_f32_16x16x32_bf16 v[32:35], v[84:87], a[36:39], v[32:35]
    ds_read_b32 v106, v96 offset:1536
    s_add_u32 s72, s72, 196608
    v_mfma_f32_16x16x32_bf16 v[36:39], v[80:83], a[40:43], v[36:39]
    ds_read_b64_tr_b16 v[66:67], v236 offset:35328
    ds_read_b32 v107, v96 offset:1792
    v_mfma_f32_16x16x32_bf16 v[36:39], v[84:87], a[44:47], v[36:39]
    s_lshl_b32 s75, s36, 5
    s_lshl_b32 s77, s35, 2
    v_mfma_f32_16x16x32_bf16 v[48:51], v[80:83], a[48:51], v[48:51]
    ds_read_b64_tr_b16 v[68:69], v236 offset:37376
    buffer_load_dwordx4 a[20:23], v248, s[56:59], s68 offen offset:0 sc1
    v_mfma_f32_16x16x32_bf16 v[48:51], v[84:87], a[52:55], v[48:51]
    s_add_u32 s75, s75, s77
    s_add_u32 s75, s75, s34
    v_mfma_f32_16x16x32_bf16 v[52:55], v[80:83], a[56:59], v[52:55]
    ds_read_b64_tr_b16 v[70:71], v236 offset:39424
    s_lshl_b32 s75, s75, 4
    v_mfma_f32_16x16x32_bf16 v[52:55], v[84:87], a[60:63], v[52:55]
    s_add_u32 s75, s75, s37
    s_waitcnt lgkmcnt(7)
    v_mfma_f32_16x16x32_bf16 v[40:43], v[88:91], a[32:35], v[40:43]
    ds_read_b64_tr_b16 v[72:73], v241 offset:33280
    buffer_load_dwordx4 a[24:27], v246, s[56:59], s68 offen offset:1024 sc1
    v_mfma_f32_16x16x32_bf16 v[40:43], v[92:95], a[36:39], v[40:43]
    s_lshl_b32 s75, s75, 5
    s_add_u32 s75, s75, s36
    v_mfma_f32_16x16x32_bf16 v[44:47], v[88:91], a[40:43], v[44:47]
    ds_read_b64_tr_b16 v[74:75], v241 offset:35328
    s_lshl_b32 s75, s75, 7
    v_mfma_f32_16x16x32_bf16 v[44:47], v[92:95], a[44:47], v[44:47]
    s_add_u32 s75, s75, 13565952
    v_mfma_f32_16x16x32_bf16 v[56:59], v[88:91], a[48:51], v[56:59]
    ds_read_b64_tr_b16 v[76:77], v241 offset:37376
    buffer_load_dwordx4 a[28:31], v248, s[56:59], s68 offen offset:1024 sc1
    v_mfma_f32_16x16x32_bf16 v[56:59], v[92:95], a[52:55], v[56:59]
    s_add_u32 s44, s32, s75
    s_addc_u32 s45, s33, 0
    v_mfma_f32_16x16x32_bf16 v[60:63], v[88:91], a[56:59], v[60:63]
    ds_read_b64_tr_b16 v[78:79], v241 offset:39424
    s_add_u32 s68, s68, 8192
    v_mfma_f32_16x16x32_bf16 v[60:63], v[92:95], a[60:63], v[60:63]
    s_cmp_eq_u32 s68, s71
    s_cselect_b32 s76, 8192, 0
    s_add_u32 s68, s68, s76
    s_waitcnt lgkmcnt(6)
    v_add_f32 v100, v100, v101
    s_waitcnt vmcnt(14) lgkmcnt(4)
    v_mfma_f32_16x16x32_bf16 v[0:3], v[64:67], a[64:67], v[0:3]
    ds_read_b64_tr_b16 v[80:81], v236 offset:33536
    buffer_load_dwordx4 a[32:35], v245, s[56:59], s68 offen offset:0 sc1
    v_mfma_f32_16x16x32_bf16 v[0:3], v[68:71], a[68:71], v[0:3]
    v_add_f32 v100, v100, v102
L_pad7:
    s_cbranch_execz L_pad8
    s_waitcnt vmcnt(13)
    v_mfma_f32_16x16x32_bf16 v[4:7], v[64:67], a[72:75], v[4:7]
    ds_read_b64_tr_b16 v[82:83], v236 offset:35584
    s_mov_b32 s46, 36864
    v_mfma_f32_16x16x32_bf16 v[4:7], v[68:71], a[76:79], v[4:7]
    v_add_f32 v100, v100, v103
    s_waitcnt vmcnt(11)
    v_mfma_f32_16x16x32_bf16 v[16:19], v[64:67], a[80:83], v[16:19]
    ds_read_b64_tr_b16 v[84:85], v236 offset:37632
    buffer_load_dwordx4 a[36:39], v247, s[56:59], s68 offen offset:0 sc1
    v_mfma_f32_16x16x32_bf16 v[16:19], v[68:71], a[84:87], v[16:19]
    v_add_f32 v100, v100, v104
    s_waitcnt vmcnt(10)
    v_mfma_f32_16x16x32_bf16 v[20:23], v[64:67], a[88:91], v[20:23]
    ds_read_b64_tr_b16 v[86:87], v236 offset:39680
    s_mov_b32 s77, 32768
    v_mfma_f32_16x16x32_bf16 v[20:23], v[68:71], a[92:95], v[20:23]
    v_add_f32 v100, v100, v105
    s_waitcnt lgkmcnt(4)
    v_mfma_f32_16x16x32_bf16 v[8:11], v[72:75], a[64:67], v[8:11]
    ds_read_b64_tr_b16 v[88:89], v241 offset:33536
    buffer_load_dwordx4 a[40:43], v245, s[56:59], s68 offen offset:1024 sc1
    v_mfma_f32_16x16x32_bf16 v[8:11], v[76:79], a[68:71], v[8:11]
    s_lshl_b32 s64, s34, 10
    v_add_f32 v100, v100, v106
    v_mfma_f32_16x16x32_bf16 v[12:15], v[72:75], a[72:75], v[12:15]
    ds_read_b64_tr_b16 v[90:91], v241 offset:35584
    v_add_f32 v100, v100, v107
    v_mfma_f32_16x16x32_bf16 v[12:15], v[76:79], a[76:79], v[12:15]
    v_add_u32 v232, s64, v254
    v_add_u32 v233, 65536, v232
    v_mfma_f32_16x16x32_bf16 v[24:27], v[72:75], a[80:83], v[24:27]
    ds_read_b64_tr_b16 v[92:93], v241 offset:37632
    buffer_load_dwordx4 a[44:47], v247, s[56:59], s68 offen offset:1024 sc1
    v_mfma_f32_16x16x32_bf16 v[24:27], v[76:79], a[84:87], v[24:27]
    s_lshr_b32 s64, s34, 1
    v_mov_b32 v101, v100
    v_mfma_f32_16x16x32_bf16 v[28:31], v[72:75], a[88:91], v[28:31]
    ds_read_b64_tr_b16 v[94:95], v241 offset:39680
    s_nop 0
    v_mfma_f32_16x16x32_bf16 v[28:31], v[76:79], a[92:95], v[28:31]
    s_and_b32 s65, s34, 1
    s_waitcnt lgkmcnt(4)
    v_mfma_f32_16x16x32_bf16 v[32:35], v[80:83], a[64:67], v[32:35]
    ds_read_b64_tr_b16 v[64:65], v237 offset:0
    buffer_load_dwordx4 a[48:51], v246, s[56:59], s68 offen offset:0 sc1
    v_mfma_f32_16x16x32_bf16 v[32:35], v[84:87], a[68:71], v[32:35]
    v_permlane32_swap_b32 v100, v101
    v_mfma_f32_16x16x32_bf16 v[36:39], v[80:83], a[72:75], v[36:39]
    ds_read_b64_tr_b16 v[66:67], v237 offset:2048
    s_lshl_b32 s66, s64, 2
    v_mfma_f32_16x16x32_bf16 v[36:39], v[84:87], a[76:79], v[36:39]
    s_add_u32 s66, s66, s65
    v_add_f32 v100, v100, v101
    v_mfma_f32_16x16x32_bf16 v[48:51], v[80:83], a[80:83], v[48:51]
    ds_read_b64_tr_b16 v[68:69], v237 offset:4096
    buffer_load_dwordx4 a[52:55], v248, s[56:59], s68 offen offset:0 sc1
    v_mfma_f32_16x16x32_bf16 v[48:51], v[84:87], a[84:87], v[48:51]
    s_lshl_b32 s66, s66, 13
    v_mov_b32 v101, v100
    v_mfma_f32_16x16x32_bf16 v[52:55], v[80:83], a[88:91], v[52:55]
    ds_read_b64_tr_b16 v[70:71], v237 offset:6144
    s_nop 0
    v_mfma_f32_16x16x32_bf16 v[52:55], v[84:87], a[92:95], v[52:55]
    s_lshl_b32 s67, s64, 5
    s_waitcnt lgkmcnt(4)
    v_mfma_f32_16x16x32_bf16 v[40:43], v[88:91], a[64:67], v[40:43]
    ds_read_b64_tr_b16 v[72:73], v242 offset:0
    buffer_load_dwordx4 a[56:59], v246, s[56:59], s68 offen offset:1024 sc1
    v_mfma_f32_16x16x32_bf16 v[40:43], v[92:95], a[68:71], v[40:43]
    v_permlane16_swap_b32 v100, v101
    v_mfma_f32_16x16x32_bf16 v[44:47], v[88:91], a[72:75], v[44:47]
    ds_read_b64_tr_b16 v[74:75], v242 offset:2048
    s_add_u32 s67, s67, s65
    v_mfma_f32_16x16x32_bf16 v[44:47], v[92:95], a[76:79], v[44:47]
    s_lshl_b32 s67, s67, 10
    v_add_f32 v100, v100, v101
    v_mfma_f32_16x16x32_bf16 v[56:59], v[88:91], a[80:83], v[56:59]
    ds_read_b64_tr_b16 v[76:77], v242 offset:4096
    buffer_load_dwordx4 a[60:63], v248, s[56:59], s68 offen offset:1024 sc1
    v_mfma_f32_16x16x32_bf16 v[56:59], v[92:95], a[84:87], v[56:59]
    s_add_u32 s78, s67, 98304
    v_cvt_pk_bf16_f32 v100, v100, v100
    v_mfma_f32_16x16x32_bf16 v[60:63], v[88:91], a[88:91], v[60:63]
    ds_read_b64_tr_b16 v[78:79], v242 offset:6144
    s_add_u32 s68, s68, 8192
    v_mfma_f32_16x16x32_bf16 v[60:63], v[92:95], a[92:95], v[60:63]
    s_cmp_eq_u32 s68, s71
    s_cselect_b32 s76, 8192, 0
    s_add_u32 s68, s68, s76
    v_lshlrev_b32 v101, 16, v100
    s_waitcnt vmcnt(14) lgkmcnt(4)
    v_mfma_f32_16x16x32_bf16 v[0:3], v[64:67], a[0:3], v[0:3]
    ds_read_b64_tr_b16 v[80:81], v237 offset:256
    buffer_load_dwordx4 a[64:67], v245, s[56:59], s68 offen offset:0 sc1
    v_mfma_f32_16x16x32_bf16 v[0:3], v[68:71], a[4:7], v[0:3]
    v_add_f32 v101, 1.0, v101
    s_waitcnt vmcnt(13)
    v_mfma_f32_16x16x32_bf16 v[4:7], v[64:67], a[8:11], v[4:7]
    ds_read_b64_tr_b16 v[82:83], v237 offset:2304
    s_mul_i32 s3, s64, 655360
    v_mfma_f32_16x16x32_bf16 v[4:7], v[68:71], a[12:15], v[4:7]
    v_cvt_pk_bf16_f32 v101, v101, v101
    s_waitcnt vmcnt(11)
    v_mfma_f32_16x16x32_bf16 v[16:19], v[64:67], a[16:19], v[16:19]
    ds_read_b64_tr_b16 v[84:85], v237 offset:4352
    buffer_load_dwordx4 a[68:71], v247, s[56:59], s68 offen offset:0 sc1
    v_mfma_f32_16x16x32_bf16 v[16:19], v[68:71], a[20:23], v[16:19]
    s_cmp_eq_u32 s36, 2
    s_cselect_b64 vcc, -1, 0
    v_cndmask_b32 v211, v100, v101, vcc
    s_waitcnt vmcnt(10)
    v_mfma_f32_16x16x32_bf16 v[20:23], v[64:67], a[24:27], v[20:23]
    ds_read_b64_tr_b16 v[86:87], v237 offset:6400
    s_add_u32 s3, s3, 81920
    v_mfma_f32_16x16x32_bf16 v[20:23], v[68:71], a[28:31], v[20:23]
    s_add_u32 s3, s3, s66
    s_waitcnt lgkmcnt(4)
    v_mfma_f32_16x16x32_bf16 v[8:11], v[72:75], a[0:3], v[8:11]
    ds_read_b64_tr_b16 v[88:89], v242 offset:256
    buffer_load_dwordx4 a[72:75], v245, s[56:59], s68 offen offset:1024 sc1
    v_mfma_f32_16x16x32_bf16 v[8:11], v[76:79], a[4:7], v[8:11]
    s_lshl_b32 s65, s65, 5
    v_xor_b32 v255, s65, v255
    v_mfma_f32_16x16x32_bf16 v[12:15], v[72:75], a[8:11], v[12:15]
    ds_read_b64_tr_b16 v[90:91], v242 offset:2304
    s_lshl_b32 s64, s37, 7
    v_mfma_f32_16x16x32_bf16 v[12:15], v[76:79], a[12:15], v[12:15]
    v_and_b32 v215, 32, v239
    v_xor_b32 v255, v215, v255
    v_mfma_f32_16x16x32_bf16 v[24:27], v[72:75], a[16:19], v[24:27]
    ds_read_b64_tr_b16 v[92:93], v242 offset:4352
    buffer_load_dwordx4 a[76:79], v247, s[56:59], s68 offen offset:1024 sc1
    v_mfma_f32_16x16x32_bf16 v[24:27], v[76:79], a[20:23], v[24:27]
    s_add_u32 s48, s20, s64
    s_addc_u32 s49, s21, 0
    s_mov_b32 s50, 1409024
    v_mfma_f32_16x16x32_bf16 v[28:31], v[72:75], a[24:27], v[28:31]
    ds_read_b64_tr_b16 v[94:95], v242 offset:6400
    s_mov_b32 s51, 0x20000
    v_mfma_f32_16x16x32_bf16 v[28:31], v[76:79], a[28:31], v[28:31]
    s_sub_u32 s50, s50, s64
    s_waitcnt lgkmcnt(4)
    v_mfma_f32_16x16x32_bf16 v[32:35], v[80:83], a[0:3], v[32:35]
    ds_read_b64_tr_b16 v[64:65], v237 offset:16640
    buffer_load_dwordx4 a[80:83], v246, s[56:59], s68 offen offset:0 sc1
    v_mfma_f32_16x16x32_bf16 v[32:35], v[84:87], a[4:7], v[32:35]
    s_lshl_b32 s64, s35, 5
    s_add_u32 s64, s64, s38
    v_mfma_f32_16x16x32_bf16 v[36:39], v[80:83], a[8:11], v[36:39]
    ds_read_b64_tr_b16 v[66:67], v237 offset:18688
    s_lshl_b32 s14, s64, 13
    v_mfma_f32_16x16x32_bf16 v[36:39], v[84:87], a[12:15], v[36:39]
    s_lshr_b32 s39, s64, 2
    s_lshl_b32 s39, s39, 15
    v_mfma_f32_16x16x32_bf16 v[48:51], v[80:83], a[16:19], v[48:51]
    ds_read_b64_tr_b16 v[68:69], v237 offset:20736
    buffer_load_dwordx4 a[84:87], v248, s[56:59], s68 offen offset:0 sc1
    v_mfma_f32_16x16x32_bf16 v[48:51], v[84:87], a[20:23], v[48:51]
    s_load_dword s96, s[98:99], 20 glc
    s_and_b32 s65, s64, 3
    v_mfma_f32_16x16x32_bf16 v[52:55], v[80:83], a[24:27], v[52:55]
    ds_read_b64_tr_b16 v[70:71], v237 offset:22784
    s_lshl_b32 s65, s65, 7
    v_mfma_f32_16x16x32_bf16 v[52:55], v[84:87], a[28:31], v[52:55]
    s_add_u32 s39, s39, s65
    s_waitcnt lgkmcnt(4)
    v_mfma_f32_16x16x32_bf16 v[40:43], v[88:91], a[0:3], v[40:43]
    ds_read_b64_tr_b16 v[72:73], v242 offset:16640
    buffer_load_dwordx4 a[88:91], v246, s[56:59], s68 offen offset:1024 sc1
    v_mfma_f32_16x16x32_bf16 v[40:43], v[92:95], a[4:7], v[40:43]
    s_lshl_b32 s65, s34, 3
    v_and_b32 v231, 7, v239
    v_mfma_f32_16x16x32_bf16 v[44:47], v[88:91], a[8:11], v[44:47]
    ds_read_b64_tr_b16 v[74:75], v242 offset:18688
    v_lshrrev_b32 v208, 3, v239
    v_mfma_f32_16x16x32_bf16 v[44:47], v[92:95], a[12:15], v[44:47]
    v_add_u32 v208, s65, v208
    v_lshlrev_b32 v228, 9, v208
    v_mfma_f32_16x16x32_bf16 v[56:59], v[88:91], a[16:19], v[56:59]
    ds_read_b64_tr_b16 v[76:77], v242 offset:20736
    buffer_load_dwordx4 a[92:95], v248, s[56:59], s68 offen offset:1024 sc1
    v_mfma_f32_16x16x32_bf16 v[56:59], v[92:95], a[20:23], v[56:59]
    v_lshl_add_u32 v228, v231, 4, v228
    v_add_u32 v229, 0x4000, v228
    v_mfma_f32_16x16x32_bf16 v[60:63], v[88:91], a[24:27], v[60:63]
    ds_read_b64_tr_b16 v[78:79], v242 offset:22784
    s_add_u32 s68, s68, 8192
    v_mfma_f32_16x16x32_bf16 v[60:63], v[92:95], a[28:31], v[60:63]
    s_cmp_eq_u32 s68, s71
    s_cselect_b32 s76, 8192, 0
    s_add_u32 s68, s68, s76
    s_waitcnt vmcnt(14) lgkmcnt(4)
    v_mfma_f32_16x16x32_bf16 v[0:3], v[64:67], a[32:35], v[0:3]
    ds_read_b64_tr_b16 v[80:81], v237 offset:16896
    buffer_load_dwordx4 a[0:3], v245, s[56:59], s68 offen offset:0 sc1
    v_mfma_f32_16x16x32_bf16 v[0:3], v[68:71], a[36:39], v[0:3]
    v_lshlrev_b32 v230, 4, v208
    s_waitcnt vmcnt(13)
    v_mfma_f32_16x16x32_bf16 v[4:7], v[64:67], a[40:43], v[4:7]
    ds_read_b64_tr_b16 v[82:83], v237 offset:18944
    v_lshl_add_u32 v208, v231, 10, v230
    v_mfma_f32_16x16x32_bf16 v[4:7], v[68:71], a[44:47], v[4:7]
    v_lshlrev_b32 v209, 4, v231
    s_waitcnt vmcnt(11)
    v_mfma_f32_16x16x32_bf16 v[16:19], v[64:67], a[48:51], v[16:19]
    ds_read_b64_tr_b16 v[84:85], v237 offset:20992
    buffer_load_dwordx4 a[4:7], v247, s[56:59], s68 offen offset:0 sc1
    v_mfma_f32_16x16x32_bf16 v[16:19], v[68:71], a[52:55], v[16:19]
    v_lshrrev_b32 v212, 4, v239
    s_waitcnt vmcnt(10)
    v_mfma_f32_16x16x32_bf16 v[20:23], v[64:67], a[56:59], v[20:23]
    ds_read_b64_tr_b16 v[86:87], v237 offset:23040
    s_mov_b64 s[52:53], s[4:5]
    v_mfma_f32_16x16x32_bf16 v[20:23], v[68:71], a[60:63], v[20:23]
    v_lshlrev_b32 v212, 3, v212
    s_waitcnt lgkmcnt(4)
    v_mfma_f32_16x16x32_bf16 v[8:11], v[72:75], a[32:35], v[8:11]
    ds_read_b64_tr_b16 v[88:89], v242 offset:16896
    buffer_load_dwordx4 a[8:11], v245, s[56:59], s68 offen offset:1024 sc1
    v_mfma_f32_16x16x32_bf16 v[8:11], v[76:79], a[36:39], v[8:11]
    s_mov_b32 s54, 0x200000
    s_and_b32 s64, s38, 15
    v_mfma_f32_16x16x32_bf16 v[12:15], v[72:75], a[40:43], v[12:15]
    ds_read_b64_tr_b16 v[90:91], v242 offset:18944
    s_mul_i32 s64, s64, 192
    v_mfma_f32_16x16x32_bf16 v[12:15], v[76:79], a[44:47], v[12:15]
    s_add_u32 s60, s18, s64
    s_addc_u32 s61, s19, 0
    s_sub_u32 s62, 2752, s64
    v_mfma_f32_16x16x32_bf16 v[24:27], v[72:75], a[48:51], v[24:27]
    ds_read_b64_tr_b16 v[92:93], v242 offset:20992
    buffer_load_dwordx4 a[12:15], v247, s[56:59], s68 offen offset:1024 sc1
    v_mfma_f32_16x16x32_bf16 v[24:27], v[76:79], a[52:55], v[24:27]
    s_max_i32 s62, s62, 0
    s_lshl_b32 s15, s37, 7
    v_mfma_f32_16x16x32_bf16 v[28:31], v[72:75], a[56:59], v[28:31]
    ds_read_b64_tr_b16 v[94:95], v242 offset:23040
    v_mfma_f32_16x16x32_bf16 v[28:31], v[76:79], a[60:63], v[28:31]
    s_waitcnt lgkmcnt(4)
    v_mfma_f32_16x16x32_bf16 v[32:35], v[80:83], a[32:35], v[32:35]
    ds_read_b64_tr_b16 v[64:65], v237 offset:33280
    buffer_load_dwordx4 a[16:19], v246, s[56:59], s68 offen offset:0 sc1
    v_mfma_f32_16x16x32_bf16 v[32:35], v[84:87], a[36:39], v[32:35]
    v_mfma_f32_16x16x32_bf16 v[36:39], v[80:83], a[40:43], v[36:39]
    ds_read_b64_tr_b16 v[66:67], v237 offset:35328
    v_mfma_f32_16x16x32_bf16 v[36:39], v[84:87], a[44:47], v[36:39]
    v_mfma_f32_16x16x32_bf16 v[48:51], v[80:83], a[48:51], v[48:51]
    ds_read_b64_tr_b16 v[68:69], v237 offset:37376
    buffer_load_dwordx4 a[20:23], v248, s[56:59], s68 offen offset:0 sc1
    v_mfma_f32_16x16x32_bf16 v[48:51], v[84:87], a[52:55], v[48:51]
    v_mfma_f32_16x16x32_bf16 v[52:55], v[80:83], a[56:59], v[52:55]
    ds_read_b64_tr_b16 v[70:71], v237 offset:39424
    v_mfma_f32_16x16x32_bf16 v[52:55], v[84:87], a[60:63], v[52:55]
    s_waitcnt lgkmcnt(4)
    v_mfma_f32_16x16x32_bf16 v[40:43], v[88:91], a[32:35], v[40:43]
    ds_read_b64_tr_b16 v[72:73], v242 offset:33280
    buffer_load_dwordx4 a[24:27], v246, s[56:59], s68 offen offset:1024 sc1
    v_mfma_f32_16x16x32_bf16 v[40:43], v[92:95], a[36:39], v[40:43]
    v_mfma_f32_16x16x32_bf16 v[44:47], v[88:91], a[40:43], v[44:47]
    ds_read_b64_tr_b16 v[74:75], v242 offset:35328
    v_mfma_f32_16x16x32_bf16 v[44:47], v[92:95], a[44:47], v[44:47]
    v_mfma_f32_16x16x32_bf16 v[56:59], v[88:91], a[48:51], v[56:59]
    ds_read_b64_tr_b16 v[76:77], v242 offset:37376
    buffer_load_dwordx4 a[28:31], v248, s[56:59], s68 offen offset:1024 sc1
    s_waitcnt lgkmcnt(0)
    v_mfma_f32_16x16x32_bf16 v[56:59], v[92:95], a[52:55], v[56:59]
    s_cmp_ge_u32 s96, 8
    s_cbranch_scc1 L_pk6
    s_mov_b32 s97, 0
L_poll7:
    s_load_dword s96, s[98:99], 20 glc
    s_add_u32 s97, s97, 1
    s_cmp_gt_u32 s97, 200000
    s_cbranch_scc1 L_pout7
    s_waitcnt lgkmcnt(0)
    s_cmp_lt_u32 s96, 8
    s_cbranch_scc1 L_poll7
L_pout7:
    s_waitcnt lgkmcnt(0)
L_pk6:
    v_mfma_f32_16x16x32_bf16 v[60:63], v[88:91], a[56:59], v[60:63]
    ds_read_b64_tr_b16 v[78:79], v242 offset:39424
    s_add_u32 s71, s71, 4096
    v_mfma_f32_16x16x32_bf16 v[60:63], v[92:95], a[60:63], v[60:63]
    s_cmp_eq_u32 s37, 0
    s_cselect_b32 s68, 8192, 0
    s_add_u32 s68, s68, 4096
    s_waitcnt vmcnt(14)
    v_mfma_f32_16x16x32_bf16 v[0:3], v[64:67], a[64:67], v[0:3]
    ds_read_b64_tr_b16 v[80:81], v237 offset:33536
    buffer_load_dwordx4 a[32:35], v245, s[56:59], s68 offen offset:0 sc1
    v_mfma_f32_16x16x32_bf16 v[0:3], v[68:71], a[68:71], v[0:3]
    s_waitcnt vmcnt(13)
    v_mfma_f32_16x16x32_bf16 v[4:7], v[64:67], a[72:75], v[4:7]
    ds_read_b64_tr_b16 v[82:83], v237 offset:35584
    v_mfma_f32_16x16x32_bf16 v[4:7], v[68:71], a[76:79], v[4:7]
    s_waitcnt vmcnt(11)
    v_mfma_f32_16x16x32_bf16 v[16:19], v[64:67], a[80:83], v[16:19]
    ds_read_b64_tr_b16 v[84:85], v237 offset:37632
    buffer_load_dwordx4 a[36:39], v247, s[56:59], s68 offen offset:0 sc1
    v_mfma_f32_16x16x32_bf16 v[16:19], v[68:71], a[84:87], v[16:19]
    s_waitcnt vmcnt(10)
    v_mfma_f32_16x16x32_bf16 v[20:23], v[64:67], a[88:91], v[20:23]
    ds_read_b64_tr_b16 v[86:87], v237 offset:39680
    v_mfma_f32_16x16x32_bf16 v[20:23], v[68:71], a[92:95], v[20:23]
    s_waitcnt lgkmcnt(4)
    v_mfma_f32_16x16x32_bf16 v[8:11], v[72:75], a[64:67], v[8:11]
    ds_read_b64_tr_b16 v[88:89], v242 offset:33536
    buffer_load_dwordx4 a[40:43], v245, s[56:59], s68 offen offset:1024 sc1
    v_mfma_f32_16x16x32_bf16 v[8:11], v[76:79], a[68:71], v[8:11]
    v_mfma_f32_16x16x32_bf16 v[12:15], v[72:75], a[72:75], v[12:15]
    ds_read_b64_tr_b16 v[90:91], v242 offset:35584
    v_mfma_f32_16x16x32_bf16 v[12:15], v[76:79], a[76:79], v[12:15]
    v_mfma_f32_16x16x32_bf16 v[24:27], v[72:75], a[80:83], v[24:27]
    ds_read_b64_tr_b16 v[92:93], v242 offset:37632
    buffer_load_dwordx4 a[44:47], v247, s[56:59], s68 offen offset:1024 sc1
    v_mfma_f32_16x16x32_bf16 v[24:27], v[76:79], a[84:87], v[24:27]
    v_mfma_f32_16x16x32_bf16 v[28:31], v[72:75], a[88:91], v[28:31]
    ds_read_b64_tr_b16 v[94:95], v242 offset:39680
    v_mfma_f32_16x16x32_bf16 v[28:31], v[76:79], a[92:95], v[28:31]
    s_waitcnt lgkmcnt(4)
    v_mfma_f32_16x16x32_bf16 v[32:35], v[80:83], a[64:67], v[32:35]
    ds_read_b64_tr_b16 v[64:65], v238 offset:0
    buffer_load_dwordx4 a[48:51], v246, s[56:59], s68 offen offset:0 sc1
    v_mfma_f32_16x16x32_bf16 v[32:35], v[84:87], a[68:71], v[32:35]
    v_mfma_f32_16x16x32_bf16 v[36:39], v[80:83], a[72:75], v[36:39]
    ds_read_b64_tr_b16 v[66:67], v238 offset:2048
    v_mfma_f32_16x16x32_bf16 v[36:39], v[84:87], a[76:79], v[36:39]
    v_mfma_f32_16x16x32_bf16 v[48:51], v[80:83], a[80:83], v[48:51]
    ds_read_b64_tr_b16 v[68:69], v238 offset:4096
    buffer_load_dwordx4 a[52:55], v248, s[56:59], s68 offen offset:0 sc1
    v_mfma_f32_16x16x32_bf16 v[48:51], v[84:87], a[84:87], v[48:51]
    v_mfma_f32_16x16x32_bf16 v[52:55], v[80:83], a[88:91], v[52:55]
    ds_read_b64_tr_b16 v[70:71], v238 offset:6144
    v_mfma_f32_16x16x32_bf16 v[52:55], v[84:87], a[92:95], v[52:55]
    s_waitcnt lgkmcnt(4)
    v_mfma_f32_16x16x32_bf16 v[40:43], v[88:91], a[64:67], v[40:43]
    ds_read_b64_tr_b16 v[72:73], v243 offset:0
    buffer_load_dwordx4 a[56:59], v246, s[56:59], s68 offen offset:1024 sc1
    v_mfma_f32_16x16x32_bf16 v[40:43], v[92:95], a[68:71], v[40:43]
    v_mfma_f32_16x16x32_bf16 v[44:47], v[88:91], a[72:75], v[44:47]
    ds_read_b64_tr_b16 v[74:75], v243 offset:2048
    v_mfma_f32_16x16x32_bf16 v[44:47], v[92:95], a[76:79], v[44:47]
    v_mfma_f32_16x16x32_bf16 v[56:59], v[88:91], a[80:83], v[56:59]
    ds_read_b64_tr_b16 v[76:77], v243 offset:4096
    buffer_load_dwordx4 a[60:63], v248, s[56:59], s68 offen offset:1024 sc1
    v_mfma_f32_16x16x32_bf16 v[56:59], v[92:95], a[84:87], v[56:59]
    v_mfma_f32_16x16x32_bf16 v[60:63], v[88:91], a[88:91], v[60:63]
    ds_read_b64_tr_b16 v[78:79], v243 offset:6144
    s_add_u32 s68, s68, 8192
    v_mfma_f32_16x16x32_bf16 v[60:63], v[92:95], a[92:95], v[60:63]
    s_cmp_eq_u32 s68, s71
    s_cselect_b32 s76, 8192, 0
    s_add_u32 s68, s68, s76
    s_waitcnt vmcnt(14) lgkmcnt(4)
    v_mfma_f32_16x16x32_bf16 v[0:3], v[64:67], a[0:3], v[0:3]
    ds_read_b64_tr_b16 v[80:81], v238 offset:256
    buffer_load_dwordx4 a[64:67], v245, s[56:59], s68 offen offset:0 sc1
    v_mfma_f32_16x16x32_bf16 v[0:3], v[68:71], a[4:7], v[0:3]
    s_waitcnt vmcnt(13)
    v_mfma_f32_16x16x32_bf16 v[4:7], v[64:67], a[8:11], v[4:7]
    ds_read_b64_tr_b16 v[82:83], v238 offset:2304
    v_mfma_f32_16x16x32_bf16 v[4:7], v[68:71], a[12:15], v[4:7]
    s_waitcnt vmcnt(11)
    v_mfma_f32_16x16x32_bf16 v[16:19], v[64:67], a[16:19], v[16:19]
    ds_read_b64_tr_b16 v[84:85], v238 offset:4352
    buffer_load_dwordx4 a[68:71], v247, s[56:59], s68 offen offset:0 sc1
    v_mfma_f32_16x16x32_bf16 v[16:19], v[68:71], a[20:23], v[16:19]
    s_waitcnt vmcnt(10)
    v_mfma_f32_16x16x32_bf16 v[20:23], v[64:67], a[24:27], v[20:23]
    ds_read_b64_tr_b16 v[86:87], v238 offset:6400
    v_mfma_f32_16x16x32_bf16 v[20:23], v[68:71], a[28:31], v[20:23]
    s_waitcnt lgkmcnt(4)
    v_mfma_f32_16x16x32_bf16 v[8:11], v[72:75], a[0:3], v[8:11]
    ds_read_b64_tr_b16 v[88:89], v243 offset:256
    buffer_load_dwordx4 a[72:75], v245, s[56:59], s68 offen offset:1024 sc1
    v_mfma_f32_16x16x32_bf16 v[8:11], v[76:79], a[4:7], v[8:11]
    v_mfma_f32_16x16x32_bf16 v[12:15], v[72:75], a[8:11], v[12:15]
    ds_read_b64_tr_b16 v[90:91], v243 offset:2304
    v_mfma_f32_16x16x32_bf16 v[12:15], v[76:79], a[12:15], v[12:15]
    v_mfma_f32_16x16x32_bf16 v[24:27], v[72:75], a[16:19], v[24:27]
    ds_read_b64_tr_b16 v[92:93], v243 offset:4352
    buffer_load_dwordx4 a[76:79], v247, s[56:59], s68 offen offset:1024 sc1
    v_mfma_f32_16x16x32_bf16 v[24:27], v[76:79], a[20:23], v[24:27]
    v_mfma_f32_16x16x32_bf16 v[28:31], v[72:75], a[24:27], v[28:31]
    ds_read_b64_tr_b16 v[94:95], v243 offset:6400
    v_mfma_f32_16x16x32_bf16 v[28:31], v[76:79], a[28:31], v[28:31]
    s_waitcnt lgkmcnt(4)
    v_mfma_f32_16x16x32_bf16 v[32:35], v[80:83], a[0:3], v[32:35]
    ds_read_b64_tr_b16 v[64:65], v236 offset:8192
    buffer_load_dwordx4 a[80:83], v246, s[56:59], s68 offen offset:0 sc1
    v_mfma_f32_16x16x32_bf16 v[32:35], v[84:87], a[4:7], v[32:35]
    v_mfma_f32_16x16x32_bf16 v[36:39], v[80:83], a[8:11], v[36:39]
    ds_read_b64_tr_b16 v[66:67], v236 offset:10240
    v_mfma_f32_16x16x32_bf16 v[36:39], v[84:87], a[12:15], v[36:39]
    v_mfma_f32_16x16x32_bf16 v[48:51], v[80:83], a[16:19], v[48:51]
    ds_read_b64_tr_b16 v[68:69], v236 offset:12288
    buffer_load_dwordx4 a[84:87], v248, s[56:59], s68 offen offset:0 sc1
    v_mfma_f32_16x16x32_bf16 v[48:51], v[84:87], a[20:23], v[48:51]
    v_mfma_f32_16x16x32_bf16 v[52:55], v[80:83], a[24:27], v[52:55]
    ds_read_b64_tr_b16 v[70:71], v236 offset:14336
    v_mfma_f32_16x16x32_bf16 v[52:55], v[84:87], a[28:31], v[52:55]
    s_waitcnt lgkmcnt(4)
    v_mfma_f32_16x16x32_bf16 v[40:43], v[88:91], a[0:3], v[40:43]
    ds_read_b64_tr_b16 v[72:73], v241 offset:8192
    buffer_load_dwordx4 a[88:91], v246, s[56:59], s68 offen offset:1024 sc1
    v_mfma_f32_16x16x32_bf16 v[40:43], v[92:95], a[4:7], v[40:43]
    v_mfma_f32_16x16x32_bf16 v[44:47], v[88:91], a[8:11], v[44:47]
    ds_read_b64_tr_b16 v[74:75], v241 offset:10240
    v_mfma_f32_16x16x32_bf16 v[44:47], v[92:95], a[12:15], v[44:47]
    v_mfma_f32_16x16x32_bf16 v[56:59], v[88:91], a[16:19], v[56:59]
    ds_read_b64_tr_b16 v[76:77], v241 offset:12288
    buffer_load_dwordx4 a[92:95], v248, s[56:59], s68 offen offset:1024 sc1
    v_mfma_f32_16x16x32_bf16 v[56:59], v[92:95], a[20:23], v[56:59]
    v_mfma_f32_16x16x32_bf16 v[60:63], v[88:91], a[24:27], v[60:63]
    ds_read_b64_tr_b16 v[78:79], v241 offset:14336
    s_add_u32 s68, s68, 8192
    v_mfma_f32_16x16x32_bf16 v[60:63], v[92:95], a[28:31], v[60:63]
    s_cmp_eq_u32 s68, s71
    s_cselect_b32 s76, 8192, 0
    s_add_u32 s68, s68, s76
    s_waitcnt vmcnt(14) lgkmcnt(4)
    v_mfma_f32_16x16x32_bf16 v[0:3], v[64:67], a[32:35], v[0:3]
    ds_read_b64_tr_b16 v[80:81], v236 offset:8448
    buffer_load_dwordx4 a[0:3], v245, s[56:59], s68 offen offset:0 sc1
    v_mfma_f32_16x16x32_bf16 v[0:3], v[68:71], a[36:39], v[0:3]
    s_waitcnt vmcnt(13)
    v_mfma_f32_16x16x32_bf16 v[4:7], v[64:67], a[40:43], v[4:7]
    ds_read_b64_tr_b16 v[82:83], v236 offset:10496
    v_mfma_f32_16x16x32_bf16 v[4:7], v[68:71], a[44:47], v[4:7]
    s_waitcnt vmcnt(11)
    v_mfma_f32_16x16x32_bf16 v[16:19], v[64:67], a[48:51], v[16:19]
    ds_read_b64_tr_b16 v[84:85], v236 offset:12544
    buffer_load_dwordx4 a[4:7], v247, s[56:59], s68 offen offset:0 sc1
    v_mfma_f32_16x16x32_bf16 v[16:19], v[68:71], a[52:55], v[16:19]
    s_waitcnt vmcnt(10)
    v_mfma_f32_16x16x32_bf16 v[20:23], v[64:67], a[56:59], v[20:23]
    ds_read_b64_tr_b16 v[86:87], v236 offset:14592
    v_mfma_f32_16x16x32_bf16 v[20:23], v[68:71], a[60:63], v[20:23]
    s_waitcnt lgkmcnt(4)
    v_mfma_f32_16x16x32_bf16 v[8:11], v[72:75], a[32:35], v[8:11]
    ds_read_b64_tr_b16 v[88:89], v241 offset:8448
    buffer_load_dwordx4 a[8:11], v245, s[56:59], s68 offen offset:1024 sc1
    v_mfma_f32_16x16x32_bf16 v[8:11], v[76:79], a[36:39], v[8:11]
    v_mfma_f32_16x16x32_bf16 v[12:15], v[72:75], a[40:43], v[12:15]
    ds_read_b64_tr_b16 v[90:91], v241 offset:10496
    v_mfma_f32_16x16x32_bf16 v[12:15], v[76:79], a[44:47], v[12:15]
    v_mfma_f32_16x16x32_bf16 v[24:27], v[72:75], a[48:51], v[24:27]
    ds_read_b64_tr_b16 v[92:93], v241 offset:12544
    buffer_load_dwordx4 a[12:15], v247, s[56:59], s68 offen offset:1024 sc1
    v_mfma_f32_16x16x32_bf16 v[24:27], v[76:79], a[52:55], v[24:27]
    v_mfma_f32_16x16x32_bf16 v[28:31], v[72:75], a[56:59], v[28:31]
    ds_read_b64_tr_b16 v[94:95], v241 offset:14592
    v_mfma_f32_16x16x32_bf16 v[28:31], v[76:79], a[60:63], v[28:31]
    s_waitcnt lgkmcnt(4)
    v_mfma_f32_16x16x32_bf16 v[32:35], v[80:83], a[32:35], v[32:35]
    ds_read_b64_tr_b16 v[64:65], v236 offset:24832
    buffer_load_dwordx4 a[16:19], v246, s[56:59], s68 offen offset:0 sc1
    v_mfma_f32_16x16x32_bf16 v[32:35], v[84:87], a[36:39], v[32:35]
    v_mfma_f32_16x16x32_bf16 v[36:39], v[80:83], a[40:43], v[36:39]
    ds_read_b64_tr_b16 v[66:67], v236 offset:26880
    v_mfma_f32_16x16x32_bf16 v[36:39], v[84:87], a[44:47], v[36:39]
    v_mfma_f32_16x16x32_bf16 v[48:51], v[80:83], a[48:51], v[48:51]
    ds_read_b64_tr_b16 v[68:69], v236 offset:28928
    buffer_load_dwordx4 a[20:23], v248, s[56:59], s68 offen offset:0 sc1
    v_mfma_f32_16x16x32_bf16 v[48:51], v[84:87], a[52:55], v[48:51]
    v_mfma_f32_16x16x32_bf16 v[52:55], v[80:83], a[56:59], v[52:55]
    ds_read_b64_tr_b16 v[70:71], v236 offset:30976
    v_mfma_f32_16x16x32_bf16 v[52:55], v[84:87], a[60:63], v[52:55]
    s_waitcnt lgkmcnt(4)
    v_mfma_f32_16x16x32_bf16 v[40:43], v[88:91], a[32:35], v[40:43]
    ds_read_b64_tr_b16 v[72:73], v241 offset:24832
    buffer_load_dwordx4 a[24:27], v246, s[56:59], s68 offen offset:1024 sc1
    v_mfma_f32_16x16x32_bf16 v[40:43], v[92:95], a[36:39], v[40:43]
    v_mfma_f32_16x16x32_bf16 v[44:47], v[88:91], a[40:43], v[44:47]
    ds_read_b64_tr_b16 v[74:75], v241 offset:26880
    v_mfma_f32_16x16x32_bf16 v[44:47], v[92:95], a[44:47], v[44:47]
    v_mfma_f32_16x16x32_bf16 v[56:59], v[88:91], a[48:51], v[56:59]
    ds_read_b64_tr_b16 v[76:77], v241 offset:28928
    buffer_load_dwordx4 a[28:31], v248, s[56:59], s68 offen offset:1024 sc1
    v_mfma_f32_16x16x32_bf16 v[56:59], v[92:95], a[52:55], v[56:59]
    v_mfma_f32_16x16x32_bf16 v[60:63], v[88:91], a[56:59], v[60:63]
    ds_read_b64_tr_b16 v[78:79], v241 offset:30976
    s_add_u32 s68, s68, 8192
    v_mfma_f32_16x16x32_bf16 v[60:63], v[92:95], a[60:63], v[60:63]
    s_cmp_eq_u32 s68, s71
    s_cselect_b32 s76, 8192, 0
    s_add_u32 s68, s68, s76
    s_waitcnt vmcnt(14) lgkmcnt(4)
    v_mfma_f32_16x16x32_bf16 v[0:3], v[64:67], a[64:67], v[0:3]
    ds_read_b64_tr_b16 v[80:81], v236 offset:25088
    buffer_load_dwordx4 a[32:35], v245, s[56:59], s68 offen offset:0 sc1
    v_mfma_f32_16x16x32_bf16 v[0:3], v[68:71], a[68:71], v[0:3]
    s_waitcnt vmcnt(13)
    v_mfma_f32_16x16x32_bf16 v[4:7], v[64:67], a[72:75], v[4:7]
    ds_read_b64_tr_b16 v[82:83], v236 offset:27136
    v_mfma_f32_16x16x32_bf16 v[4:7], v[68:71], a[76:79], v[4:7]
    s_waitcnt vmcnt(11)
    v_mfma_f32_16x16x32_bf16 v[16:19], v[64:67], a[80:83], v[16:19]
    ds_read_b64_tr_b16 v[84:85], v236 offset:29184
    buffer_load_dwordx4 a[36:39], v247, s[56:59], s68 offen offset:0 sc1
    v_mfma_f32_16x16x32_bf16 v[16:19], v[68:71], a[84:87], v[16:19]
    s_waitcnt vmcnt(10)
    v_mfma_f32_16x16x32_bf16 v[20:23], v[64:67], a[88:91], v[20:23]
    ds_read_b64_tr_b16 v[86:87], v236 offset:31232
    v_mfma_f32_16x16x32_bf16 v[20:23], v[68:71], a[92:95], v[20:23]
    s_waitcnt lgkmcnt(4)
    v_mfma_f32_16x16x32_bf16 v[8:11], v[72:75], a[64:67], v[8:11]
    ds_read_b64_tr_b16 v[88:89], v241 offset:25088
    buffer_load_dwordx4 a[40:43], v245, s[56:59], s68 offen offset:1024 sc1
    v_mfma_f32_16x16x32_bf16 v[8:11], v[76:79], a[68:71], v[8:11]
    v_mfma_f32_16x16x32_bf16 v[12:15], v[72:75], a[72:75], v[12:15]
    ds_read_b64_tr_b16 v[90:91], v241 offset:27136
    v_mfma_f32_16x16x32_bf16 v[12:15], v[76:79], a[76:79], v[12:15]
    v_mfma_f32_16x16x32_bf16 v[24:27], v[72:75], a[80:83], v[24:27]
    ds_read_b64_tr_b16 v[92:93], v241 offset:29184
    buffer_load_dwordx4 a[44:47], v247, s[56:59], s68 offen offset:1024 sc1
    v_mfma_f32_16x16x32_bf16 v[24:27], v[76:79], a[84:87], v[24:27]
    v_mfma_f32_16x16x32_bf16 v[28:31], v[72:75], a[88:91], v[28:31]
    ds_read_b64_tr_b16 v[94:95], v241 offset:31232
    v_mfma_f32_16x16x32_bf16 v[28:31], v[76:79], a[92:95], v[28:31]
    s_waitcnt lgkmcnt(4)
    v_mfma_f32_16x16x32_bf16 v[32:35], v[80:83], a[64:67], v[32:35]
    ds_read_b64_tr_b16 v[64:65], v236 offset:41472
    buffer_load_dwordx4 a[48:51], v246, s[56:59], s68 offen offset:0 sc1
    v_mfma_f32_16x16x32_bf16 v[32:35], v[84:87], a[68:71], v[32:35]
    v_mfma_f32_16x16x32_bf16 v[36:39], v[80:83], a[72:75], v[36:39]
    ds_read_b64_tr_b16 v[66:67], v236 offset:43520
    v_mfma_f32_16x16x32_bf16 v[36:39], v[84:87], a[76:79], v[36:39]
    v_mfma_f32_16x16x32_bf16 v[48:51], v[80:83], a[80:83], v[48:51]
    ds_read_b64_tr_b16 v[68:69], v236 offset:45568
    buffer_load_dwordx4 a[52:55], v248, s[56:59], s68 offen offset:0 sc1
    v_mfma_f32_16x16x32_bf16 v[48:51], v[84:87], a[84:87], v[48:51]
    v_mfma_f32_16x16x32_bf16 v[52:55], v[80:83], a[88:91], v[52:55]
    ds_read_b64_tr_b16 v[70:71], v236 offset:47616
    v_mfma_f32_16x16x32_bf16 v[52:55], v[84:87], a[92:95], v[52:55]
    s_waitcnt lgkmcnt(4)
    v_mfma_f32_16x16x32_bf16 v[40:43], v[88:91], a[64:67], v[40:43]
    ds_read_b64_tr_b16 v[72:73], v241 offset:41472
    buffer_load_dwordx4 a[56:59], v246, s[56:59], s68 offen offset:1024 sc1
    v_mfma_f32_16x16x32_bf16 v[40:43], v[92:95], a[68:71], v[40:43]
    v_mfma_f32_16x16x32_bf16 v[44:47], v[88:91], a[72:75], v[44:47]
    ds_read_b64_tr_b16 v[74:75], v241 offset:43520
    v_mfma_f32_16x16x32_bf16 v[44:47], v[92:95], a[76:79], v[44:47]
    v_mfma_f32_16x16x32_bf16 v[56:59], v[88:91], a[80:83], v[56:59]
    ds_read_b64_tr_b16 v[76:77], v241 offset:45568
    buffer_load_dwordx4 a[60:63], v248, s[56:59], s68 offen offset:1024 sc1
    v_mfma_f32_16x16x32_bf16 v[56:59], v[92:95], a[84:87], v[56:59]
    v_mfma_f32_16x16x32_bf16 v[60:63], v[88:91], a[88:91], v[60:63]
    ds_read_b64_tr_b16 v[78:79], v241 offset:47616
    s_add_u32 s68, s68, 8192
    v_mfma_f32_16x16x32_bf16 v[60:63], v[92:95], a[92:95], v[60:63]
    s_cmp_eq_u32 s68, s71
    s_cselect_b32 s76, 8192, 0
    s_add_u32 s68, s68, s76
    s_waitcnt vmcnt(14) lgkmcnt(4)
    v_mfma_f32_16x16x32_bf16 v[0:3], v[64:67], a[0:3], v[0:3]
    ds_read_b64_tr_b16 v[80:81], v236 offset:41728
    buffer_load_dwordx4 a[64:67], v245, s[56:59], s68 offen offset:0 sc1
    v_mfma_f32_16x16x32_bf16 v[0:3], v[68:71], a[4:7], v[0:3]
    s_waitcnt vmcnt(13)
    v_mfma_f32_16x16x32_bf16 v[4:7], v[64:67], a[8:11], v[4:7]
    ds_read_b64_tr_b16 v[82:83], v236 offset:43776
    v_mfma_f32_16x16x32_bf16 v[4:7], v[68:71], a[12:15], v[4:7]
    s_waitcnt vmcnt(11)
    v_mfma_f32_16x16x32_bf16 v[16:19], v[64:67], a[16:19], v[16:19]
    ds_read_b64_tr_b16 v[84:85], v236 offset:45824
    buffer_load_dwordx4 a[68:71], v247, s[56:59], s68 offen offset:0 sc1
    v_mfma_f32_16x16x32_bf16 v[16:19], v[68:71], a[20:23], v[16:19]
    s_waitcnt vmcnt(10)
    v_mfma_f32_16x16x32_bf16 v[20:23], v[64:67], a[24:27], v[20:23]
    ds_read_b64_tr_b16 v[86:87], v236 offset:47872
    v_mfma_f32_16x16x32_bf16 v[20:23], v[68:71], a[28:31], v[20:23]
    s_waitcnt lgkmcnt(4)
    v_mfma_f32_16x16x32_bf16 v[8:11], v[72:75], a[0:3], v[8:11]
    ds_read_b64_tr_b16 v[88:89], v241 offset:41728
    buffer_load_dwordx4 a[72:75], v245, s[56:59], s68 offen offset:1024 sc1
    v_mfma_f32_16x16x32_bf16 v[8:11], v[76:79], a[4:7], v[8:11]
    v_mfma_f32_16x16x32_bf16 v[12:15], v[72:75], a[8:11], v[12:15]
    ds_read_b64_tr_b16 v[90:91], v241 offset:43776
    v_mfma_f32_16x16x32_bf16 v[12:15], v[76:79], a[12:15], v[12:15]
    v_mfma_f32_16x16x32_bf16 v[24:27], v[72:75], a[16:19], v[24:27]
L_pad8:
    s_cbranch_execz L_warmed1
    ds_read_b64_tr_b16 v[92:93], v241 offset:45824
    buffer_load_dwordx4 a[76:79], v247, s[56:59], s68 offen offset:1024 sc1
    v_mfma_f32_16x16x32_bf16 v[24:27], v[76:79], a[20:23], v[24:27]
    v_mfma_f32_16x16x32_bf16 v[28:31], v[72:75], a[24:27], v[28:31]
    ds_read_b64_tr_b16 v[94:95], v241 offset:47872
    v_mfma_f32_16x16x32_bf16 v[28:31], v[76:79], a[28:31], v[28:31]
    s_waitcnt lgkmcnt(4)
    v_mfma_f32_16x16x32_bf16 v[32:35], v[80:83], a[0:3], v[32:35]
    ds_read_b64_tr_b16 v[64:65], v237 offset:8192
    buffer_load_dwordx4 a[80:83], v246, s[56:59], s68 offen offset:0 sc1
    v_mfma_f32_16x16x32_bf16 v[32:35], v[84:87], a[4:7], v[32:35]
    v_mfma_f32_16x16x32_bf16 v[36:39], v[80:83], a[8:11], v[36:39]
    ds_read_b64_tr_b16 v[66:67], v237 offset:10240
    v_mfma_f32_16x16x32_bf16 v[36:39], v[84:87], a[12:15], v[36:39]
    v_mfma_f32_16x16x32_bf16 v[48:51], v[80:83], a[16:19], v[48:51]
    ds_read_b64_tr_b16 v[68:69], v237 offset:12288
    buffer_load_dwordx4 a[84:87], v248, s[56:59], s68 offen offset:0 sc1
    v_mfma_f32_16x16x32_bf16 v[48:51], v[84:87], a[20:23], v[48:51]
    v_mfma_f32_16x16x32_bf16 v[52:55], v[80:83], a[24:27], v[52:55]
    ds_read_b64_tr_b16 v[70:71], v237 offset:14336
    v_mfma_f32_16x16x32_bf16 v[52:55], v[84:87], a[28:31], v[52:55]
    s_waitcnt lgkmcnt(4)
    v_mfma_f32_16x16x32_bf16 v[40:43], v[88:91], a[0:3], v[40:43]
    ds_read_b64_tr_b16 v[72:73], v242 offset:8192
    buffer_load_dwordx4 a[88:91], v246, s[56:59], s68 offen offset:1024 sc1
    v_mfma_f32_16x16x32_bf16 v[40:43], v[92:95], a[4:7], v[40:43]
    v_mfma_f32_16x16x32_bf16 v[44:47], v[88:91], a[8:11], v[44:47]
    ds_read_b64_tr_b16 v[74:75], v242 offset:10240
    v_mfma_f32_16x16x32_bf16 v[44:47], v[92:95], a[12:15], v[44:47]
    v_mfma_f32_16x16x32_bf16 v[56:59], v[88:91], a[16:19], v[56:59]
    ds_read_b64_tr_b16 v[76:77], v242 offset:12288
    buffer_load_dwordx4 a[92:95], v248, s[56:59], s68 offen offset:1024 sc1
    v_mfma_f32_16x16x32_bf16 v[56:59], v[92:95], a[20:23], v[56:59]
    v_mfma_f32_16x16x32_bf16 v[60:63], v[88:91], a[24:27], v[60:63]
    ds_read_b64_tr_b16 v[78:79], v242 offset:14336
    s_add_u32 s68, s68, 8192
    v_mfma_f32_16x16x32_bf16 v[60:63], v[92:95], a[28:31], v[60:63]
    s_cmp_eq_u32 s68, s71
    s_cselect_b32 s76, 8192, 0
    s_add_u32 s68, s68, s76
    s_waitcnt vmcnt(14) lgkmcnt(4)
    v_mfma_f32_16x16x32_bf16 v[0:3], v[64:67], a[32:35], v[0:3]
    ds_read_b64_tr_b16 v[80:81], v237 offset:8448
    buffer_load_dwordx4 a[0:3], v245, s[56:59], s68 offen offset:0 sc1
    v_mfma_f32_16x16x32_bf16 v[0:3], v[68:71], a[36:39], v[0:3]
    s_waitcnt vmcnt(13)
    v_mfma_f32_16x16x32_bf16 v[4:7], v[64:67], a[40:43], v[4:7]
    ds_read_b64_tr_b16 v[82:83], v237 offset:10496
    v_mfma_f32_16x16x32_bf16 v[4:7], v[68:71], a[44:47], v[4:7]
    s_waitcnt vmcnt(11)
    v_mfma_f32_16x16x32_bf16 v[16:19], v[64:67], a[48:51], v[16:19]
    ds_read_b64_tr_b16 v[84:85], v237 offset:12544
    buffer_load_dwordx4 a[4:7], v247, s[56:59], s68 offen offset:0 sc1
    v_mfma_f32_16x16x32_bf16 v[16:19], v[68:71], a[52:55], v[16:19]
    s_waitcnt vmcnt(10)
    v_mfma_f32_16x16x32_bf16 v[20:23], v[64:67], a[56:59], v[20:23]
    ds_read_b64_tr_b16 v[86:87], v237 offset:14592
    v_mfma_f32_16x16x32_bf16 v[20:23], v[68:71], a[60:63], v[20:23]
    s_waitcnt lgkmcnt(4)
    v_mfma_f32_16x16x32_bf16 v[8:11], v[72:75], a[32:35], v[8:11]
    ds_read_b64_tr_b16 v[88:89], v242 offset:8448
    buffer_load_dwordx4 a[8:11], v245, s[56:59], s68 offen offset:1024 sc1
    v_mfma_f32_16x16x32_bf16 v[8:11], v[76:79], a[36:39], v[8:11]
    v_mfma_f32_16x16x32_bf16 v[12:15], v[72:75], a[40:43], v[12:15]
    ds_read_b64_tr_b16 v[90:91], v242 offset:10496
    v_mfma_f32_16x16x32_bf16 v[12:15], v[76:79], a[44:47], v[12:15]
    v_mfma_f32_16x16x32_bf16 v[24:27], v[72:75], a[48:51], v[24:27]
    ds_read_b64_tr_b16 v[92:93], v242 offset:12544
    buffer_load_dwordx4 a[12:15], v247, s[56:59], s68 offen offset:1024 sc1
    v_mfma_f32_16x16x32_bf16 v[24:27], v[76:79], a[52:55], v[24:27]
    v_mfma_f32_16x16x32_bf16 v[28:31], v[72:75], a[56:59], v[28:31]
    ds_read_b64_tr_b16 v[94:95], v242 offset:14592
    v_mfma_f32_16x16x32_bf16 v[28:31], v[76:79], a[60:63], v[28:31]
    s_waitcnt lgkmcnt(4)
    v_mfma_f32_16x16x32_bf16 v[32:35], v[80:83], a[32:35], v[32:35]
    ds_read_b64_tr_b16 v[64:65], v237 offset:24832
    buffer_load_dwordx4 a[16:19], v246, s[56:59], s68 offen offset:0 sc1
    v_mfma_f32_16x16x32_bf16 v[32:35], v[84:87], a[36:39], v[32:35]
    v_mfma_f32_16x16x32_bf16 v[36:39], v[80:83], a[40:43], v[36:39]
    ds_read_b64_tr_b16 v[66:67], v237 offset:26880
    v_mfma_f32_16x16x32_bf16 v[36:39], v[84:87], a[44:47], v[36:39]
    v_mfma_f32_16x16x32_bf16 v[48:51], v[80:83], a[48:51], v[48:51]
    ds_read_b64_tr_b16 v[68:69], v237 offset:28928
    buffer_load_dwordx4 a[20:23], v248, s[56:59], s68 offen offset:0 sc1
    v_mfma_f32_16x16x32_bf16 v[48:51], v[84:87], a[52:55], v[48:51]
    v_mfma_f32_16x16x32_bf16 v[52:55], v[80:83], a[56:59], v[52:55]
    ds_read_b64_tr_b16 v[70:71], v237 offset:30976
    v_mfma_f32_16x16x32_bf16 v[52:55], v[84:87], a[60:63], v[52:55]
    s_waitcnt lgkmcnt(4)
    v_mfma_f32_16x16x32_bf16 v[40:43], v[88:91], a[32:35], v[40:43]
    ds_read_b64_tr_b16 v[72:73], v242 offset:24832
    buffer_load_dwordx4 a[24:27], v246, s[56:59], s68 offen offset:1024 sc1
    v_mfma_f32_16x16x32_bf16 v[40:43], v[92:95], a[36:39], v[40:43]
    v_mfma_f32_16x16x32_bf16 v[44:47], v[88:91], a[40:43], v[44:47]
    ds_read_b64_tr_b16 v[74:75], v242 offset:26880
    v_mfma_f32_16x16x32_bf16 v[44:47], v[92:95], a[44:47], v[44:47]
    v_mfma_f32_16x16x32_bf16 v[56:59], v[88:91], a[48:51], v[56:59]
    ds_read_b64_tr_b16 v[76:77], v242 offset:28928
    buffer_load_dwordx4 a[28:31], v248, s[56:59], s68 offen offset:1024 sc1
    v_mfma_f32_16x16x32_bf16 v[56:59], v[92:95], a[52:55], v[56:59]
    v_mfma_f32_16x16x32_bf16 v[60:63], v[88:91], a[56:59], v[60:63]
    ds_read_b64_tr_b16 v[78:79], v242 offset:30976
    s_add_u32 s68, s68, 8192
    v_mfma_f32_16x16x32_bf16 v[60:63], v[92:95], a[60:63], v[60:63]
    s_cmp_eq_u32 s68, s71
    s_cselect_b32 s76, 8192, 0
    s_add_u32 s68, s68, s76
    s_waitcnt vmcnt(14) lgkmcnt(4)
    v_mfma_f32_16x16x32_bf16 v[0:3], v[64:67], a[64:67], v[0:3]
    ds_read_b64_tr_b16 v[80:81], v237 offset:25088
    buffer_load_dwordx4 a[32:35], v245, s[56:59], s68 offen offset:0 sc1
    v_mfma_f32_16x16x32_bf16 v[0:3], v[68:71], a[68:71], v[0:3]
    s_waitcnt vmcnt(13)
    v_mfma_f32_16x16x32_bf16 v[4:7], v[64:67], a[72:75], v[4:7]
    ds_read_b64_tr_b16 v[82:83], v237 offset:27136
    v_mfma_f32_16x16x32_bf16 v[4:7], v[68:71], a[76:79], v[4:7]
    s_waitcnt vmcnt(11)
    v_mfma_f32_16x16x32_bf16 v[16:19], v[64:67], a[80:83], v[16:19]
    ds_read_b64_tr_b16 v[84:85], v237 offset:29184
    buffer_load_dwordx4 a[36:39], v247, s[56:59], s68 offen offset:0 sc1
    v_mfma_f32_16x16x32_bf16 v[16:19], v[68:71], a[84:87], v[16:19]
    s_waitcnt vmcnt(10)
    v_mfma_f32_16x16x32_bf16 v[20:23], v[64:67], a[88:91], v[20:23]
    ds_read_b64_tr_b16 v[86:87], v237 offset:31232
    v_mfma_f32_16x16x32_bf16 v[20:23], v[68:71], a[92:95], v[20:23]
    s_waitcnt lgkmcnt(4)
    v_mfma_f32_16x16x32_bf16 v[8:11], v[72:75], a[64:67], v[8:11]
    ds_read_b64_tr_b16 v[88:89], v242 offset:25088
    buffer_load_dwordx4 a[40:43], v245, s[56:59], s68 offen offset:1024 sc1
    v_mfma_f32_16x16x32_bf16 v[8:11], v[76:79], a[68:71], v[8:11]
    v_mfma_f32_16x16x32_bf16 v[12:15], v[72:75], a[72:75], v[12:15]
    ds_read_b64_tr_b16 v[90:91], v242 offset:27136
    v_mfma_f32_16x16x32_bf16 v[12:15], v[76:79], a[76:79], v[12:15]
    v_mfma_f32_16x16x32_bf16 v[24:27], v[72:75], a[80:83], v[24:27]
    ds_read_b64_tr_b16 v[92:93], v242 offset:29184
    buffer_load_dwordx4 a[44:47], v247, s[56:59], s68 offen offset:1024 sc1
    v_mfma_f32_16x16x32_bf16 v[24:27], v[76:79], a[84:87], v[24:27]
    v_mfma_f32_16x16x32_bf16 v[28:31], v[72:75], a[88:91], v[28:31]
    ds_read_b64_tr_b16 v[94:95], v242 offset:31232
    v_mfma_f32_16x16x32_bf16 v[28:31], v[76:79], a[92:95], v[28:31]
    s_waitcnt lgkmcnt(4)
    v_mfma_f32_16x16x32_bf16 v[32:35], v[80:83], a[64:67], v[32:35]
    ds_read_b64_tr_b16 v[64:65], v237 offset:41472
    buffer_load_dwordx4 a[48:51], v246, s[56:59], s68 offen offset:0 sc1
    v_mfma_f32_16x16x32_bf16 v[32:35], v[84:87], a[68:71], v[32:35]
    v_mfma_f32_16x16x32_bf16 v[36:39], v[80:83], a[72:75], v[36:39]
    ds_read_b64_tr_b16 v[66:67], v237 offset:43520
    v_mfma_f32_16x16x32_bf16 v[36:39], v[84:87], a[76:79], v[36:39]
    v_mfma_f32_16x16x32_bf16 v[48:51], v[80:83], a[80:83], v[48:51]
    ds_read_b64_tr_b16 v[68:69], v237 offset:45568
    buffer_load_dwordx4 a[52:55], v248, s[56:59], s68 offen offset:0 sc1
    v_mfma_f32_16x16x32_bf16 v[48:51], v[84:87], a[84:87], v[48:51]
    v_mfma_f32_16x16x32_bf16 v[52:55], v[80:83], a[88:91], v[52:55]
    ds_read_b64_tr_b16 v[70:71], v237 offset:47616
    v_mfma_f32_16x16x32_bf16 v[52:55], v[84:87], a[92:95], v[52:55]
    s_waitcnt lgkmcnt(4)
    v_mfma_f32_16x16x32_bf16 v[40:43], v[88:91], a[64:67], v[40:43]
    ds_read_b64_tr_b16 v[72:73], v242 offset:41472
    buffer_load_dwordx4 a[56:59], v246, s[56:59], s68 offen offset:1024 sc1
    v_mfma_f32_16x16x32_bf16 v[40:43], v[92:95], a[68:71], v[40:43]
    v_mfma_f32_16x16x32_bf16 v[44:47], v[88:91], a[72:75], v[44:47]
    ds_read_b64_tr_b16 v[74:75], v242 offset:43520
    v_mfma_f32_16x16x32_bf16 v[44:47], v[92:95], a[76:79], v[44:47]
    v_mfma_f32_16x16x32_bf16 v[56:59], v[88:91], a[80:83], v[56:59]
    ds_read_b64_tr_b16 v[76:77], v242 offset:45568
    buffer_load_dwordx4 a[60:63], v248, s[56:59], s68 offen offset:1024 sc1
    v_mfma_f32_16x16x32_bf16 v[56:59], v[92:95], a[84:87], v[56:59]
    v_mfma_f32_16x16x32_bf16 v[60:63], v[88:91], a[88:91], v[60:63]
    ds_read_b64_tr_b16 v[78:79], v242 offset:47616
    v_mfma_f32_16x16x32_bf16 v[60:63], v[92:95], a[92:95], v[60:63]
    s_waitcnt vmcnt(14) lgkmcnt(4)
    v_mfma_f32_16x16x32_bf16 v[0:3], v[64:67], a[0:3], v[0:3]
    ds_read_b64_tr_b16 v[80:81], v237 offset:41728
    v_mfma_f32_16x16x32_bf16 v[0:3], v[68:71], a[4:7], v[0:3]
    s_waitcnt vmcnt(12)
    v_mfma_f32_16x16x32_bf16 v[4:7], v[64:67], a[8:11], v[4:7]
    ds_read_b64_tr_b16 v[82:83], v237 offset:43776
    v_mfma_f32_16x16x32_bf16 v[4:7], v[68:71], a[12:15], v[4:7]
    s_waitcnt vmcnt(10)
    v_mfma_f32_16x16x32_bf16 v[16:19], v[64:67], a[16:19], v[16:19]
    ds_read_b64_tr_b16 v[84:85], v237 offset:45824
    v_mfma_f32_16x16x32_bf16 v[16:19], v[68:71], a[20:23], v[16:19]
    s_waitcnt vmcnt(8)
    v_mfma_f32_16x16x32_bf16 v[20:23], v[64:67], a[24:27], v[20:23]
    ds_read_b64_tr_b16 v[86:87], v237 offset:47872
    v_mfma_f32_16x16x32_bf16 v[20:23], v[68:71], a[28:31], v[20:23]
    s_waitcnt lgkmcnt(4)
    v_mfma_f32_16x16x32_bf16 v[8:11], v[72:75], a[0:3], v[8:11]
    ds_read_b64_tr_b16 v[88:89], v242 offset:41728
    v_mfma_f32_16x16x32_bf16 v[8:11], v[76:79], a[4:7], v[8:11]
    v_mfma_f32_16x16x32_bf16 v[12:15], v[72:75], a[8:11], v[12:15]
    ds_read_b64_tr_b16 v[90:91], v242 offset:43776
    v_mfma_f32_16x16x32_bf16 v[12:15], v[76:79], a[12:15], v[12:15]
    v_mfma_f32_16x16x32_bf16 v[24:27], v[72:75], a[16:19], v[24:27]
    ds_read_b64_tr_b16 v[92:93], v242 offset:45824
    v_mfma_f32_16x16x32_bf16 v[24:27], v[76:79], a[20:23], v[24:27]
    v_mfma_f32_16x16x32_bf16 v[28:31], v[72:75], a[24:27], v[28:31]
    ds_read_b64_tr_b16 v[94:95], v242 offset:47872
    v_mfma_f32_16x16x32_bf16 v[28:31], v[76:79], a[28:31], v[28:31]
    s_waitcnt lgkmcnt(4)
    v_mfma_f32_16x16x32_bf16 v[32:35], v[80:83], a[0:3], v[32:35]
    ds_read_b64_tr_b16 v[64:65], v238 offset:8192
    s_mov_b64 s[52:53], s[22:23]
    v_mfma_f32_16x16x32_bf16 v[32:35], v[84:87], a[4:7], v[32:35]
    s_movk_i32 s54, 1024
    buffer_load_dwordx2 v[128:129], v212, s[60:63], 0 offen offset:0
    v_mfma_f32_16x16x32_bf16 v[36:39], v[80:83], a[8:11], v[36:39]
    ds_read_b64_tr_b16 v[66:67], v238 offset:10240
    buffer_load_dwordx2 v[130:131], v212, s[60:63], 0 offen offset:32
    v_mfma_f32_16x16x32_bf16 v[36:39], v[84:87], a[12:15], v[36:39]
    v_mfma_f32_16x16x32_bf16 v[48:51], v[80:83], a[16:19], v[48:51]
    ds_read_b64_tr_b16 v[68:69], v238 offset:12288
    buffer_load_dwordx2 v[132:133], v212, s[60:63], 0 offen offset:64
    v_mfma_f32_16x16x32_bf16 v[48:51], v[84:87], a[20:23], v[48:51]
    v_mfma_f32_16x16x32_bf16 v[52:55], v[80:83], a[24:27], v[52:55]
    ds_read_b64_tr_b16 v[70:71], v238 offset:14336
    buffer_load_dwordx2 v[134:135], v212, s[60:63], 0 offen offset:96
    v_mfma_f32_16x16x32_bf16 v[52:55], v[84:87], a[28:31], v[52:55]
    s_waitcnt lgkmcnt(4)
    v_mfma_f32_16x16x32_bf16 v[40:43], v[88:91], a[0:3], v[40:43]
    ds_read_b64_tr_b16 v[72:73], v243 offset:8192
    buffer_load_dwordx2 v[136:137], v212, s[60:63], 0 offen offset:128
    v_mfma_f32_16x16x32_bf16 v[40:43], v[92:95], a[4:7], v[40:43]
    v_mfma_f32_16x16x32_bf16 v[44:47], v[88:91], a[8:11], v[44:47]
    ds_read_b64_tr_b16 v[74:75], v243 offset:10240
    buffer_load_dwordx2 v[138:139], v212, s[60:63], 0 offen offset:160
    v_mfma_f32_16x16x32_bf16 v[44:47], v[92:95], a[12:15], v[44:47]
    v_mfma_f32_16x16x32_bf16 v[56:59], v[88:91], a[16:19], v[56:59]
    ds_read_b64_tr_b16 v[76:77], v243 offset:12288
    buffer_load_dwordx4 v[192:195], v209, s[52:55], s15 offen
    v_mfma_f32_16x16x32_bf16 v[56:59], v[92:95], a[20:23], v[56:59]
    v_mfma_f32_16x16x32_bf16 v[60:63], v[88:91], a[24:27], v[60:63]
    ds_read_b64_tr_b16 v[78:79], v243 offset:14336
    v_mfma_f32_16x16x32_bf16 v[60:63], v[92:95], a[28:31], v[60:63]
    s_waitcnt vmcnt(13) lgkmcnt(4)
    v_mfma_f32_16x16x32_bf16 v[0:3], v[64:67], a[32:35], v[0:3]
    ds_read_b64_tr_b16 v[80:81], v238 offset:8448
    s_barrier
    v_mfma_f32_16x16x32_bf16 v[0:3], v[68:71], a[36:39], v[0:3]
    s_waitcnt vmcnt(11)
    v_mfma_f32_16x16x32_bf16 v[4:7], v[64:67], a[40:43], v[4:7]
    ds_read_b64_tr_b16 v[82:83], v238 offset:10496
    v_mfma_f32_16x16x32_bf16 v[4:7], v[68:71], a[44:47], v[4:7]
    s_waitcnt vmcnt(9)
    v_mfma_f32_16x16x32_bf16 v[16:19], v[64:67], a[48:51], v[16:19]
    ds_read_b64_tr_b16 v[84:85], v238 offset:12544
    v_mfma_f32_16x16x32_bf16 v[16:19], v[68:71], a[52:55], v[16:19]
    s_waitcnt vmcnt(7)
    v_mfma_f32_16x16x32_bf16 v[20:23], v[64:67], a[56:59], v[20:23]
    ds_read_b64_tr_b16 v[86:87], v238 offset:14592
    v_mfma_f32_16x16x32_bf16 v[20:23], v[68:71], a[60:63], v[20:23]
    s_waitcnt lgkmcnt(4)
    v_mfma_f32_16x16x32_bf16 v[8:11], v[72:75], a[32:35], v[8:11]
    ds_read_b64_tr_b16 v[88:89], v243 offset:8448
    buffer_store_short v211, v210, s[40:43], s72 offen sc1
    v_mfma_f32_16x16x32_bf16 v[8:11], v[76:79], a[36:39], v[8:11]
    v_mfma_f32_16x16x32_bf16 v[12:15], v[72:75], a[40:43], v[12:15]
    ds_read_b64_tr_b16 v[90:91], v243 offset:10496
    v_mfma_f32_16x16x32_bf16 v[12:15], v[76:79], a[44:47], v[12:15]
    v_mfma_f32_16x16x32_bf16 v[24:27], v[72:75], a[48:51], v[24:27]
    ds_read_b64_tr_b16 v[92:93], v243 offset:12544
    v_cvt_pk_bf16_f32 v96, v0, v1
    v_mfma_f32_16x16x32_bf16 v[24:27], v[76:79], a[52:55], v[24:27]
    v_cvt_pk_bf16_f32 v97, v2, v3
    v_cvt_pk_bf16_f32 v98, v4, v5
    v_cvt_pk_bf16_f32 v99, v6, v7
    v_mfma_f32_16x16x32_bf16 v[28:31], v[72:75], a[56:59], v[28:31]
    ds_read_b64_tr_b16 v[94:95], v243 offset:14592
    v_cvt_pk_bf16_f32 v100, v16, v17
    v_mfma_f32_16x16x32_bf16 v[28:31], v[76:79], a[60:63], v[28:31]
    v_cvt_pk_bf16_f32 v101, v18, v19
    v_cvt_pk_bf16_f32 v102, v20, v21
    s_waitcnt lgkmcnt(4)
    v_mfma_f32_16x16x32_bf16 v[32:35], v[80:83], a[32:35], v[32:35]
    v_cvt_pk_bf16_f32 v103, v22, v23
    v_mfma_f32_16x16x32_bf16 v[32:35], v[84:87], a[36:39], v[32:35]
    v_permlane16_swap_b32 v96, v98
    v_permlane16_swap_b32 v97, v99
    v_mfma_f32_16x16x32_bf16 v[36:39], v[80:83], a[40:43], v[36:39]
    v_permlane16_swap_b32 v100, v102
    v_mfma_f32_16x16x32_bf16 v[36:39], v[84:87], a[44:47], v[36:39]
    v_permlane16_swap_b32 v101, v103
    v_mfma_f32_16x16x32_bf16 v[48:51], v[80:83], a[48:51], v[48:51]
    buffer_store_dwordx4 v[96:99], v254, s[44:47], 0 offen offset:0 sc1
    v_mfma_f32_16x16x32_bf16 v[48:51], v[84:87], a[52:55], v[48:51]
    v_mfma_f32_16x16x32_bf16 v[52:55], v[80:83], a[56:59], v[52:55]
    buffer_store_dwordx4 v[100:103], v254, s[44:47], s77 offen offset:0 sc1
    v_cvt_pk_bf16_f32 v104, v8, v9
    v_mfma_f32_16x16x32_bf16 v[52:55], v[84:87], a[60:63], v[52:55]
    v_cvt_pk_bf16_f32 v105, v10, v11
    v_cvt_pk_bf16_f32 v106, v12, v13
    s_waitcnt lgkmcnt(0)
    v_mfma_f32_16x16x32_bf16 v[40:43], v[88:91], a[32:35], v[40:43]
    v_cvt_pk_bf16_f32 v107, v14, v15
    v_cvt_pk_bf16_f32 v108, v24, v25
    v_mfma_f32_16x16x32_bf16 v[40:43], v[92:95], a[36:39], v[40:43]
    v_cvt_pk_bf16_f32 v109, v26, v27
    v_cvt_pk_bf16_f32 v110, v28, v29
    v_cvt_pk_bf16_f32 v111, v30, v31
    v_mfma_f32_16x16x32_bf16 v[44:47], v[88:91], a[40:43], v[44:47]
    v_permlane16_swap_b32 v104, v106
    v_mfma_f32_16x16x32_bf16 v[44:47], v[92:95], a[44:47], v[44:47]
    v_permlane16_swap_b32 v105, v107
    v_mfma_f32_16x16x32_bf16 v[56:59], v[88:91], a[48:51], v[56:59]
    v_permlane16_swap_b32 v108, v110
    v_mfma_f32_16x16x32_bf16 v[56:59], v[92:95], a[52:55], v[56:59]
    v_permlane16_swap_b32 v109, v111
    v_mfma_f32_16x16x32_bf16 v[60:63], v[88:91], a[56:59], v[60:63]
    buffer_store_dwordx4 v[104:107], v254, s[44:47], 0 offen offset:1024 sc1
    buffer_store_dwordx4 v[108:111], v254, s[44:47], s77 offen offset:1024 sc1
    v_mfma_f32_16x16x32_bf16 v[60:63], v[92:95], a[60:63], v[60:63]
    v_cvt_pk_bf16_f32 v112, v32, v33
    v_cvt_pk_bf16_f32 v113, v34, v35
    v_cvt_pk_bf16_f32 v114, v36, v37
    v_cvt_pk_bf16_f32 v115, v38, v39
    v_cvt_pk_bf16_f32 v116, v48, v49
    v_cvt_pk_bf16_f32 v117, v50, v51
    v_cvt_pk_bf16_f32 v118, v52, v53
    v_cvt_pk_bf16_f32 v119, v54, v55
    v_permlane16_swap_b32 v112, v114
    v_permlane16_swap_b32 v113, v115
    v_permlane16_swap_b32 v116, v118
    v_permlane16_swap_b32 v117, v119
    buffer_store_dwordx4 v[112:115], v254, s[44:47], 0 offen offset:2048 sc1
    buffer_store_dwordx4 v[116:119], v254, s[44:47], s77 offen offset:2048 sc1
    v_cvt_pk_bf16_f32 v120, v40, v41
    v_cvt_pk_bf16_f32 v121, v42, v43
    v_cvt_pk_bf16_f32 v122, v44, v45
    v_cvt_pk_bf16_f32 v123, v46, v47
    v_cvt_pk_bf16_f32 v124, v56, v57
    v_cvt_pk_bf16_f32 v125, v58, v59
    v_cvt_pk_bf16_f32 v126, v60, v61
    v_cvt_pk_bf16_f32 v127, v62, v63
    v_permlane16_swap_b32 v120, v122
    v_permlane16_swap_b32 v121, v123
    v_permlane16_swap_b32 v124, v126
    v_permlane16_swap_b32 v125, v127
    buffer_store_dwordx4 v[120:123], v254, s[44:47], 0 offen offset:3072 sc1
    buffer_store_dwordx4 v[124:127], v254, s[44:47], s77 offen offset:3072 sc1
    ds_write_b128 v232, a[96:99] offset:0
    s_add_u32 s3, s3, 81920
    buffer_load_dwordx4 a[128:131], v255, s[48:51], s3 offen
    ds_write_b128 v232, a[100:103] offset:32768
    ds_write_b128 v233, a[104:107] offset:0
    s_add_u32 s3, s3, 16384
    buffer_load_dwordx4 a[132:135], v255, s[48:51], s3 offen
    ds_write_b128 v232, a[108:111] offset:4096
    ds_write_b128 v232, a[112:115] offset:36864
    s_add_u32 s3, s3, 81920
    buffer_load_dwordx4 a[136:139], v255, s[48:51], s3 offen
    ds_write_b128 v233, a[116:119] offset:4096
    ds_write_b128 v232, a[120:123] offset:8192
    s_add_u32 s3, s3, 16384
    buffer_load_dwordx4 a[140:143], v255, s[48:51], s3 offen
    ds_write_b128 v232, a[124:127] offset:40960
    ds_write_b128 v233, a[192:195] offset:8192
    s_add_u32 s3, s3, 81920
    buffer_load_dwordx4 a[144:147], v255, s[48:51], s3 offen
    ds_write_b128 v232, a[196:199] offset:12288
    ds_write_b128 v232, a[200:203] offset:45056
    s_add_u32 s3, s3, 16384
    buffer_load_dwordx4 a[148:151], v255, s[48:51], s3 offen
    ds_write_b128 v233, a[204:207] offset:12288
    ds_write_b128 v232, a[208:211] offset:16384
    s_add_u32 s3, s3, 81920
    buffer_load_dwordx4 a[152:155], v255, s[48:51], s3 offen
    ds_write_b128 v232, a[212:215] offset:49152
    ds_write_b128 v233, a[216:219] offset:16384
    s_add_u32 s3, s3, 16384
    buffer_load_dwordx4 a[156:159], v255, s[48:51], s3 offen
    ds_write_b128 v232, a[220:223] offset:20480
    s_add_u32 s44, s32, 13565952
    s_addc_u32 s45, s33, 0
    s_mov_b32 s46, 8389120
    s_mov_b32 s47, 0x20000
    s_lshl_b32 s72, s35, 12
    s_add_u32 s72, s72, 262144
    s_add_u32 s56, s32, s72
    s_addc_u32 s57, s33, 0
    s_mov_b32 s58, 4096
    s_mov_b32 s59, 0x20000
    s_add_u32 s60, s32, 3145728
    s_addc_u32 s61, s33, 0
    s_mov_b32 s62, 0x200000
    s_mov_b32 s63, 0x20000
    s_waitcnt vmcnt(17)
    v_lshlrev_b32 v80, 16, v152
    v_and_b32 v81, 0xffff0000, v152
    v_lshlrev_b32 v82, 16, v153
    v_and_b32 v83, 0xffff0000, v153
    v_lshlrev_b32 v84, 16, v154
    v_and_b32 v85, 0xffff0000, v154
    v_lshlrev_b32 v86, 16, v155
    v_and_b32 v87, 0xffff0000, v155
    v_lshlrev_b32 v88, 16, v156
    v_and_b32 v89, 0xffff0000, v156
    v_lshlrev_b32 v90, 16, v157
    v_and_b32 v91, 0xffff0000, v157
    v_lshlrev_b32 v92, 16, v158
    v_and_b32 v93, 0xffff0000, v158
    v_lshlrev_b32 v94, 16, v159
    v_and_b32 v95, 0xffff0000, v159
    v_mov_b32 v112, 0
    v_mov_b32 v113, 0
    v_mov_b32 v114, 0
    v_mov_b32 v115, 0
    v_mov_b32 v116, 0
    v_mov_b32 v117, 0
    v_mov_b32 v118, 0
    v_mov_b32 v119, 0
    v_mov_b32 v120, 0
    v_mov_b32 v121, 0
    v_mov_b32 v122, 0
    v_mov_b32 v123, 0
    v_mov_b32 v124, 0
    v_mov_b32 v125, 0
    v_mov_b32 v126, 0
    v_mov_b32 v127, 0
    s_add_u32 s68, s39, 2097280
    s_add_u32 s69, s39, 4194560
    s_add_u32 s70, s39, 6291840
    s_add_u32 s14, s39, 5177344
    s_mov_b32 s71, 0x00003f80
    s_mov_b32 s72, 0x3f800000
    s_mov_b32 s75, 0x3f803f80
    s_lshl_b32 s64, s34, 2
    s_add_u32 s64, s64, 163584
    v_lshl_add_u32 v12, v231, 5, s64
    v_lshrrev_b32 v13, 5, v239
    v_lshl_add_u32 v12, v13, 4, v12
    v_lshlrev_b32 v13, 5, v231
    v_add_u32 v13, 163584, v13
    v_mov_b32 v10, 0
    v_mov_b32 v11, 0
    s_waitcnt vmcnt(8)
    s_barrier
    s_cmp_lg_u32 s34, 0
    s_cbranch_scc1 L_nsig10
    s_mov_b64 exec, 0xffffffff
    buffer_atomic_add v234, v235, s[40:43], s73 offen offset:8 sc1
    s_mov_b64 exec, -1
L_nsig10:
    s_add_u32 m0, s78, 0
    s_nop 0
    buffer_load_dwordx4 v255, s[48:51], s66 offen lds
    s_add_u32 m0, s78, 2048
    s_add_u32 s66, s66, 16384
    buffer_load_dwordx4 v255, s[48:51], s66 offen lds
    s_add_u32 m0, s78, 4096
    s_add_u32 s66, s66, 81920
    buffer_load_dwordx4 v255, s[48:51], s66 offen lds
    s_add_u32 m0, s78, 6144
    s_add_u32 s66, s66, 16384
    buffer_load_dwordx4 v255, s[48:51], s66 offen lds
    ds_write_b128 v232, a[224:227] offset:53248
    ds_write_b128 v233, a[228:231] offset:20480
    ds_write_b128 v232, a[232:235] offset:24576
    ds_write_b128 v232, a[236:239] offset:57344
    ds_write_b128 v233, a[240:243] offset:24576
    ds_write_b128 v232, a[244:247] offset:28672
    ds_write_b128 v232, a[248:251] offset:61440
    ds_write_b128 v233, a[252:255] offset:28672
    s_mov_b32 s97, 0
L_poll11:
    s_load_dword s96, s[98:99], 8 glc
    s_add_u32 s97, s97, 1
    s_cmp_gt_u32 s97, 200000
    s_cbranch_scc1 L_pout11
    s_waitcnt lgkmcnt(0)
    s_cmp_lt_u32 s96, 32
    s_cbranch_scc1 L_poll11
L_pout11:
    s_waitcnt lgkmcnt(0)
    buffer_load_dwordx4 v[56:59], v230, s[56:59], 0 offen offset:0 sc1
    buffer_load_dwordx4 v[60:63], v230, s[56:59], 0 offen offset:512 sc1
    buffer_load_dwordx4 v[16:19], v228, s[44:47], s39 offen sc1
    buffer_load_dwordx4 v[20:23], v229, s[44:47], s39 offen sc1
    buffer_load_dwordx4 v[24:27], v228, s[44:47], s68 offen sc1
    buffer_load_dwordx4 v[28:31], v229, s[44:47], s68 offen sc1
    buffer_load_dwordx4 v[32:35], v228, s[44:47], s69 offen sc1
    buffer_load_dwordx4 v[36:39], v229, s[44:47], s69 offen sc1
    buffer_load_dwordx4 v[40:43], v228, s[44:47], s70 offen sc1
    buffer_load_dwordx4 v[44:47], v229, s[44:47], s70 offen sc1
    buffer_load_dwordx4 v[64:67], v230, s[56:59], 0 offen offset:1024 sc1
    buffer_load_dwordx4 v[68:71], v230, s[56:59], 0 offen offset:1536 sc1
    buffer_load_dwordx4 v[72:75], v230, s[56:59], 0 offen offset:2048 sc1
    buffer_load_dwordx4 v[76:79], v230, s[56:59], 0 offen offset:2560 sc1
    s_waitcnt vmcnt(12)
    v_lshlrev_b32 v96, 16, v56
    v_and_b32 v97, 0xffff0000, v56
    v_lshlrev_b32 v98, 16, v57
    v_and_b32 v99, 0xffff0000, v57
    v_lshlrev_b32 v100, 16, v58
    v_and_b32 v101, 0xffff0000, v58
    v_lshlrev_b32 v102, 16, v59
    v_and_b32 v103, 0xffff0000, v59
    v_lshlrev_b32 v104, 16, v60
    v_and_b32 v105, 0xffff0000, v60
    v_lshlrev_b32 v106, 16, v61
    v_and_b32 v107, 0xffff0000, v61
    v_lshlrev_b32 v108, 16, v62
    v_and_b32 v109, 0xffff0000, v62
    v_lshlrev_b32 v110, 16, v63
    v_and_b32 v111, 0xffff0000, v63
    s_waitcnt vmcnt(10)
    v_dot2c_f32_bf16 v112, s71, v16
    v_dot2c_f32_bf16 v113, s72, v16
    v_dot2c_f32_bf16 v114, s71, v17
    v_dot2c_f32_bf16 v115, s72, v17
    v_dot2c_f32_bf16 v116, s71, v18
    v_dot2c_f32_bf16 v117, s72, v18
    v_dot2c_f32_bf16 v118, s71, v19
    v_dot2c_f32_bf16 v119, s72, v19
    v_dot2c_f32_bf16 v120, s71, v20
    v_dot2c_f32_bf16 v121, s72, v20
    v_dot2c_f32_bf16 v122, s71, v21
    v_dot2c_f32_bf16 v123, s72, v21
    v_dot2c_f32_bf16 v124, s71, v22
    v_dot2c_f32_bf16 v125, s72, v22
    v_dot2c_f32_bf16 v126, s71, v23
    v_dot2c_f32_bf16 v127, s72, v23
    s_waitcnt vmcnt(8)
    v_dot2c_f32_bf16 v112, s71, v24
    v_dot2c_f32_bf16 v113, s72, v24
    v_dot2c_f32_bf16 v114, s71, v25
    v_dot2c_f32_bf16 v115, s72, v25
    v_dot2c_f32_bf16 v116, s71, v26
    v_dot2c_f32_bf16 v117, s72, v26
    v_dot2c_f32_bf16 v118, s71, v27
    v_dot2c_f32_bf16 v119, s72, v27
    v_dot2c_f32_bf16 v120, s71, v28
    v_dot2c_f32_bf16 v121, s72, v28
    v_dot2c_f32_bf16 v122, s71, v29
    v_dot2c_f32_bf16 v123, s72, v29
    v_dot2c_f32_bf16 v124, s71, v30
    v_dot2c_f32_bf16 v125, s72, v30
    v_dot2c_f32_bf16 v126, s71, v31
    v_dot2c_f32_bf16 v127, s72, v31
    s_waitcnt vmcnt(6)
    v_dot2c_f32_bf16 v112, s71, v32
    v_dot2c_f32_bf16 v113, s72, v32
    v_dot2c_f32_bf16 v114, s71, v33
    v_dot2c_f32_bf16 v115, s72, v33
    v_dot2c_f32_bf16 v116, s71, v34
    v_dot2c_f32_bf16 v117, s72, v34
    v_dot2c_f32_bf16 v118, s71, v35
    v_dot2c_f32_bf16 v119, s72, v35
    v_dot2c_f32_bf16 v120, s71, v36
    v_dot2c_f32_bf16 v121, s72, v36
    v_dot2c_f32_bf16 v122, s71, v37
    v_dot2c_f32_bf16 v123, s72, v37
    v_dot2c_f32_bf16 v124, s71, v38
    v_dot2c_f32_bf16 v125, s72, v38
    v_dot2c_f32_bf16 v126, s71, v39
    v_dot2c_f32_bf16 v127, s72, v39
    s_waitcnt vmcnt(4)
    v_dot2c_f32_bf16 v112, s71, v40
    v_dot2c_f32_bf16 v113, s72, v40
    v_dot2c_f32_bf16 v114, s71, v41
    v_dot2c_f32_bf16 v115, s72, v41
    v_dot2c_f32_bf16 v116, s71, v42
    v_dot2c_f32_bf16 v117, s72, v42
    v_dot2c_f32_bf16 v118, s71, v43
    v_dot2c_f32_bf16 v119, s72, v43
    v_dot2c_f32_bf16 v120, s71, v44
    v_dot2c_f32_bf16 v121, s72, v44
    v_dot2c_f32_bf16 v122, s71, v45
    v_dot2c_f32_bf16 v123, s72, v45
    v_dot2c_f32_bf16 v124, s71, v46
    v_dot2c_f32_bf16 v125, s72, v46
    v_dot2c_f32_bf16 v126, s71, v47
    v_dot2c_f32_bf16 v127, s72, v47
    v_pk_fma_f32 v[80:81], v[96:97], v[112:113], v[80:81]
    v_pk_fma_f32 v[82:83], v[98:99], v[114:115], v[82:83]
    v_pk_fma_f32 v[84:85], v[100:101], v[116:117], v[84:85]
    v_pk_fma_f32 v[86:87], v[102:103], v[118:119], v[86:87]
    v_pk_fma_f32 v[88:89], v[104:105], v[120:121], v[88:89]
    v_pk_fma_f32 v[90:91], v[106:107], v[122:123], v[90:91]
    v_pk_fma_f32 v[92:93], v[108:109], v[124:125], v[92:93]
    v_pk_fma_f32 v[94:95], v[110:111], v[126:127], v[94:95]
    v_cvt_pk_bf16_f32 v56, v80, v81
    v_cvt_pk_bf16_f32 v57, v82, v83
    v_cvt_pk_bf16_f32 v58, v84, v85
    v_cvt_pk_bf16_f32 v59, v86, v87
    v_cvt_pk_bf16_f32 v60, v88, v89
    v_cvt_pk_bf16_f32 v61, v90, v91
    v_cvt_pk_bf16_f32 v62, v92, v93
    v_cvt_pk_bf16_f32 v63, v94, v95
    v_dot2c_f32_bf16 v10, s75, v56
    v_dot2c_f32_bf16 v11, v56, v56
    v_dot2c_f32_bf16 v10, s75, v57
    v_dot2c_f32_bf16 v11, v57, v57
    v_dot2c_f32_bf16 v10, s75, v58
    v_dot2c_f32_bf16 v11, v58, v58
    v_dot2c_f32_bf16 v10, s75, v59
    v_dot2c_f32_bf16 v11, v59, v59
    v_dot2c_f32_bf16 v10, s75, v60
    v_dot2c_f32_bf16 v11, v60, v60
    v_dot2c_f32_bf16 v10, s75, v61
    v_dot2c_f32_bf16 v11, v61, v61
    v_dot2c_f32_bf16 v10, s75, v62
    v_dot2c_f32_bf16 v11, v62, v62
    v_dot2c_f32_bf16 v10, s75, v63
    v_dot2c_f32_bf16 v11, v63, v63
    buffer_store_dwordx4 v[56:59], v228, s[40:43], s14 offen sc1
    buffer_store_dwordx4 v[60:63], v229, s[40:43], s14 offen sc1
    s_nop 0
    v_add_f32_dpp v10, v10, v10 row_ror:8 row_mask:0xf bank_mask:0xf
    v_add_f32_dpp v11, v11, v11 row_ror:8 row_mask:0xf bank_mask:0xf
    v_lshlrev_b32 v112, 16, v56
    v_and_b32 v113, 0xffff0000, v56
    v_permlane32_swap_b32 v10, v11
    v_lshlrev_b32 v114, 16, v57
    v_and_b32 v115, 0xffff0000, v57
L_pad9:
    s_cbranch_execz L_pad10
    v_add_f32 v10, v10, v11
    v_mov_b32 v11, v10
    v_lshlrev_b32 v116, 16, v58
    v_and_b32 v117, 0xffff0000, v58
    v_permlane16_swap_b32 v10, v11
    v_lshlrev_b32 v118, 16, v59
    v_and_b32 v119, 0xffff0000, v59
    v_add_f32 v10, v10, v11
    ds_write_b32 v12, v10
    v_lshlrev_b32 v120, 16, v60
    v_and_b32 v121, 0xffff0000, v60
    v_lshlrev_b32 v122, 16, v61
    v_and_b32 v123, 0xffff0000, v61
    v_lshlrev_b32 v124, 16, v62
    v_and_b32 v125, 0xffff0000, v62
    v_lshlrev_b32 v126, 16, v63
    v_and_b32 v127, 0xffff0000, v63
    s_waitcnt vmcnt(2)
    v_lshlrev_b32 v80, 16, v64
    v_and_b32 v81, 0xffff0000, v64
    v_lshlrev_b32 v82, 16, v65
    v_and_b32 v83, 0xffff0000, v65
    v_lshlrev_b32 v84, 16, v66
    v_and_b32 v85, 0xffff0000, v66
    v_lshlrev_b32 v86, 16, v67
    v_and_b32 v87, 0xffff0000, v67
    s_waitcnt lgkmcnt(0)
    s_barrier
    ds_read_b128 v[24:27], v13
    ds_read_b128 v[28:31], v13 offset:16
    v_lshlrev_b32 v88, 16, v68
    v_and_b32 v89, 0xffff0000, v68
    v_lshlrev_b32 v90, 16, v69
    v_and_b32 v91, 0xffff0000, v69
    v_lshlrev_b32 v92, 16, v70
    v_and_b32 v93, 0xffff0000, v70
    v_lshlrev_b32 v94, 16, v71
    v_and_b32 v95, 0xffff0000, v71
    v_lshlrev_b32 v96, 16, v72
    v_and_b32 v97, 0xffff0000, v72
    v_lshlrev_b32 v98, 16, v73
    v_and_b32 v99, 0xffff0000, v73
    v_lshlrev_b32 v100, 16, v74
    v_and_b32 v101, 0xffff0000, v74
    v_lshlrev_b32 v102, 16, v75
    v_and_b32 v103, 0xffff0000, v75
    v_lshlrev_b32 v104, 16, v76
    v_and_b32 v105, 0xffff0000, v76
    v_lshlrev_b32 v106, 16, v77
    v_and_b32 v107, 0xffff0000, v77
    v_lshlrev_b32 v108, 16, v78
    v_and_b32 v109, 0xffff0000, v78
    v_lshlrev_b32 v110, 16, v79
    v_and_b32 v111, 0xffff0000, v79
    s_waitcnt lgkmcnt(0)
    v_pk_add_f32 v[24:25], v[24:25], v[26:27]
    v_pk_add_f32 v[28:29], v[28:29], v[30:31]
    v_add_f32 v24, v24, v25
    v_add_f32 v28, v28, v29
    v_mul_f32 v24, 0x3b000000, v24
    v_mul_f32 v28, 0x3b000000, v28
    v_fma_f32 v28, -v24, v24, v28
    v_max_f32 v28, 0, v28
    v_add_f32 v28, 0x3727c5ac, v28
    v_rsq_f32 v28, v28
    s_nop 0
    v_mul_f32 v24, -v24, v28
    v_pk_fma_f32 v[112:113], v[112:113], v[28:29], v[24:25] op_sel_hi:[1,0,0]
    v_pk_fma_f32 v[114:115], v[114:115], v[28:29], v[24:25] op_sel_hi:[1,0,0]
    v_pk_fma_f32 v[116:117], v[116:117], v[28:29], v[24:25] op_sel_hi:[1,0,0]
    v_pk_fma_f32 v[118:119], v[118:119], v[28:29], v[24:25] op_sel_hi:[1,0,0]
    v_pk_fma_f32 v[112:113], v[112:113], v[96:97], v[80:81]
    v_pk_fma_f32 v[114:115], v[114:115], v[98:99], v[82:83]
    v_pk_fma_f32 v[116:117], v[116:117], v[100:101], v[84:85]
    v_pk_fma_f32 v[118:119], v[118:119], v[102:103], v[86:87]
    v_cvt_pk_bf16_f32 v48, v112, v113
    v_cvt_pk_bf16_f32 v49, v114, v115
    v_cvt_pk_bf16_f32 v50, v116, v117
    v_cvt_pk_bf16_f32 v51, v118, v119
    buffer_store_dwordx4 v[48:51], v228, s[60:63], s39 offen sc1
    v_pk_fma_f32 v[120:121], v[120:121], v[28:29], v[24:25] op_sel_hi:[1,0,0]
    v_pk_fma_f32 v[122:123], v[122:123], v[28:29], v[24:25] op_sel_hi:[1,0,0]
    v_pk_fma_f32 v[124:125], v[124:125], v[28:29], v[24:25] op_sel_hi:[1,0,0]
    v_pk_fma_f32 v[126:127], v[126:127], v[28:29], v[24:25] op_sel_hi:[1,0,0]
    v_pk_fma_f32 v[120:121], v[120:121], v[104:105], v[88:89]
    v_pk_fma_f32 v[122:123], v[122:123], v[106:107], v[90:91]
    v_pk_fma_f32 v[124:125], v[124:125], v[108:109], v[92:93]
    v_pk_fma_f32 v[126:127], v[126:127], v[110:111], v[94:95]
    v_cvt_pk_bf16_f32 v52, v120, v121
    v_cvt_pk_bf16_f32 v53, v122, v123
    v_cvt_pk_bf16_f32 v54, v124, v125
    v_cvt_pk_bf16_f32 v55, v126, v127
    buffer_store_dwordx4 v[52:55], v229, s[60:63], s39 offen sc1
    s_and_b32 s64, s38, 15
    s_lshr_b32 s74, s36, 1
    s_lshl_b32 s72, s74, 12
    s_add_u32 s73, s73, s72
    s_lshl_b32 s74, s74, 2
    s_add_u32 s74, s74, s34
    s_lshl_b32 s75, s35, 3
    s_add_u32 s75, s75, s74
    v_and_b32 v100, 0xff, v236
    v_lshrrev_b32 v101, 4, v239
    v_lshl_add_u32 v116, v101, 9, v100
    v_xor_b32 v117, 32, v116
    v_add_u32 v118, 65536, v116
    v_add_u32 v119, 65536, v117
    s_lshl_b32 s76, s75, 15
    s_add_u32 s76, s76, 3145728
    s_add_u32 s60, s32, s76
    s_addc_u32 s61, s33, 0
    s_mov_b32 s62, 0x8000
    s_mov_b32 s63, 0x20000
    s_cmp_eq_u32 s64, 15
    s_cselect_b32 s62, 0, s62
    s_mul_i32 s76, s75, 88064
    s_mul_i32 s72, s64, 6144
    s_add_u32 s76, s76, s72
    s_add_u32 s76, s76, 7340032
    s_sub_u32 s72, 88064, s72
    s_max_i32 s72, s72, 0
    s_add_u32 s44, s32, s76
    s_addc_u32 s45, s33, 0
    s_mov_b32 s46, s72
    s_mov_b32 s47, 0x20000
    s_mov_b32 s75, 0
    s_lshr_b32 s68, s34, 1
    s_lshl_b32 s68, s68, 14
    s_sub_u32 s68, 65536, s68
    s_add_u32 s68, s68, s67
    v_add_u32 v122, s68, v254
    v_add_u32 v123, s78, v254
    v_mov_b32 v124, 0xbdd2d3e8
    v_mov_b32 v126, 0xc0135761
    s_movk_i32 s69, 4096
    s_lshr_b32 s38, s34, 1
    s_mul_i32 s38, s38, 40
    s_sub_u32 s38, 81, s38
    s_lshl_b32 s38, s38, 14
    v_lshlrev_b32 v0, 16, v128
    v_and_b32 v1, 0xffff0000, v128
    v_lshlrev_b32 v2, 16, v129
    v_and_b32 v3, 0xffff0000, v129
    v_lshlrev_b32 v4, 16, v128
    v_and_b32 v5, 0xffff0000, v128
    v_lshlrev_b32 v6, 16, v129
    v_and_b32 v7, 0xffff0000, v129
    v_lshlrev_b32 v8, 16, v130
    v_and_b32 v9, 0xffff0000, v130
    v_lshlrev_b32 v10, 16, v131
    v_and_b32 v11, 0xffff0000, v131
    v_lshlrev_b32 v12, 16, v130
    v_and_b32 v13, 0xffff0000, v130
    v_lshlrev_b32 v14, 16, v131
    v_and_b32 v15, 0xffff0000, v131
    v_lshlrev_b32 v16, 16, v132
    v_and_b32 v17, 0xffff0000, v132
    v_lshlrev_b32 v18, 16, v133
    v_and_b32 v19, 0xffff0000, v133
    v_lshlrev_b32 v20, 16, v132
    v_and_b32 v21, 0xffff0000, v132
    v_lshlrev_b32 v22, 16, v133
    v_and_b32 v23, 0xffff0000, v133
    v_lshlrev_b32 v24, 16, v134
    v_and_b32 v25, 0xffff0000, v134
    v_lshlrev_b32 v26, 16, v135
    v_and_b32 v27, 0xffff0000, v135
    v_lshlrev_b32 v28, 16, v134
    v_and_b32 v29, 0xffff0000, v134
    v_lshlrev_b32 v30, 16, v135
    v_and_b32 v31, 0xffff0000, v135
    v_lshlrev_b32 v32, 16, v136
    v_and_b32 v33, 0xffff0000, v136
    v_lshlrev_b32 v34, 16, v137
    v_and_b32 v35, 0xffff0000, v137
    v_lshlrev_b32 v36, 16, v136
    v_and_b32 v37, 0xffff0000, v136
    v_lshlrev_b32 v38, 16, v137
    v_and_b32 v39, 0xffff0000, v137
    v_lshlrev_b32 v40, 16, v138
    v_and_b32 v41, 0xffff0000, v138
    v_lshlrev_b32 v42, 16, v139
    v_and_b32 v43, 0xffff0000, v139
    v_lshlrev_b32 v44, 16, v138
    v_and_b32 v45, 0xffff0000, v138
    v_lshlrev_b32 v46, 16, v139
    v_and_b32 v47, 0xffff0000, v139
    s_waitcnt vmcnt(0)
    s_barrier
    s_cmp_lg_u32 s34, 0
    s_cbranch_scc1 L_nsig12
    s_mov_b64 exec, 0xffff
    buffer_atomic_add v234, v235, s[40:43], s73 offen offset:12 sc1
    s_mov_b64 exec, -1
L_nsig12:
    s_add_u32 m0, s78, 8192
    s_add_u32 s66, s66, 81920
    buffer_load_dwordx4 v255, s[48:51], s66 offen lds
    s_add_u32 m0, s78, 10240
    s_add_u32 s66, s66, 16384
    buffer_load_dwordx4 v255, s[48:51], s66 offen lds
    s_add_u32 m0, s78, 12288
    s_add_u32 s66, s66, 81920
    buffer_load_dwordx4 v255, s[48:51], s66 offen lds
    s_add_u32 m0, s78, 14336
    s_add_u32 s66, s66, 16384
    buffer_load_dwordx4 v255, s[48:51], s66 offen lds
    s_add_u32 m0, s78, 16384
    s_add_u32 s66, s66, 81920
    buffer_load_dwordx4 v255, s[48:51], s66 offen lds
    s_add_u32 m0, s78, 18432
    s_add_u32 s66, s66, 16384
    buffer_load_dwordx4 v255, s[48:51], s66 offen lds
    s_add_u32 m0, s78, 20480
    s_add_u32 s66, s66, 81920
    buffer_load_dwordx4 v255, s[48:51], s66 offen lds
    s_add_u32 m0, s78, 22528
    s_add_u32 s66, s66, 16384
    buffer_load_dwordx4 v255, s[48:51], s66 offen lds
    s_lshr_b32 s70, s34, 1
    s_and_b32 s71, s34, 1
    s_lshl_b32 s77, s35, 12
    s_add_u32 s77, s77, s15
    s_add_u32 s77, s77, 199680
    buffer_load_dwordx4 v[176:179], v209, s[40:43], s77 offen sc1
    s_lshl_b32 s64, s71, 10
    v_subrev_u32 v100, s64, v236
    v_lshrrev_b32 v101, 4, v239
    v_lshl_add_u32 v100, v101, 9, v100
    v_add_u32 v160, s67, v100
    v_xor_b32 v161, 32, v160
    v_add_u32 v162, s78, v100
    v_xor_b32 v163, 32, v162
    v_add_u32 v164, s68, v100
    v_xor_b32 v165, 32, v164
    v_lshrrev_b32 v102, 3, v239
    v_lshl_add_u32 v166, v102, 10, v209
    v_lshlrev_b32 v103, 4, v102
    v_lshl_add_u32 v167, v231, 9, v103
    s_lshl_b32 s64, s70, 15
    s_mul_i32 s65, s71, 8704
    s_add_u32 s65, s65, 106496
    s_add_u32 s77, s65, s64
    v_and_b32 v100, 15, v239
    v_mul_u32_u24 v100, 272, v100
    v_and_b32 v101, 48, v239
    v_add3_u32 v168, v100, v101, s77
    s_mul_i32 s77, s70, 4352
    s_add_u32 s65, s65, s77
    v_mul_u32_u24 v100, 272, v102
    v_lshl_add_u32 v100, v231, 5, v100
    v_add_u32 v169, s65, v100
    s_lshl_b32 s64, s35, 2
    s_add_u32 s64, s64, s36
    s_lshl_b32 s64, s64, 1
    s_add_u32 s64, s64, s71
    s_lshl_b32 s76, s64, 15
    s_lshl_b32 s74, s37, 12
    s_add_u32 s74, s74, s76
    s_lshl_b32 s77, s70, 8
    s_add_u32 s74, s74, s77
    s_mul_i32 s77, s64, 0
    s_add_u32 s74, s74, s77
    s_add_u32 s74, s74, 5177344
    s_lshl_b32 s77, s70, 14
    s_add_u32 s76, s76, s77
    s_add_u32 s76, s76, s15
    s_add_u32 s77, s76, 8192
    s_mul_i32 s64, s64, 88064
    s_add_u32 s64, s64, 7340032
    s_lshl_b32 s72, s70, 11
    s_add_u32 s56, s32, s64
    s_addc_u32 s57, s33, 0
    s_mov_b32 s58, 88064
    s_mov_b32 s59, 0x20000
    s_mov_b32 s52, s28
    s_mov_b32 s53, s29
    s_mov_b32 s54, 0x200000
    s_mov_b32 s55, 0x20000
    ds_read_b64_tr_b16 v[64:65], v116 offset:0
    ds_read_b64_tr_b16 v[66:67], v116 offset:256
    ds_read_b64_tr_b16 v[68:69], v116 offset:2048
    ds_read_b64_tr_b16 v[70:71], v116 offset:2304
    ds_read_b64_tr_b16 v[72:73], v117 offset:0
    ds_read_b64_tr_b16 v[74:75], v117 offset:256
    ds_read_b64_tr_b16 v[76:77], v117 offset:2048
    ds_read_b64_tr_b16 v[78:79], v117 offset:2304
    ds_read_b64_tr_b16 v[80:81], v116 offset:32768
    ds_read_b64_tr_b16 v[82:83], v116 offset:33024
    ds_read_b64_tr_b16 v[84:85], v116 offset:34816
    ds_read_b64_tr_b16 v[86:87], v116 offset:35072
    s_mov_b32 s97, 0
L_poll14:
    s_load_dword s96, s[98:99], 12 glc
    s_add_u32 s97, s97, 1
    s_cmp_gt_u32 s97, 200000
    s_cbranch_scc1 L_pout14
    s_waitcnt lgkmcnt(0)
    s_cmp_lt_u32 s96, 16
    s_cbranch_scc1 L_poll14
L_pout14:
    s_waitcnt lgkmcnt(0)
    buffer_load_dwordx4 a[0:3], v249, s[60:63], s75 offen offset:0 sc1
    buffer_load_dwordx4 a[4:7], v249, s[60:63], s75 offen offset:2048 sc1
    buffer_load_dwordx4 a[8:11], v249, s[60:63], s75 offen offset:256 sc1
    buffer_load_dwordx4 a[12:15], v249, s[60:63], s75 offen offset:2304 sc1
    s_add_u32 s75, s75, 4096
    buffer_load_dwordx4 a[16:19], v249, s[60:63], s75 offen offset:0 sc1
    buffer_load_dwordx4 a[20:23], v249, s[60:63], s75 offen offset:2048 sc1
    buffer_load_dwordx4 a[24:27], v249, s[60:63], s75 offen offset:256 sc1
    buffer_load_dwordx4 a[28:31], v249, s[60:63], s75 offen offset:2304 sc1
    s_add_u32 s75, s75, 4096
    buffer_load_dwordx4 a[32:35], v249, s[60:63], s75 offen offset:0 sc1
    buffer_load_dwordx4 a[36:39], v249, s[60:63], s75 offen offset:2048 sc1
    buffer_load_dwordx4 a[40:43], v249, s[60:63], s75 offen offset:256 sc1
    buffer_load_dwordx4 a[44:47], v249, s[60:63], s75 offen offset:2304 sc1
    s_add_u32 s75, s75, 4096
    s_waitcnt vmcnt(10) lgkmcnt(8)
    v_mfma_f32_16x16x32_bf16 v[0:3], v[64:67], a[0:3], v[0:3]
    ds_read_b64_tr_b16 v[88:89], v117 offset:32768
    buffer_load_dwordx4 a[48:51], v249, s[60:63], s75 offen offset:0 sc1
    v_mfma_f32_16x16x32_bf16 v[0:3], v[68:71], a[4:7], v[0:3]
    ds_read_b64_tr_b16 v[90:91], v117 offset:33024
    s_waitcnt vmcnt(9)
    v_mfma_f32_16x16x32_bf16 v[4:7], v[64:67], a[8:11], v[4:7]
    ds_read_b64_tr_b16 v[92:93], v117 offset:34816
    v_mfma_f32_16x16x32_bf16 v[4:7], v[68:71], a[12:15], v[4:7]
    ds_read_b64_tr_b16 v[94:95], v117 offset:35072
    s_waitcnt lgkmcnt(8)
    v_mfma_f32_16x16x32_bf16 v[8:11], v[72:75], a[0:3], v[8:11]
    ds_read_b64_tr_b16 v[64:65], v116 offset:4096
    buffer_load_dwordx4 a[52:55], v249, s[60:63], s75 offen offset:2048 sc1
    v_mfma_f32_16x16x32_bf16 v[8:11], v[76:79], a[4:7], v[8:11]
    ds_read_b64_tr_b16 v[66:67], v116 offset:4352
    v_mfma_f32_16x16x32_bf16 v[12:15], v[72:75], a[8:11], v[12:15]
    ds_read_b64_tr_b16 v[68:69], v116 offset:6144
    v_mfma_f32_16x16x32_bf16 v[12:15], v[76:79], a[12:15], v[12:15]
    ds_read_b64_tr_b16 v[70:71], v116 offset:6400
    s_waitcnt lgkmcnt(8)
    v_mfma_f32_16x16x32_bf16 v[16:19], v[80:83], a[0:3], v[16:19]
    ds_read_b64_tr_b16 v[72:73], v117 offset:4096
    buffer_load_dwordx4 a[56:59], v249, s[60:63], s75 offen offset:256 sc1
    v_mfma_f32_16x16x32_bf16 v[16:19], v[84:87], a[4:7], v[16:19]
    ds_read_b64_tr_b16 v[74:75], v117 offset:4352
    v_mfma_f32_16x16x32_bf16 v[20:23], v[80:83], a[8:11], v[20:23]
    ds_read_b64_tr_b16 v[76:77], v117 offset:6144
    v_mfma_f32_16x16x32_bf16 v[20:23], v[84:87], a[12:15], v[20:23]
    ds_read_b64_tr_b16 v[78:79], v117 offset:6400
    s_waitcnt lgkmcnt(8)
    v_mfma_f32_16x16x32_bf16 v[24:27], v[88:91], a[0:3], v[24:27]
    ds_read_b64_tr_b16 v[80:81], v116 offset:36864
    buffer_load_dwordx4 a[60:63], v249, s[60:63], s75 offen offset:2304 sc1
    v_mfma_f32_16x16x32_bf16 v[24:27], v[92:95], a[4:7], v[24:27]
    ds_read_b64_tr_b16 v[82:83], v116 offset:37120
    v_mfma_f32_16x16x32_bf16 v[28:31], v[88:91], a[8:11], v[28:31]
    ds_read_b64_tr_b16 v[84:85], v116 offset:38912
    v_mfma_f32_16x16x32_bf16 v[28:31], v[92:95], a[12:15], v[28:31]
    ds_read_b64_tr_b16 v[86:87], v116 offset:39168
    s_waitcnt vmcnt(10) lgkmcnt(8)
    v_mfma_f32_16x16x32_bf16 v[0:3], v[64:67], a[16:19], v[0:3]
    ds_read_b64_tr_b16 v[88:89], v117 offset:36864
    s_add_u32 s75, s75, 4096
    v_mfma_f32_16x16x32_bf16 v[0:3], v[68:71], a[20:23], v[0:3]
    ds_read_b64_tr_b16 v[90:91], v117 offset:37120
    buffer_load_dwordx4 a[64:67], v249, s[60:63], s75 offen offset:0 sc1
    s_waitcnt vmcnt(9)
    v_mfma_f32_16x16x32_bf16 v[4:7], v[64:67], a[24:27], v[4:7]
    ds_read_b64_tr_b16 v[92:93], v117 offset:38912
    v_mfma_f32_16x16x32_bf16 v[4:7], v[68:71], a[28:31], v[4:7]
    ds_read_b64_tr_b16 v[94:95], v117 offset:39168
    s_waitcnt lgkmcnt(8)
    v_mfma_f32_16x16x32_bf16 v[8:11], v[72:75], a[16:19], v[8:11]
    ds_read_b64_tr_b16 v[64:65], v116 offset:8192
    buffer_load_dwordx4 a[68:71], v249, s[60:63], s75 offen offset:2048 sc1
    v_mfma_f32_16x16x32_bf16 v[8:11], v[76:79], a[20:23], v[8:11]
    ds_read_b64_tr_b16 v[66:67], v116 offset:8448
    v_mfma_f32_16x16x32_bf16 v[12:15], v[72:75], a[24:27], v[12:15]
    ds_read_b64_tr_b16 v[68:69], v116 offset:10240
    v_mfma_f32_16x16x32_bf16 v[12:15], v[76:79], a[28:31], v[12:15]
    ds_read_b64_tr_b16 v[70:71], v116 offset:10496
    s_waitcnt lgkmcnt(8)
    v_mfma_f32_16x16x32_bf16 v[16:19], v[80:83], a[16:19], v[16:19]
    ds_read_b64_tr_b16 v[72:73], v117 offset:8192
    buffer_load_dwordx4 a[72:75], v249, s[60:63], s75 offen offset:256 sc1
    v_mfma_f32_16x16x32_bf16 v[16:19], v[84:87], a[20:23], v[16:19]
    ds_read_b64_tr_b16 v[74:75], v117 offset:8448
    v_mfma_f32_16x16x32_bf16 v[20:23], v[80:83], a[24:27], v[20:23]
    ds_read_b64_tr_b16 v[76:77], v117 offset:10240
    v_mfma_f32_16x16x32_bf16 v[20:23], v[84:87], a[28:31], v[20:23]
    ds_read_b64_tr_b16 v[78:79], v117 offset:10496
    s_waitcnt lgkmcnt(8)
    v_mfma_f32_16x16x32_bf16 v[24:27], v[88:91], a[16:19], v[24:27]
    ds_read_b64_tr_b16 v[80:81], v116 offset:40960
    buffer_load_dwordx4 a[76:79], v249, s[60:63], s75 offen offset:2304 sc1
    v_mfma_f32_16x16x32_bf16 v[24:27], v[92:95], a[20:23], v[24:27]
    ds_read_b64_tr_b16 v[82:83], v116 offset:41216
    v_mfma_f32_16x16x32_bf16 v[28:31], v[88:91], a[24:27], v[28:31]
    ds_read_b64_tr_b16 v[84:85], v116 offset:43008
    v_mfma_f32_16x16x32_bf16 v[28:31], v[92:95], a[28:31], v[28:31]
    ds_read_b64_tr_b16 v[86:87], v116 offset:43264
    s_waitcnt vmcnt(10) lgkmcnt(8)
    v_mfma_f32_16x16x32_bf16 v[0:3], v[64:67], a[32:35], v[0:3]
    ds_read_b64_tr_b16 v[88:89], v117 offset:40960
    s_add_u32 s75, s75, 4096
    v_mfma_f32_16x16x32_bf16 v[0:3], v[68:71], a[36:39], v[0:3]
    ds_read_b64_tr_b16 v[90:91], v117 offset:41216
    buffer_load_dwordx4 a[80:83], v249, s[60:63], s75 offen offset:0 sc1
    s_waitcnt vmcnt(9)
    v_mfma_f32_16x16x32_bf16 v[4:7], v[64:67], a[40:43], v[4:7]
    ds_read_b64_tr_b16 v[92:93], v117 offset:43008
    v_mfma_f32_16x16x32_bf16 v[4:7], v[68:71], a[44:47], v[4:7]
    ds_read_b64_tr_b16 v[94:95], v117 offset:43264
    s_waitcnt lgkmcnt(8)
    v_mfma_f32_16x16x32_bf16 v[8:11], v[72:75], a[32:35], v[8:11]
    ds_read_b64_tr_b16 v[64:65], v116 offset:12288
    buffer_load_dwordx4 a[84:87], v249, s[60:63], s75 offen offset:2048 sc1
    v_mfma_f32_16x16x32_bf16 v[8:11], v[76:79], a[36:39], v[8:11]
    ds_read_b64_tr_b16 v[66:67], v116 offset:12544
    v_mfma_f32_16x16x32_bf16 v[12:15], v[72:75], a[40:43], v[12:15]
    ds_read_b64_tr_b16 v[68:69], v116 offset:14336
    v_mfma_f32_16x16x32_bf16 v[12:15], v[76:79], a[44:47], v[12:15]
    ds_read_b64_tr_b16 v[70:71], v116 offset:14592
    s_waitcnt lgkmcnt(8)
    v_mfma_f32_16x16x32_bf16 v[16:19], v[80:83], a[32:35], v[16:19]
    ds_read_b64_tr_b16 v[72:73], v117 offset:12288
    buffer_load_dwordx4 a[88:91], v249, s[60:63], s75 offen offset:256 sc1
    v_mfma_f32_16x16x32_bf16 v[16:19], v[84:87], a[36:39], v[16:19]
    ds_read_b64_tr_b16 v[74:75], v117 offset:12544
    v_mfma_f32_16x16x32_bf16 v[20:23], v[80:83], a[40:43], v[20:23]
    ds_read_b64_tr_b16 v[76:77], v117 offset:14336
    v_mfma_f32_16x16x32_bf16 v[20:23], v[84:87], a[44:47], v[20:23]
    ds_read_b64_tr_b16 v[78:79], v117 offset:14592
    s_waitcnt lgkmcnt(8)
    v_mfma_f32_16x16x32_bf16 v[24:27], v[88:91], a[32:35], v[24:27]
    ds_read_b64_tr_b16 v[80:81], v116 offset:45056
    buffer_load_dwordx4 a[92:95], v249, s[60:63], s75 offen offset:2304 sc1
    v_mfma_f32_16x16x32_bf16 v[24:27], v[92:95], a[36:39], v[24:27]
    ds_read_b64_tr_b16 v[82:83], v116 offset:45312
    v_mfma_f32_16x16x32_bf16 v[28:31], v[88:91], a[40:43], v[28:31]
    ds_read_b64_tr_b16 v[84:85], v116 offset:47104
    v_mfma_f32_16x16x32_bf16 v[28:31], v[92:95], a[44:47], v[28:31]
    ds_read_b64_tr_b16 v[86:87], v116 offset:47360
    s_waitcnt vmcnt(10) lgkmcnt(8)
    v_mfma_f32_16x16x32_bf16 v[0:3], v[64:67], a[48:51], v[0:3]
    ds_read_b64_tr_b16 v[88:89], v117 offset:45056
    s_add_u32 s75, s75, 4096
    v_mfma_f32_16x16x32_bf16 v[0:3], v[68:71], a[52:55], v[0:3]
    ds_read_b64_tr_b16 v[90:91], v117 offset:45312
    buffer_load_dwordx4 a[96:99], v249, s[60:63], s75 offen offset:0 sc1
    s_waitcnt vmcnt(9)
    v_mfma_f32_16x16x32_bf16 v[4:7], v[64:67], a[56:59], v[4:7]
    ds_read_b64_tr_b16 v[92:93], v117 offset:47104
    v_mfma_f32_16x16x32_bf16 v[4:7], v[68:71], a[60:63], v[4:7]
    ds_read_b64_tr_b16 v[94:95], v117 offset:47360
    s_waitcnt lgkmcnt(8)
    v_mfma_f32_16x16x32_bf16 v[8:11], v[72:75], a[48:51], v[8:11]
    ds_read_b64_tr_b16 v[64:65], v116 offset:16384
    buffer_load_dwordx4 a[100:103], v249, s[60:63], s75 offen offset:2048 sc1
    v_mfma_f32_16x16x32_bf16 v[8:11], v[76:79], a[52:55], v[8:11]
    ds_read_b64_tr_b16 v[66:67], v116 offset:16640
    v_mfma_f32_16x16x32_bf16 v[12:15], v[72:75], a[56:59], v[12:15]
    ds_read_b64_tr_b16 v[68:69], v116 offset:18432
    v_mfma_f32_16x16x32_bf16 v[12:15], v[76:79], a[60:63], v[12:15]
    ds_read_b64_tr_b16 v[70:71], v116 offset:18688
    s_waitcnt lgkmcnt(8)
    v_mfma_f32_16x16x32_bf16 v[16:19], v[80:83], a[48:51], v[16:19]
    ds_read_b64_tr_b16 v[72:73], v117 offset:16384
    buffer_load_dwordx4 a[104:107], v249, s[60:63], s75 offen offset:256 sc1
    v_mfma_f32_16x16x32_bf16 v[16:19], v[84:87], a[52:55], v[16:19]
    ds_read_b64_tr_b16 v[74:75], v117 offset:16640
    v_mfma_f32_16x16x32_bf16 v[20:23], v[80:83], a[56:59], v[20:23]
    ds_read_b64_tr_b16 v[76:77], v117 offset:18432
    v_mfma_f32_16x16x32_bf16 v[20:23], v[84:87], a[60:63], v[20:23]
    ds_read_b64_tr_b16 v[78:79], v117 offset:18688
    s_waitcnt lgkmcnt(8)
    v_mfma_f32_16x16x32_bf16 v[24:27], v[88:91], a[48:51], v[24:27]
    ds_read_b64_tr_b16 v[80:81], v116 offset:49152
    buffer_load_dwordx4 a[108:111], v249, s[60:63], s75 offen offset:2304 sc1
    v_mfma_f32_16x16x32_bf16 v[24:27], v[92:95], a[52:55], v[24:27]
    ds_read_b64_tr_b16 v[82:83], v116 offset:49408
    v_mfma_f32_16x16x32_bf16 v[28:31], v[88:91], a[56:59], v[28:31]
    ds_read_b64_tr_b16 v[84:85], v116 offset:51200
    v_mfma_f32_16x16x32_bf16 v[28:31], v[92:95], a[60:63], v[28:31]
    ds_read_b64_tr_b16 v[86:87], v116 offset:51456
    s_waitcnt vmcnt(10) lgkmcnt(8)
    v_mfma_f32_16x16x32_bf16 v[0:3], v[64:67], a[64:67], v[0:3]
    ds_read_b64_tr_b16 v[88:89], v117 offset:49152
    s_add_u32 s75, s75, 4096
    v_mfma_f32_16x16x32_bf16 v[0:3], v[68:71], a[68:71], v[0:3]
    ds_read_b64_tr_b16 v[90:91], v117 offset:49408
    buffer_load_dwordx4 a[112:115], v249, s[60:63], s75 offen offset:0 sc1
    s_waitcnt vmcnt(9)
    v_mfma_f32_16x16x32_bf16 v[4:7], v[64:67], a[72:75], v[4:7]
    ds_read_b64_tr_b16 v[92:93], v117 offset:51200
    v_mfma_f32_16x16x32_bf16 v[4:7], v[68:71], a[76:79], v[4:7]
    ds_read_b64_tr_b16 v[94:95], v117 offset:51456
    s_waitcnt lgkmcnt(8)
    v_mfma_f32_16x16x32_bf16 v[8:11], v[72:75], a[64:67], v[8:11]
    ds_read_b64_tr_b16 v[64:65], v116 offset:20480
    buffer_load_dwordx4 a[116:119], v249, s[60:63], s75 offen offset:2048 sc1
    v_mfma_f32_16x16x32_bf16 v[8:11], v[76:79], a[68:71], v[8:11]
    ds_read_b64_tr_b16 v[66:67], v116 offset:20736
    v_mfma_f32_16x16x32_bf16 v[12:15], v[72:75], a[72:75], v[12:15]
    ds_read_b64_tr_b16 v[68:69], v116 offset:22528
    v_mfma_f32_16x16x32_bf16 v[12:15], v[76:79], a[76:79], v[12:15]
    ds_read_b64_tr_b16 v[70:71], v116 offset:22784
    s_waitcnt lgkmcnt(8)
    v_mfma_f32_16x16x32_bf16 v[16:19], v[80:83], a[64:67], v[16:19]
    ds_read_b64_tr_b16 v[72:73], v117 offset:20480
    buffer_load_dwordx4 a[120:123], v249, s[60:63], s75 offen offset:256 sc1
    v_mfma_f32_16x16x32_bf16 v[16:19], v[84:87], a[68:71], v[16:19]
    ds_read_b64_tr_b16 v[74:75], v117 offset:20736
    v_mfma_f32_16x16x32_bf16 v[20:23], v[80:83], a[72:75], v[20:23]
    ds_read_b64_tr_b16 v[76:77], v117 offset:22528
    v_mfma_f32_16x16x32_bf16 v[20:23], v[84:87], a[76:79], v[20:23]
    ds_read_b64_tr_b16 v[78:79], v117 offset:22784
    s_waitcnt lgkmcnt(8)
    v_mfma_f32_16x16x32_bf16 v[24:27], v[88:91], a[64:67], v[24:27]
    ds_read_b64_tr_b16 v[80:81], v116 offset:53248
    buffer_load_dwordx4 a[124:127], v249, s[60:63], s75 offen offset:2304 sc1
    v_mfma_f32_16x16x32_bf16 v[24:27], v[92:95], a[68:71], v[24:27]
    ds_read_b64_tr_b16 v[82:83], v116 offset:53504
    v_mfma_f32_16x16x32_bf16 v[28:31], v[88:91], a[72:75], v[28:31]
    ds_read_b64_tr_b16 v[84:85], v116 offset:55296
    s_add_u32 m0, s78, 24576
    v_mfma_f32_16x16x32_bf16 v[28:31], v[92:95], a[76:79], v[28:31]
    ds_read_b64_tr_b16 v[86:87], v116 offset:55552
    s_add_u32 s66, s66, 81920
    s_waitcnt vmcnt(10) lgkmcnt(8)
    v_mfma_f32_16x16x32_bf16 v[0:3], v[64:67], a[80:83], v[0:3]
    ds_read_b64_tr_b16 v[88:89], v117 offset:53248
    s_add_u32 s75, s75, 4096
    v_mfma_f32_16x16x32_bf16 v[0:3], v[68:71], a[84:87], v[0:3]
    ds_read_b64_tr_b16 v[90:91], v117 offset:53504
    s_waitcnt vmcnt(8)
    v_mfma_f32_16x16x32_bf16 v[4:7], v[64:67], a[88:91], v[4:7]
    ds_read_b64_tr_b16 v[92:93], v117 offset:55296
    buffer_load_dwordx4 v255, s[48:51], s66 offen lds
    v_mfma_f32_16x16x32_bf16 v[4:7], v[68:71], a[92:95], v[4:7]
    ds_read_b64_tr_b16 v[94:95], v117 offset:55552
    s_waitcnt lgkmcnt(8)
    v_mfma_f32_16x16x32_bf16 v[8:11], v[72:75], a[80:83], v[8:11]
    ds_read_b64_tr_b16 v[64:65], v116 offset:24576
    s_add_u32 m0, s78, 26624
    v_mfma_f32_16x16x32_bf16 v[8:11], v[76:79], a[84:87], v[8:11]
    ds_read_b64_tr_b16 v[66:67], v116 offset:24832
    s_add_u32 s66, s66, 16384
    v_mfma_f32_16x16x32_bf16 v[12:15], v[72:75], a[88:91], v[12:15]
    ds_read_b64_tr_b16 v[68:69], v116 offset:26624
    v_mfma_f32_16x16x32_bf16 v[12:15], v[76:79], a[92:95], v[12:15]
    ds_read_b64_tr_b16 v[70:71], v116 offset:26880
    s_waitcnt lgkmcnt(8)
    v_mfma_f32_16x16x32_bf16 v[16:19], v[80:83], a[80:83], v[16:19]
    ds_read_b64_tr_b16 v[72:73], v117 offset:24576
    buffer_load_dwordx4 v255, s[48:51], s66 offen lds
    v_mfma_f32_16x16x32_bf16 v[16:19], v[84:87], a[84:87], v[16:19]
    ds_read_b64_tr_b16 v[74:75], v117 offset:24832
    v_mfma_f32_16x16x32_bf16 v[20:23], v[80:83], a[88:91], v[20:23]
    ds_read_b64_tr_b16 v[76:77], v117 offset:26624
    s_add_u32 m0, s78, 28672
    v_mfma_f32_16x16x32_bf16 v[20:23], v[84:87], a[92:95], v[20:23]
    ds_read_b64_tr_b16 v[78:79], v117 offset:26880
    s_waitcnt lgkmcnt(8)
    v_mfma_f32_16x16x32_bf16 v[24:27], v[88:91], a[80:83], v[24:27]
    ds_read_b64_tr_b16 v[80:81], v116 offset:57344
    s_add_u32 s66, s66, 81920
    v_mfma_f32_16x16x32_bf16 v[24:27], v[92:95], a[84:87], v[24:27]
    ds_read_b64_tr_b16 v[82:83], v116 offset:57600
    v_mfma_f32_16x16x32_bf16 v[28:31], v[88:91], a[88:91], v[28:31]
    ds_read_b64_tr_b16 v[84:85], v116 offset:59392
    buffer_load_dwordx4 v255, s[48:51], s66 offen lds
    v_mfma_f32_16x16x32_bf16 v[28:31], v[92:95], a[92:95], v[28:31]
    ds_read_b64_tr_b16 v[86:87], v116 offset:59648
    s_waitcnt vmcnt(9) lgkmcnt(8)
    v_mfma_f32_16x16x32_bf16 v[0:3], v[64:67], a[96:99], v[0:3]
    ds_read_b64_tr_b16 v[88:89], v117 offset:57344
    s_add_u32 m0, s78, 30720
    v_mfma_f32_16x16x32_bf16 v[0:3], v[68:71], a[100:103], v[0:3]
    ds_read_b64_tr_b16 v[90:91], v117 offset:57600
    s_waitcnt vmcnt(7)
    v_mfma_f32_16x16x32_bf16 v[4:7], v[64:67], a[104:107], v[4:7]
    ds_read_b64_tr_b16 v[92:93], v117 offset:59392
    s_add_u32 s66, s66, 16384
    v_mfma_f32_16x16x32_bf16 v[4:7], v[68:71], a[108:111], v[4:7]
    ds_read_b64_tr_b16 v[94:95], v117 offset:59648
    s_waitcnt lgkmcnt(8)
    v_mfma_f32_16x16x32_bf16 v[8:11], v[72:75], a[96:99], v[8:11]
    ds_read_b64_tr_b16 v[64:65], v116 offset:28672
    buffer_load_dwordx4 v255, s[48:51], s66 offen lds
    v_mfma_f32_16x16x32_bf16 v[8:11], v[76:79], a[100:103], v[8:11]
    ds_read_b64_tr_b16 v[66:67], v116 offset:28928
    v_mfma_f32_16x16x32_bf16 v[12:15], v[72:75], a[104:107], v[12:15]
    ds_read_b64_tr_b16 v[68:69], v116 offset:30720
    s_add_u32 s3, s3, 81920
    v_mfma_f32_16x16x32_bf16 v[12:15], v[76:79], a[108:111], v[12:15]
    ds_read_b64_tr_b16 v[70:71], v116 offset:30976
    s_waitcnt lgkmcnt(8)
    v_mfma_f32_16x16x32_bf16 v[16:19], v[80:83], a[96:99], v[16:19]
    ds_read_b64_tr_b16 v[72:73], v117 offset:28672
    v_mfma_f32_16x16x32_bf16 v[16:19], v[84:87], a[100:103], v[16:19]
    ds_read_b64_tr_b16 v[74:75], v117 offset:28928
    v_mfma_f32_16x16x32_bf16 v[20:23], v[80:83], a[104:107], v[20:23]
L_pad10:
    s_cbranch_execz L_pad11
    ds_read_b64_tr_b16 v[76:77], v117 offset:30720
    buffer_load_dwordx4 a[160:163], v255, s[48:51], s3 offen
    v_mfma_f32_16x16x32_bf16 v[20:23], v[84:87], a[108:111], v[20:23]
    ds_read_b64_tr_b16 v[78:79], v117 offset:30976
    s_waitcnt lgkmcnt(8)
    v_mfma_f32_16x16x32_bf16 v[24:27], v[88:91], a[96:99], v[24:27]
    ds_read_b64_tr_b16 v[80:81], v116 offset:61440
    s_add_u32 s3, s3, 16384
    v_mfma_f32_16x16x32_bf16 v[24:27], v[92:95], a[100:103], v[24:27]
    ds_read_b64_tr_b16 v[82:83], v116 offset:61696
    v_mfma_f32_16x16x32_bf16 v[28:31], v[88:91], a[104:107], v[28:31]
    ds_read_b64_tr_b16 v[84:85], v116 offset:63488
    v_mfma_f32_16x16x32_bf16 v[28:31], v[92:95], a[108:111], v[28:31]
    ds_read_b64_tr_b16 v[86:87], v116 offset:63744
    s_waitcnt vmcnt(7) lgkmcnt(8)
    v_mfma_f32_16x16x32_bf16 v[0:3], v[64:67], a[112:115], v[0:3]
    ds_read_b64_tr_b16 v[88:89], v117 offset:61440
    buffer_load_dwordx4 a[164:167], v255, s[48:51], s3 offen
    v_mfma_f32_16x16x32_bf16 v[0:3], v[68:71], a[116:119], v[0:3]
    ds_read_b64_tr_b16 v[90:91], v117 offset:61696
    s_waitcnt vmcnt(6)
    v_mfma_f32_16x16x32_bf16 v[4:7], v[64:67], a[120:123], v[4:7]
    ds_read_b64_tr_b16 v[92:93], v117 offset:63488
    s_add_u32 s3, s3, 81920
    v_mfma_f32_16x16x32_bf16 v[4:7], v[68:71], a[124:127], v[4:7]
    ds_read_b64_tr_b16 v[94:95], v117 offset:63744
    s_waitcnt lgkmcnt(8)
    v_mfma_f32_16x16x32_bf16 v[8:11], v[72:75], a[112:115], v[8:11]
    ds_read_b64_tr_b16 v[64:65], v118 offset:0
    v_mfma_f32_16x16x32_bf16 v[8:11], v[76:79], a[116:119], v[8:11]
    ds_read_b64_tr_b16 v[66:67], v118 offset:256
    v_mfma_f32_16x16x32_bf16 v[12:15], v[72:75], a[120:123], v[12:15]
    ds_read_b64_tr_b16 v[68:69], v118 offset:2048
    buffer_load_dwordx4 a[168:171], v255, s[48:51], s3 offen
    v_mfma_f32_16x16x32_bf16 v[12:15], v[76:79], a[124:127], v[12:15]
    ds_read_b64_tr_b16 v[70:71], v118 offset:2304
    s_waitcnt lgkmcnt(8)
    v_mfma_f32_16x16x32_bf16 v[16:19], v[80:83], a[112:115], v[16:19]
    ds_read_b64_tr_b16 v[72:73], v119 offset:0
    s_add_u32 s3, s3, 16384
    v_mfma_f32_16x16x32_bf16 v[16:19], v[84:87], a[116:119], v[16:19]
    ds_read_b64_tr_b16 v[74:75], v119 offset:256
    v_mfma_f32_16x16x32_bf16 v[20:23], v[80:83], a[120:123], v[20:23]
    ds_read_b64_tr_b16 v[76:77], v119 offset:2048
    v_mfma_f32_16x16x32_bf16 v[20:23], v[84:87], a[124:127], v[20:23]
    ds_read_b64_tr_b16 v[78:79], v119 offset:2304
    s_waitcnt lgkmcnt(8)
    v_mfma_f32_16x16x32_bf16 v[24:27], v[88:91], a[112:115], v[24:27]
    ds_read_b64_tr_b16 v[80:81], v118 offset:4096
    buffer_load_dwordx4 a[172:175], v255, s[48:51], s3 offen
    v_mfma_f32_16x16x32_bf16 v[24:27], v[92:95], a[116:119], v[24:27]
    ds_read_b64_tr_b16 v[82:83], v118 offset:4352
    v_mfma_f32_16x16x32_bf16 v[28:31], v[88:91], a[120:123], v[28:31]
    ds_read_b64_tr_b16 v[84:85], v118 offset:6144
    v_mfma_f32_16x16x32_bf16 v[28:31], v[92:95], a[124:127], v[28:31]
    ds_read_b64_tr_b16 v[86:87], v118 offset:6400
    s_barrier
    v_pk_mul_f32 v[96:97], v[0:1], v[0:1]
    v_pk_mul_f32 v[98:99], v[2:3], v[2:3]
    v_pk_mul_f32 v[100:101], v[4:5], v[4:5]
    v_pk_mul_f32 v[102:103], v[6:7], v[6:7]
    v_pk_fma_f32 v[96:97], v[96:97], v[124:125], v[126:127] op_sel_hi:[1,0,0]
    v_pk_fma_f32 v[98:99], v[98:99], v[124:125], v[126:127] op_sel_hi:[1,0,0]
    v_pk_fma_f32 v[100:101], v[100:101], v[124:125], v[126:127] op_sel_hi:[1,0,0]
    v_pk_fma_f32 v[102:103], v[102:103], v[124:125], v[126:127] op_sel_hi:[1,0,0]
    v_pk_mul_f32 v[96:97], v[96:97], v[0:1]
    v_pk_mul_f32 v[98:99], v[98:99], v[2:3]
    v_pk_mul_f32 v[100:101], v[100:101], v[4:5]
    s_add_u32 m0, s67, 0
    s_add_u32 s66, s66, 81920
    buffer_load_dwordx4 v255, s[48:51], s66 offen lds
    v_pk_mul_f32 v[102:103], v[102:103], v[6:7]
    v_exp_f32 v96, v96
    v_exp_f32 v97, v97
    v_exp_f32 v98, v98
    v_exp_f32 v99, v99
    v_exp_f32 v100, v100
    v_exp_f32 v101, v101
    v_exp_f32 v102, v102
    v_exp_f32 v103, v103
    v_pk_add_f32 v[96:97], v[96:97], 1.0 op_sel_hi:[1,0]
    v_pk_add_f32 v[98:99], v[98:99], 1.0 op_sel_hi:[1,0]
    v_pk_add_f32 v[100:101], v[100:101], 1.0 op_sel_hi:[1,0]
    v_pk_add_f32 v[102:103], v[102:103], 1.0 op_sel_hi:[1,0]
    v_rcp_f32 v96, v96
    v_rcp_f32 v97, v97
    v_rcp_f32 v98, v98
    v_rcp_f32 v99, v99
    v_rcp_f32 v100, v100
    v_rcp_f32 v101, v101
    v_rcp_f32 v102, v102
    v_rcp_f32 v103, v103
    v_pk_mul_f32 v[96:97], v[96:97], v[0:1]
    v_pk_mul_f32 v[98:99], v[98:99], v[2:3]
    v_pk_mul_f32 v[100:101], v[100:101], v[4:5]
    v_pk_mul_f32 v[102:103], v[102:103], v[6:7]
    v_cvt_pk_bf16_f32 v104, v96, v97
    v_cvt_pk_bf16_f32 v105, v98, v99
    v_cvt_pk_bf16_f32 v106, v100, v101
    s_add_u32 m0, s67, 2048
    s_add_u32 s66, s66, 16384
    buffer_load_dwordx4 v255, s[48:51], s66 offen lds
    v_cvt_pk_bf16_f32 v107, v102, v103
    v_pk_mul_f32 v[96:97], v[8:9], v[8:9]
    v_pk_mul_f32 v[98:99], v[10:11], v[10:11]
    v_permlane16_swap_b32 v104, v106
    v_permlane16_swap_b32 v105, v107
    buffer_store_dwordx4 v[104:107], v254, s[44:47], 0 offen offset:0 sc1
    v_pk_mul_f32 v[100:101], v[12:13], v[12:13]
    v_pk_mul_f32 v[102:103], v[14:15], v[14:15]
    v_pk_fma_f32 v[96:97], v[96:97], v[124:125], v[126:127] op_sel_hi:[1,0,0]
    v_pk_fma_f32 v[98:99], v[98:99], v[124:125], v[126:127] op_sel_hi:[1,0,0]
    v_pk_fma_f32 v[100:101], v[100:101], v[124:125], v[126:127] op_sel_hi:[1,0,0]
    v_pk_fma_f32 v[102:103], v[102:103], v[124:125], v[126:127] op_sel_hi:[1,0,0]
    v_pk_mul_f32 v[96:97], v[96:97], v[8:9]
    v_pk_mul_f32 v[98:99], v[98:99], v[10:11]
    v_pk_mul_f32 v[100:101], v[100:101], v[12:13]
    v_pk_mul_f32 v[102:103], v[102:103], v[14:15]
    v_exp_f32 v96, v96
    v_exp_f32 v97, v97
    v_exp_f32 v98, v98
    v_exp_f32 v99, v99
    v_exp_f32 v100, v100
    v_exp_f32 v101, v101
    v_exp_f32 v102, v102
    v_exp_f32 v103, v103
    v_pk_add_f32 v[96:97], v[96:97], 1.0 op_sel_hi:[1,0]
    v_pk_add_f32 v[98:99], v[98:99], 1.0 op_sel_hi:[1,0]
    v_pk_add_f32 v[100:101], v[100:101], 1.0 op_sel_hi:[1,0]
    v_pk_add_f32 v[102:103], v[102:103], 1.0 op_sel_hi:[1,0]
    s_add_u32 m0, s67, 4096
    s_add_u32 s66, s66, 81920
    buffer_load_dwordx4 v255, s[48:51], s66 offen lds
    v_rcp_f32 v96, v96
    v_rcp_f32 v97, v97
    v_rcp_f32 v98, v98
    v_rcp_f32 v99, v99
    v_rcp_f32 v100, v100
    v_rcp_f32 v101, v101
    v_rcp_f32 v102, v102
    v_rcp_f32 v103, v103
    v_pk_mul_f32 v[96:97], v[96:97], v[8:9]
    v_pk_mul_f32 v[98:99], v[98:99], v[10:11]
    v_pk_mul_f32 v[100:101], v[100:101], v[12:13]
    v_pk_mul_f32 v[102:103], v[102:103], v[14:15]
    v_cvt_pk_bf16_f32 v108, v96, v97
    v_cvt_pk_bf16_f32 v109, v98, v99
    v_cvt_pk_bf16_f32 v110, v100, v101
    v_cvt_pk_bf16_f32 v111, v102, v103
    v_pk_mul_f32 v[96:97], v[16:17], v[16:17]
    v_pk_mul_f32 v[98:99], v[18:19], v[18:19]
    v_permlane16_swap_b32 v108, v110
    v_permlane16_swap_b32 v109, v111
    buffer_store_dwordx4 v[108:111], v254, s[44:47], 0 offen offset:1024 sc1
    v_pk_mul_f32 v[100:101], v[20:21], v[20:21]
    v_pk_mul_f32 v[102:103], v[22:23], v[22:23]
    v_pk_fma_f32 v[96:97], v[96:97], v[124:125], v[126:127] op_sel_hi:[1,0,0]
    v_pk_fma_f32 v[98:99], v[98:99], v[124:125], v[126:127] op_sel_hi:[1,0,0]
    v_pk_fma_f32 v[100:101], v[100:101], v[124:125], v[126:127] op_sel_hi:[1,0,0]
    v_pk_fma_f32 v[102:103], v[102:103], v[124:125], v[126:127] op_sel_hi:[1,0,0]
    v_pk_mul_f32 v[96:97], v[96:97], v[16:17]
    s_add_u32 m0, s67, 6144
    s_add_u32 s66, s66, 16384
    buffer_load_dwordx4 v255, s[48:51], s66 offen lds
    v_pk_mul_f32 v[98:99], v[98:99], v[18:19]
    v_pk_mul_f32 v[100:101], v[100:101], v[20:21]
    v_pk_mul_f32 v[102:103], v[102:103], v[22:23]
    v_exp_f32 v96, v96
    v_exp_f32 v97, v97
    v_exp_f32 v98, v98
    v_exp_f32 v99, v99
    v_exp_f32 v100, v100
    v_exp_f32 v101, v101
    v_exp_f32 v102, v102
    v_exp_f32 v103, v103
    v_pk_add_f32 v[96:97], v[96:97], 1.0 op_sel_hi:[1,0]
    v_pk_add_f32 v[98:99], v[98:99], 1.0 op_sel_hi:[1,0]
    v_pk_add_f32 v[100:101], v[100:101], 1.0 op_sel_hi:[1,0]
    v_pk_add_f32 v[102:103], v[102:103], 1.0 op_sel_hi:[1,0]
    v_rcp_f32 v96, v96
    v_rcp_f32 v97, v97
    v_rcp_f32 v98, v98
    v_rcp_f32 v99, v99
    v_rcp_f32 v100, v100
    v_rcp_f32 v101, v101
    v_rcp_f32 v102, v102
    v_rcp_f32 v103, v103
    v_pk_mul_f32 v[96:97], v[96:97], v[16:17]
    v_pk_mul_f32 v[98:99], v[98:99], v[18:19]
    v_pk_mul_f32 v[100:101], v[100:101], v[20:21]
    v_pk_mul_f32 v[102:103], v[102:103], v[22:23]
    v_cvt_pk_bf16_f32 v112, v96, v97
    s_add_u32 m0, s67, 8192
    s_add_u32 s66, s66, 81920
    buffer_load_dwordx4 v255, s[48:51], s66 offen lds
    v_cvt_pk_bf16_f32 v113, v98, v99
    v_cvt_pk_bf16_f32 v114, v100, v101
    v_cvt_pk_bf16_f32 v115, v102, v103
    v_pk_mul_f32 v[96:97], v[24:25], v[24:25]
    v_pk_mul_f32 v[98:99], v[26:27], v[26:27]
    v_permlane16_swap_b32 v112, v114
    v_permlane16_swap_b32 v113, v115
    buffer_store_dwordx4 v[112:115], v254, s[44:47], 0 offen offset:2048 sc1
    v_pk_mul_f32 v[100:101], v[28:29], v[28:29]
    v_pk_mul_f32 v[102:103], v[30:31], v[30:31]
    v_pk_fma_f32 v[96:97], v[96:97], v[124:125], v[126:127] op_sel_hi:[1,0,0]
    v_pk_fma_f32 v[98:99], v[98:99], v[124:125], v[126:127] op_sel_hi:[1,0,0]
    v_pk_fma_f32 v[100:101], v[100:101], v[124:125], v[126:127] op_sel_hi:[1,0,0]
    v_pk_fma_f32 v[102:103], v[102:103], v[124:125], v[126:127] op_sel_hi:[1,0,0]
    v_pk_mul_f32 v[96:97], v[96:97], v[24:25]
    v_pk_mul_f32 v[98:99], v[98:99], v[26:27]
    v_pk_mul_f32 v[100:101], v[100:101], v[28:29]
    v_pk_mul_f32 v[102:103], v[102:103], v[30:31]
    v_exp_f32 v96, v96
    v_exp_f32 v97, v97
    v_exp_f32 v98, v98
    v_exp_f32 v99, v99
    v_exp_f32 v100, v100
    v_exp_f32 v101, v101
    v_exp_f32 v102, v102
    v_exp_f32 v103, v103
    v_pk_add_f32 v[96:97], v[96:97], 1.0 op_sel_hi:[1,0]
    v_pk_add_f32 v[98:99], v[98:99], 1.0 op_sel_hi:[1,0]
    s_add_u32 m0, s67, 10240
    s_add_u32 s66, s66, 16384
    buffer_load_dwordx4 v255, s[48:51], s66 offen lds
    v_pk_add_f32 v[100:101], v[100:101], 1.0 op_sel_hi:[1,0]
    v_pk_add_f32 v[102:103], v[102:103], 1.0 op_sel_hi:[1,0]
    v_rcp_f32 v96, v96
    v_rcp_f32 v97, v97
    v_rcp_f32 v98, v98
    v_rcp_f32 v99, v99
    v_rcp_f32 v100, v100
    v_rcp_f32 v101, v101
    v_rcp_f32 v102, v102
    v_rcp_f32 v103, v103
    v_pk_mul_f32 v[96:97], v[96:97], v[24:25]
    v_pk_mul_f32 v[98:99], v[98:99], v[26:27]
    v_pk_mul_f32 v[100:101], v[100:101], v[28:29]
    v_pk_mul_f32 v[102:103], v[102:103], v[30:31]
    v_cvt_pk_bf16_f32 v104, v96, v97
    v_cvt_pk_bf16_f32 v105, v98, v99
    v_cvt_pk_bf16_f32 v106, v100, v101
    v_cvt_pk_bf16_f32 v107, v102, v103
    s_nop 0
    v_permlane16_swap_b32 v104, v106
    v_permlane16_swap_b32 v105, v107
    buffer_store_dwordx4 v[104:107], v254, s[44:47], 0 offen offset:3072 sc1
    s_waitcnt lgkmcnt(8)
    v_mfma_f32_16x16x32_bf16 v[32:35], v[64:67], a[0:3], v[32:35]
    ds_read_b64_tr_b16 v[88:89], v119 offset:4096
    v_mfma_f32_16x16x32_bf16 v[32:35], v[68:71], a[4:7], v[32:35]
    ds_read_b64_tr_b16 v[90:91], v119 offset:4352
    v_mfma_f32_16x16x32_bf16 v[36:39], v[64:67], a[8:11], v[36:39]
    ds_read_b64_tr_b16 v[92:93], v119 offset:6144
    s_add_u32 m0, s67, 12288
    v_mfma_f32_16x16x32_bf16 v[36:39], v[68:71], a[12:15], v[36:39]
    ds_read_b64_tr_b16 v[94:95], v119 offset:6400
    s_waitcnt lgkmcnt(8)
    v_mfma_f32_16x16x32_bf16 v[40:43], v[72:75], a[0:3], v[40:43]
    ds_read_b64_tr_b16 v[64:65], v118 offset:8192
    s_add_u32 s66, s66, 81920
    v_mfma_f32_16x16x32_bf16 v[40:43], v[76:79], a[4:7], v[40:43]
    ds_read_b64_tr_b16 v[66:67], v118 offset:8448
    v_mfma_f32_16x16x32_bf16 v[44:47], v[72:75], a[8:11], v[44:47]
    ds_read_b64_tr_b16 v[68:69], v118 offset:10240
    buffer_load_dwordx4 v255, s[48:51], s66 offen lds
    v_mfma_f32_16x16x32_bf16 v[44:47], v[76:79], a[12:15], v[44:47]
    ds_read_b64_tr_b16 v[70:71], v118 offset:10496
    s_waitcnt lgkmcnt(8)
    v_mfma_f32_16x16x32_bf16 v[32:35], v[80:83], a[16:19], v[32:35]
    ds_read_b64_tr_b16 v[72:73], v119 offset:8192
    v_mfma_f32_16x16x32_bf16 v[32:35], v[84:87], a[20:23], v[32:35]
    ds_read_b64_tr_b16 v[74:75], v119 offset:8448
    v_mfma_f32_16x16x32_bf16 v[36:39], v[80:83], a[24:27], v[36:39]
    ds_read_b64_tr_b16 v[76:77], v119 offset:10240
    s_add_u32 m0, s67, 14336
    v_mfma_f32_16x16x32_bf16 v[36:39], v[84:87], a[28:31], v[36:39]
    ds_read_b64_tr_b16 v[78:79], v119 offset:10496
    s_waitcnt lgkmcnt(8)
    v_mfma_f32_16x16x32_bf16 v[40:43], v[88:91], a[16:19], v[40:43]
    ds_read_b64_tr_b16 v[80:81], v118 offset:12288
    s_add_u32 s66, s66, 16384
    v_mfma_f32_16x16x32_bf16 v[40:43], v[92:95], a[20:23], v[40:43]
    ds_read_b64_tr_b16 v[82:83], v118 offset:12544
    v_mfma_f32_16x16x32_bf16 v[44:47], v[88:91], a[24:27], v[44:47]
    ds_read_b64_tr_b16 v[84:85], v118 offset:14336
    buffer_load_dwordx4 v255, s[48:51], s66 offen lds
    v_mfma_f32_16x16x32_bf16 v[44:47], v[92:95], a[28:31], v[44:47]
    ds_read_b64_tr_b16 v[86:87], v118 offset:14592
    s_waitcnt lgkmcnt(8)
    v_mfma_f32_16x16x32_bf16 v[32:35], v[64:67], a[32:35], v[32:35]
    ds_read_b64_tr_b16 v[88:89], v119 offset:12288
    v_mfma_f32_16x16x32_bf16 v[32:35], v[68:71], a[36:39], v[32:35]
    ds_read_b64_tr_b16 v[90:91], v119 offset:12544
    v_mfma_f32_16x16x32_bf16 v[36:39], v[64:67], a[40:43], v[36:39]
    ds_read_b64_tr_b16 v[92:93], v119 offset:14336
    s_add_u32 m0, s67, 16384
    v_mfma_f32_16x16x32_bf16 v[36:39], v[68:71], a[44:47], v[36:39]
    ds_read_b64_tr_b16 v[94:95], v119 offset:14592
    s_waitcnt lgkmcnt(8)
    v_mfma_f32_16x16x32_bf16 v[40:43], v[72:75], a[32:35], v[40:43]
    ds_read_b64_tr_b16 v[64:65], v118 offset:16384
    s_add_u32 s66, s66, 81920
    v_mfma_f32_16x16x32_bf16 v[40:43], v[76:79], a[36:39], v[40:43]
    ds_read_b64_tr_b16 v[66:67], v118 offset:16640
    v_mfma_f32_16x16x32_bf16 v[44:47], v[72:75], a[40:43], v[44:47]
    ds_read_b64_tr_b16 v[68:69], v118 offset:18432
    buffer_load_dwordx4 v255, s[48:51], s66 offen lds
    v_mfma_f32_16x16x32_bf16 v[44:47], v[76:79], a[44:47], v[44:47]
    ds_read_b64_tr_b16 v[70:71], v118 offset:18688
    s_waitcnt lgkmcnt(8)
    v_mfma_f32_16x16x32_bf16 v[32:35], v[80:83], a[48:51], v[32:35]
    ds_read_b64_tr_b16 v[72:73], v119 offset:16384
    v_mfma_f32_16x16x32_bf16 v[32:35], v[84:87], a[52:55], v[32:35]
    ds_read_b64_tr_b16 v[74:75], v119 offset:16640
    v_mfma_f32_16x16x32_bf16 v[36:39], v[80:83], a[56:59], v[36:39]
    ds_read_b64_tr_b16 v[76:77], v119 offset:18432
    s_add_u32 m0, s67, 18432
    v_mfma_f32_16x16x32_bf16 v[36:39], v[84:87], a[60:63], v[36:39]
    ds_read_b64_tr_b16 v[78:79], v119 offset:18688
    s_waitcnt lgkmcnt(8)
    v_mfma_f32_16x16x32_bf16 v[40:43], v[88:91], a[48:51], v[40:43]
    ds_read_b64_tr_b16 v[80:81], v118 offset:20480
    s_add_u32 s66, s66, 16384
    v_mfma_f32_16x16x32_bf16 v[40:43], v[92:95], a[52:55], v[40:43]
    ds_read_b64_tr_b16 v[82:83], v118 offset:20736
    v_mfma_f32_16x16x32_bf16 v[44:47], v[88:91], a[56:59], v[44:47]
    ds_read_b64_tr_b16 v[84:85], v118 offset:22528
    buffer_load_dwordx4 v255, s[48:51], s66 offen lds
    v_mfma_f32_16x16x32_bf16 v[44:47], v[92:95], a[60:63], v[44:47]
    ds_read_b64_tr_b16 v[86:87], v118 offset:22784
    s_waitcnt lgkmcnt(8)
    v_mfma_f32_16x16x32_bf16 v[32:35], v[64:67], a[64:67], v[32:35]
    ds_read_b64_tr_b16 v[88:89], v119 offset:20480
    v_mfma_f32_16x16x32_bf16 v[32:35], v[68:71], a[68:71], v[32:35]
    ds_read_b64_tr_b16 v[90:91], v119 offset:20736
    v_mfma_f32_16x16x32_bf16 v[36:39], v[64:67], a[72:75], v[36:39]
    ds_read_b64_tr_b16 v[92:93], v119 offset:22528
    s_add_u32 m0, s67, 20480
    v_mfma_f32_16x16x32_bf16 v[36:39], v[68:71], a[76:79], v[36:39]
    ds_read_b64_tr_b16 v[94:95], v119 offset:22784
    s_waitcnt lgkmcnt(8)
    v_mfma_f32_16x16x32_bf16 v[40:43], v[72:75], a[64:67], v[40:43]
    ds_read_b64_tr_b16 v[64:65], v118 offset:24576
    s_add_u32 s66, s66, 81920
    v_mfma_f32_16x16x32_bf16 v[40:43], v[76:79], a[68:71], v[40:43]
    ds_read_b64_tr_b16 v[66:67], v118 offset:24832
    s_waitcnt vmcnt(4)
    s_barrier
    s_cmp_lg_u32 s34, 0
    s_cbranch_scc1 L_nsig13
    s_mov_b64 exec, 0xffff
    buffer_atomic_add v234, v235, s[40:43], s73 offen offset:16 sc1
    s_mov_b64 exec, -1
L_nsig13:
    v_mfma_f32_16x16x32_bf16 v[44:47], v[72:75], a[72:75], v[44:47]
    ds_read_b64_tr_b16 v[68:69], v118 offset:26624
    buffer_load_dwordx4 v255, s[48:51], s66 offen lds
    v_mfma_f32_16x16x32_bf16 v[44:47], v[76:79], a[76:79], v[44:47]
    ds_read_b64_tr_b16 v[70:71], v118 offset:26880
    s_waitcnt lgkmcnt(8)
    v_mfma_f32_16x16x32_bf16 v[32:35], v[80:83], a[80:83], v[32:35]
    ds_read_b64_tr_b16 v[72:73], v119 offset:24576
    v_mfma_f32_16x16x32_bf16 v[32:35], v[84:87], a[84:87], v[32:35]
    ds_read_b64_tr_b16 v[74:75], v119 offset:24832
    v_mfma_f32_16x16x32_bf16 v[36:39], v[80:83], a[88:91], v[36:39]
    ds_read_b64_tr_b16 v[76:77], v119 offset:26624
    s_add_u32 m0, s67, 22528
    v_mfma_f32_16x16x32_bf16 v[36:39], v[84:87], a[92:95], v[36:39]
    ds_read_b64_tr_b16 v[78:79], v119 offset:26880
    s_waitcnt lgkmcnt(8)
    v_mfma_f32_16x16x32_bf16 v[40:43], v[88:91], a[80:83], v[40:43]
    ds_read_b64_tr_b16 v[80:81], v118 offset:28672
    s_add_u32 s66, s66, 16384
    v_mfma_f32_16x16x32_bf16 v[40:43], v[92:95], a[84:87], v[40:43]
    ds_read_b64_tr_b16 v[82:83], v118 offset:28928
    v_mfma_f32_16x16x32_bf16 v[44:47], v[88:91], a[88:91], v[44:47]
    ds_read_b64_tr_b16 v[84:85], v118 offset:30720
    buffer_load_dwordx4 v255, s[48:51], s66 offen lds
    v_mfma_f32_16x16x32_bf16 v[44:47], v[92:95], a[92:95], v[44:47]
    ds_read_b64_tr_b16 v[86:87], v118 offset:30976
    s_waitcnt lgkmcnt(8)
    v_mfma_f32_16x16x32_bf16 v[32:35], v[64:67], a[96:99], v[32:35]
    ds_read_b64_tr_b16 v[88:89], v119 offset:28672
    v_mfma_f32_16x16x32_bf16 v[32:35], v[68:71], a[100:103], v[32:35]
    ds_read_b64_tr_b16 v[90:91], v119 offset:28928
    v_mfma_f32_16x16x32_bf16 v[36:39], v[64:67], a[104:107], v[36:39]
    ds_read_b64_tr_b16 v[92:93], v119 offset:30720
    s_add_u32 m0, s67, 24576
    v_mfma_f32_16x16x32_bf16 v[36:39], v[68:71], a[108:111], v[36:39]
    ds_read_b64_tr_b16 v[94:95], v119 offset:30976
    s_waitcnt lgkmcnt(8)
    v_mfma_f32_16x16x32_bf16 v[40:43], v[72:75], a[96:99], v[40:43]
    s_add_u32 s66, s66, 81920
    v_mfma_f32_16x16x32_bf16 v[40:43], v[76:79], a[100:103], v[40:43]
    v_mfma_f32_16x16x32_bf16 v[44:47], v[72:75], a[104:107], v[44:47]
    buffer_load_dwordx4 v255, s[48:51], s66 offen lds
    v_mfma_f32_16x16x32_bf16 v[44:47], v[76:79], a[108:111], v[44:47]
    s_waitcnt lgkmcnt(4)
    v_mfma_f32_16x16x32_bf16 v[32:35], v[80:83], a[112:115], v[32:35]
    v_mfma_f32_16x16x32_bf16 v[32:35], v[84:87], a[116:119], v[32:35]
    v_mfma_f32_16x16x32_bf16 v[36:39], v[80:83], a[120:123], v[36:39]
    s_add_u32 m0, s67, 26624
    s_add_u32 s66, s66, 16384
    v_mfma_f32_16x16x32_bf16 v[36:39], v[84:87], a[124:127], v[36:39]
    s_waitcnt lgkmcnt(0)
    v_mfma_f32_16x16x32_bf16 v[40:43], v[88:91], a[112:115], v[40:43]
    v_mfma_f32_16x16x32_bf16 v[40:43], v[92:95], a[116:119], v[40:43]
    v_mfma_f32_16x16x32_bf16 v[44:47], v[88:91], a[120:123], v[44:47]
    buffer_load_dwordx4 v255, s[48:51], s66 offen lds
    v_mfma_f32_16x16x32_bf16 v[44:47], v[92:95], a[124:127], v[44:47]
    s_nop 3
    v_pk_mul_f32 v[96:97], v[32:33], v[32:33]
    v_pk_mul_f32 v[98:99], v[34:35], v[34:35]
    v_pk_mul_f32 v[100:101], v[36:37], v[36:37]
    v_pk_mul_f32 v[102:103], v[38:39], v[38:39]
    v_pk_fma_f32 v[96:97], v[96:97], v[124:125], v[126:127] op_sel_hi:[1,0,0]
    s_add_u32 m0, s67, 28672
    s_sub_u32 s66, s66, s38
    buffer_load_dwordx4 v255, s[48:51], s66 offen lds
    v_pk_fma_f32 v[98:99], v[98:99], v[124:125], v[126:127] op_sel_hi:[1,0,0]
    v_pk_fma_f32 v[100:101], v[100:101], v[124:125], v[126:127] op_sel_hi:[1,0,0]
    v_pk_fma_f32 v[102:103], v[102:103], v[124:125], v[126:127] op_sel_hi:[1,0,0]
    v_pk_mul_f32 v[96:97], v[96:97], v[32:33]
    v_pk_mul_f32 v[98:99], v[98:99], v[34:35]
    v_pk_mul_f32 v[100:101], v[100:101], v[36:37]
    v_pk_mul_f32 v[102:103], v[102:103], v[38:39]
    v_exp_f32 v96, v96
    v_exp_f32 v97, v97
    v_exp_f32 v98, v98
    v_exp_f32 v99, v99
    v_exp_f32 v100, v100
    s_add_u32 m0, s67, 30720
    s_add_u32 s66, s66, 16384
    buffer_load_dwordx4 v255, s[48:51], s66 offen lds
    v_exp_f32 v101, v101
    v_exp_f32 v102, v102
    v_exp_f32 v103, v103
    v_pk_add_f32 v[96:97], v[96:97], 1.0 op_sel_hi:[1,0]
    v_pk_add_f32 v[98:99], v[98:99], 1.0 op_sel_hi:[1,0]
    v_pk_add_f32 v[100:101], v[100:101], 1.0 op_sel_hi:[1,0]
    v_pk_add_f32 v[102:103], v[102:103], 1.0 op_sel_hi:[1,0]
    s_load_dword s96, s[98:99], 16 glc
    v_rcp_f32 v96, v96
    v_rcp_f32 v97, v97
    v_rcp_f32 v98, v98
    v_rcp_f32 v99, v99
    v_rcp_f32 v100, v100
    v_rcp_f32 v101, v101
    v_rcp_f32 v102, v102
    v_rcp_f32 v103, v103
    v_pk_mul_f32 v[96:97], v[96:97], v[32:33]
    v_pk_mul_f32 v[98:99], v[98:99], v[34:35]
    v_pk_mul_f32 v[100:101], v[100:101], v[36:37]
    v_pk_mul_f32 v[102:103], v[102:103], v[38:39]
    v_cvt_pk_bf16_f32 v108, v96, v97
    v_cvt_pk_bf16_f32 v109, v98, v99
    v_cvt_pk_bf16_f32 v110, v100, v101
    v_cvt_pk_bf16_f32 v111, v102, v103
    v_pk_mul_f32 v[96:97], v[40:41], v[40:41]
    v_pk_mul_f32 v[98:99], v[42:43], v[42:43]
    v_permlane16_swap_b32 v108, v110
    v_permlane16_swap_b32 v109, v111
    buffer_store_dwordx4 v[108:111], v254, s[44:47], s69 offen offset:0 sc1
    v_pk_mul_f32 v[100:101], v[44:45], v[44:45]
    v_pk_mul_f32 v[102:103], v[46:47], v[46:47]
    v_pk_fma_f32 v[96:97], v[96:97], v[124:125], v[126:127] op_sel_hi:[1,0,0]
    v_pk_fma_f32 v[98:99], v[98:99], v[124:125], v[126:127] op_sel_hi:[1,0,0]
    v_pk_fma_f32 v[100:101], v[100:101], v[124:125], v[126:127] op_sel_hi:[1,0,0]
    v_pk_fma_f32 v[102:103], v[102:103], v[124:125], v[126:127] op_sel_hi:[1,0,0]
    v_pk_mul_f32 v[96:97], v[96:97], v[40:41]
    v_pk_mul_f32 v[98:99], v[98:99], v[42:43]
    v_pk_mul_f32 v[100:101], v[100:101], v[44:45]
    v_pk_mul_f32 v[102:103], v[102:103], v[46:47]
    v_exp_f32 v96, v96
    v_exp_f32 v97, v97
    v_exp_f32 v98, v98
    v_exp_f32 v99, v99
    v_exp_f32 v100, v100
    v_exp_f32 v101, v101
    v_exp_f32 v102, v102
    v_exp_f32 v103, v103
    v_pk_add_f32 v[96:97], v[96:97], 1.0 op_sel_hi:[1,0]
    v_pk_add_f32 v[98:99], v[98:99], 1.0 op_sel_hi:[1,0]
    v_pk_add_f32 v[100:101], v[100:101], 1.0 op_sel_hi:[1,0]
    v_pk_add_f32 v[102:103], v[102:103], 1.0 op_sel_hi:[1,0]
    v_rcp_f32 v96, v96
    v_rcp_f32 v97, v97
    v_rcp_f32 v98, v98
    v_rcp_f32 v99, v99
    v_rcp_f32 v100, v100
    v_rcp_f32 v101, v101
    v_rcp_f32 v102, v102
    v_rcp_f32 v103, v103
    v_pk_mul_f32 v[96:97], v[96:97], v[40:41]
    v_pk_mul_f32 v[98:99], v[98:99], v[42:43]
    v_pk_mul_f32 v[100:101], v[100:101], v[44:45]
    v_pk_mul_f32 v[102:103], v[102:103], v[46:47]
    v_cvt_pk_bf16_f32 v112, v96, v97
    v_cvt_pk_bf16_f32 v113, v98, v99
    v_cvt_pk_bf16_f32 v114, v100, v101
    v_cvt_pk_bf16_f32 v115, v102, v103
    s_nop 0
    v_permlane16_swap_b32 v112, v114
    v_permlane16_swap_b32 v113, v115
    buffer_store_dwordx4 v[112:115], v254, s[44:47], s69 offen offset:1024 sc1
    ds_read_b64_tr_b16 v[64:65], v162 offset:0
    ds_read_b64_tr_b16 v[66:67], v162 offset:512
    ds_read_b64_tr_b16 v[68:69], v162 offset:4096
    ds_read_b64_tr_b16 v[70:71], v162 offset:4608
    ds_read_b64_tr_b16 v[72:73], v163 offset:0
    ds_read_b64_tr_b16 v[74:75], v163 offset:512
    ds_read_b64_tr_b16 v[76:77], v163 offset:4096
    ds_read_b64_tr_b16 v[78:79], v163 offset:4608
    ds_read_b64_tr_b16 v[80:81], v162 offset:256
    ds_read_b64_tr_b16 v[82:83], v162 offset:768
    ds_read_b64_tr_b16 v[84:85], v162 offset:4352
    ds_read_b64_tr_b16 v[86:87], v162 offset:4864
    s_waitcnt lgkmcnt(0)
    s_cmp_ge_u32 s96, 16
    s_cbranch_scc1 L_pk18
    s_mov_b32 s97, 0
L_poll19:
    s_load_dword s96, s[98:99], 16 glc
    s_add_u32 s97, s97, 1
    s_cmp_gt_u32 s97, 200000
    s_cbranch_scc1 L_pout19
    s_waitcnt lgkmcnt(0)
    s_cmp_lt_u32 s96, 16
    s_cbranch_scc1 L_poll19
L_pout19:
    s_waitcnt lgkmcnt(0)
L_pk18:
    s_waitcnt lgkmcnt(0)
    buffer_load_dwordx4 a[0:3], v249, s[56:59], s72 offen offset:0 sc1
    buffer_load_dwordx4 a[4:7], v249, s[56:59], s72 offen offset:256 sc1
    s_add_u32 s72, s72, 6144
    buffer_load_dwordx4 a[8:11], v249, s[56:59], s72 offen offset:0 sc1
    buffer_load_dwordx4 a[12:15], v249, s[56:59], s72 offen offset:256 sc1
    s_add_u32 s72, s72, 6144
    buffer_load_dwordx4 a[16:19], v249, s[56:59], s72 offen offset:0 sc1
    buffer_load_dwordx4 a[20:23], v249, s[56:59], s72 offen offset:256 sc1
    s_add_u32 s72, s72, 6144
    buffer_load_dwordx4 a[24:27], v249, s[56:59], s72 offen offset:0 sc1
    buffer_load_dwordx4 a[28:31], v249, s[56:59], s72 offen offset:256 sc1
    s_add_u32 s72, s72, 6144
    buffer_load_dwordx4 a[32:35], v249, s[56:59], s72 offen offset:0 sc1
    buffer_load_dwordx4 a[36:39], v249, s[56:59], s72 offen offset:256 sc1
    s_add_u32 s72, s72, 6144
    buffer_load_dwordx4 a[40:43], v249, s[56:59], s72 offen offset:0 sc1
    buffer_load_dwordx4 a[44:47], v249, s[56:59], s72 offen offset:256 sc1
    s_waitcnt vmcnt(12)
    s_barrier
    s_cmp_lg_u32 s34, 0
    s_cbranch_scc1 L_nsig15
    s_mov_b64 exec, 0xffff
    buffer_atomic_add v234, v235, s[40:43], s73 offen offset:24 sc1
    s_mov_b64 exec, -1
L_nsig15:
    ds_write_b128 v122, a[128:131] offset:0
    ds_write_b128 v122, a[132:135] offset:2048
    ds_write_b128 v122, a[136:139] offset:4096
    ds_write_b128 v122, a[140:143] offset:6144
    ds_write_b128 v122, a[144:147] offset:8192
    ds_write_b128 v122, a[148:151] offset:10240
    ds_write_b128 v122, a[152:155] offset:12288
    ds_write_b128 v122, a[156:159] offset:14336
    s_add_u32 s72, s72, 6144
    buffer_load_dwordx4 a[48:51], v249, s[56:59], s72 offen offset:0 sc1
    buffer_load_dwordx4 a[52:55], v249, s[56:59], s72 offen offset:256 sc1
    s_add_u32 s72, s72, 6144
    buffer_load_dwordx4 a[56:59], v249, s[56:59], s72 offen offset:0 sc1
    buffer_load_dwordx4 a[60:63], v249, s[56:59], s72 offen offset:256 sc1
    s_add_u32 s72, s72, 6144
    s_waitcnt vmcnt(12)
    v_mfma_f32_16x16x32_bf16 v[0:3], v[64:67], a[0:3], 0
    ds_read_b64_tr_b16 v[88:89], v163 offset:256
    buffer_load_dwordx4 a[64:67], v249, s[56:59], s72 offen offset:0 sc1
    v_mfma_f32_16x16x32_bf16 v[0:3], v[68:71], a[8:11], v[0:3]
    ds_read_b64_tr_b16 v[90:91], v163 offset:768
    v_mfma_f32_16x16x32_bf16 v[4:7], v[64:67], a[4:7], 0
    ds_read_b64_tr_b16 v[92:93], v163 offset:4352
    v_mfma_f32_16x16x32_bf16 v[4:7], v[68:71], a[12:15], v[4:7]
    ds_read_b64_tr_b16 v[94:95], v163 offset:4864
    v_mfma_f32_16x16x32_bf16 v[8:11], v[72:75], a[0:3], 0
    ds_read_b64_tr_b16 v[64:65], v162 offset:8192
    buffer_load_dwordx4 a[68:71], v249, s[56:59], s72 offen offset:256 sc1
    v_mfma_f32_16x16x32_bf16 v[8:11], v[76:79], a[8:11], v[8:11]
    ds_read_b64_tr_b16 v[66:67], v162 offset:8704
    v_lshlrev_b32 v128, 16, v176
    v_mfma_f32_16x16x32_bf16 v[12:15], v[72:75], a[4:7], 0
    ds_read_b64_tr_b16 v[68:69], v162 offset:12288
    s_add_u32 s72, s72, 6144
    v_mfma_f32_16x16x32_bf16 v[12:15], v[76:79], a[12:15], v[12:15]
    ds_read_b64_tr_b16 v[70:71], v162 offset:12800
L_pad11:
    s_cbranch_execz L_warmed1
    v_mfma_f32_16x16x32_bf16 v[16:19], v[80:83], a[0:3], 0
    ds_read_b64_tr_b16 v[72:73], v163 offset:8192
    buffer_load_dwordx4 a[72:75], v249, s[56:59], s72 offen offset:0 sc1
    v_mfma_f32_16x16x32_bf16 v[16:19], v[84:87], a[8:11], v[16:19]
    ds_read_b64_tr_b16 v[74:75], v163 offset:8704
    v_and_b32 v129, 0xffff0000, v176
    v_mfma_f32_16x16x32_bf16 v[20:23], v[80:83], a[4:7], 0
    ds_read_b64_tr_b16 v[76:77], v163 offset:12288
    v_lshlrev_b32 v130, 16, v177
    v_mfma_f32_16x16x32_bf16 v[20:23], v[84:87], a[12:15], v[20:23]
    ds_read_b64_tr_b16 v[78:79], v163 offset:12800
    s_waitcnt lgkmcnt(8)
    v_mfma_f32_16x16x32_bf16 v[24:27], v[88:91], a[0:3], 0
    ds_read_b64_tr_b16 v[80:81], v162 offset:8448
    buffer_load_dwordx4 a[76:79], v249, s[56:59], s72 offen offset:256 sc1
    v_mfma_f32_16x16x32_bf16 v[24:27], v[92:95], a[8:11], v[24:27]
    ds_read_b64_tr_b16 v[82:83], v162 offset:8960
    v_and_b32 v131, 0xffff0000, v177
    v_mfma_f32_16x16x32_bf16 v[28:31], v[88:91], a[4:7], 0
    ds_read_b64_tr_b16 v[84:85], v162 offset:12544
    s_add_u32 s72, s72, 6144
    v_mfma_f32_16x16x32_bf16 v[28:31], v[92:95], a[12:15], v[28:31]
    ds_read_b64_tr_b16 v[86:87], v162 offset:13056
    s_waitcnt vmcnt(12) lgkmcnt(8)
    v_mfma_f32_16x16x32_bf16 v[0:3], v[64:67], a[16:19], v[0:3]
    ds_read_b64_tr_b16 v[88:89], v163 offset:8448
    buffer_load_dwordx4 a[80:83], v249, s[56:59], s72 offen offset:0 sc1
    v_mfma_f32_16x16x32_bf16 v[0:3], v[68:71], a[24:27], v[0:3]
    ds_read_b64_tr_b16 v[90:91], v163 offset:8960
    v_lshlrev_b32 v132, 16, v178
    v_mfma_f32_16x16x32_bf16 v[4:7], v[64:67], a[20:23], v[4:7]
    ds_read_b64_tr_b16 v[92:93], v163 offset:12544
    v_and_b32 v133, 0xffff0000, v178
    v_mfma_f32_16x16x32_bf16 v[4:7], v[68:71], a[28:31], v[4:7]
    ds_read_b64_tr_b16 v[94:95], v163 offset:13056
    s_waitcnt lgkmcnt(8)
    v_mfma_f32_16x16x32_bf16 v[8:11], v[72:75], a[16:19], v[8:11]
    ds_read_b64_tr_b16 v[64:65], v162 offset:16384
    buffer_load_dwordx4 a[84:87], v249, s[56:59], s72 offen offset:256 sc1
    v_mfma_f32_16x16x32_bf16 v[8:11], v[76:79], a[24:27], v[8:11]
    ds_read_b64_tr_b16 v[66:67], v162 offset:16896
    v_lshlrev_b32 v134, 16, v179
    v_mfma_f32_16x16x32_bf16 v[12:15], v[72:75], a[20:23], v[12:15]
    ds_read_b64_tr_b16 v[68:69], v162 offset:20480
    s_add_u32 s72, s72, 6144
    v_mfma_f32_16x16x32_bf16 v[12:15], v[76:79], a[28:31], v[12:15]
    ds_read_b64_tr_b16 v[70:71], v162 offset:20992
    s_waitcnt lgkmcnt(8)
    v_mfma_f32_16x16x32_bf16 v[16:19], v[80:83], a[16:19], v[16:19]
    ds_read_b64_tr_b16 v[72:73], v163 offset:16384
    buffer_load_dwordx4 a[88:91], v249, s[56:59], s72 offen offset:0 sc1
    v_mfma_f32_16x16x32_bf16 v[16:19], v[84:87], a[24:27], v[16:19]
    ds_read_b64_tr_b16 v[74:75], v163 offset:16896
    v_and_b32 v135, 0xffff0000, v179
    v_mfma_f32_16x16x32_bf16 v[20:23], v[80:83], a[20:23], v[20:23]
    ds_read_b64_tr_b16 v[76:77], v163 offset:20480
    s_load_dword s96, s[98:99], 24 glc
    v_mfma_f32_16x16x32_bf16 v[20:23], v[84:87], a[28:31], v[20:23]
    ds_read_b64_tr_b16 v[78:79], v163 offset:20992
    s_waitcnt lgkmcnt(8)
    v_mfma_f32_16x16x32_bf16 v[24:27], v[88:91], a[16:19], v[24:27]
    ds_read_b64_tr_b16 v[80:81], v162 offset:16640
    buffer_load_dwordx4 a[92:95], v249, s[56:59], s72 offen offset:256 sc1
    v_mfma_f32_16x16x32_bf16 v[24:27], v[92:95], a[24:27], v[24:27]
    ds_read_b64_tr_b16 v[82:83], v162 offset:17152
    v_lshlrev_b32 v136, 16, v192
    v_mfma_f32_16x16x32_bf16 v[28:31], v[88:91], a[20:23], v[28:31]
    ds_read_b64_tr_b16 v[84:85], v162 offset:20736
    s_add_u32 s72, s72, 6144
    v_mfma_f32_16x16x32_bf16 v[28:31], v[92:95], a[28:31], v[28:31]
    ds_read_b64_tr_b16 v[86:87], v162 offset:21248
    s_waitcnt vmcnt(12) lgkmcnt(8)
    v_mfma_f32_16x16x32_bf16 v[0:3], v[64:67], a[32:35], v[0:3]
    ds_read_b64_tr_b16 v[88:89], v163 offset:16640
    v_mfma_f32_16x16x32_bf16 v[0:3], v[68:71], a[40:43], v[0:3]
    ds_read_b64_tr_b16 v[90:91], v163 offset:17152
    s_barrier
    buffer_load_dwordx4 a[0:3], v249, s[56:59], s72 offen offset:0 sc1
    v_mfma_f32_16x16x32_bf16 v[4:7], v[64:67], a[36:39], v[4:7]
    ds_read_b64_tr_b16 v[92:93], v163 offset:20736
    v_and_b32 v137, 0xffff0000, v192
    v_mfma_f32_16x16x32_bf16 v[4:7], v[68:71], a[44:47], v[4:7]
    ds_read_b64_tr_b16 v[94:95], v163 offset:21248
    s_waitcnt lgkmcnt(8)
    v_mfma_f32_16x16x32_bf16 v[8:11], v[72:75], a[32:35], v[8:11]
    ds_read_b64_tr_b16 v[64:65], v162 offset:24576
    v_mfma_f32_16x16x32_bf16 v[8:11], v[76:79], a[40:43], v[8:11]
    ds_read_b64_tr_b16 v[66:67], v162 offset:25088
    ds_write_b128 v123, a[160:163] offset:0
    buffer_load_dwordx4 a[4:7], v249, s[56:59], s72 offen offset:256 sc1
    v_mfma_f32_16x16x32_bf16 v[12:15], v[72:75], a[36:39], v[12:15]
    ds_read_b64_tr_b16 v[68:69], v162 offset:28672
    s_add_u32 s72, s72, 6144
    v_mfma_f32_16x16x32_bf16 v[12:15], v[76:79], a[44:47], v[12:15]
    ds_read_b64_tr_b16 v[70:71], v162 offset:29184
    s_waitcnt lgkmcnt(9)
    v_mfma_f32_16x16x32_bf16 v[16:19], v[80:83], a[32:35], v[16:19]
    ds_read_b64_tr_b16 v[72:73], v163 offset:24576
    buffer_load_dwordx4 a[8:11], v249, s[56:59], s72 offen offset:0 sc1
    v_mfma_f32_16x16x32_bf16 v[16:19], v[84:87], a[40:43], v[16:19]
    ds_read_b64_tr_b16 v[74:75], v163 offset:25088
    v_lshlrev_b32 v138, 16, v193
    v_mfma_f32_16x16x32_bf16 v[20:23], v[80:83], a[36:39], v[20:23]
    ds_read_b64_tr_b16 v[76:77], v163 offset:28672
    v_and_b32 v139, 0xffff0000, v193
    v_mfma_f32_16x16x32_bf16 v[20:23], v[84:87], a[44:47], v[20:23]
    ds_read_b64_tr_b16 v[78:79], v163 offset:29184
    s_waitcnt lgkmcnt(9)
    v_mfma_f32_16x16x32_bf16 v[24:27], v[88:91], a[32:35], v[24:27]
    ds_read_b64_tr_b16 v[80:81], v162 offset:24832
    v_mfma_f32_16x16x32_bf16 v[24:27], v[92:95], a[40:43], v[24:27]
    ds_read_b64_tr_b16 v[82:83], v162 offset:25344
    ds_write_b128 v123, a[164:167] offset:2048
    buffer_load_dwordx4 a[12:15], v249, s[56:59], s72 offen offset:256 sc1
    v_mfma_f32_16x16x32_bf16 v[28:31], v[88:91], a[36:39], v[28:31]
    ds_read_b64_tr_b16 v[84:85], v162 offset:28928
    s_add_u32 s72, s72, 6144
    v_mfma_f32_16x16x32_bf16 v[28:31], v[92:95], a[44:47], v[28:31]
    ds_read_b64_tr_b16 v[86:87], v162 offset:29440
    s_waitcnt vmcnt(12) lgkmcnt(9)
    v_mfma_f32_16x16x32_bf16 v[0:3], v[64:67], a[48:51], v[0:3]
    ds_read_b64_tr_b16 v[88:89], v163 offset:24832
    buffer_load_dwordx4 a[16:19], v249, s[56:59], s72 offen offset:0 sc1
    v_mfma_f32_16x16x32_bf16 v[0:3], v[68:71], a[56:59], v[0:3]
    ds_read_b64_tr_b16 v[90:91], v163 offset:25344
    v_lshlrev_b32 v140, 16, v194
    v_mfma_f32_16x16x32_bf16 v[4:7], v[64:67], a[52:55], v[4:7]
    ds_read_b64_tr_b16 v[92:93], v163 offset:28928
    v_and_b32 v141, 0xffff0000, v194
    v_mfma_f32_16x16x32_bf16 v[4:7], v[68:71], a[60:63], v[4:7]
    ds_read_b64_tr_b16 v[94:95], v163 offset:29440
    s_waitcnt lgkmcnt(9)
    v_mfma_f32_16x16x32_bf16 v[8:11], v[72:75], a[48:51], v[8:11]
    ds_read_b64_tr_b16 v[64:65], v160 offset:0
    v_mfma_f32_16x16x32_bf16 v[8:11], v[76:79], a[56:59], v[8:11]
    ds_read_b64_tr_b16 v[66:67], v160 offset:512
    ds_write_b128 v123, a[168:171] offset:4096
    buffer_load_dwordx4 a[20:23], v249, s[56:59], s72 offen offset:256 sc1
    v_mfma_f32_16x16x32_bf16 v[12:15], v[72:75], a[52:55], v[12:15]
    ds_read_b64_tr_b16 v[68:69], v160 offset:4096
    v_lshlrev_b32 v142, 16, v195
    v_mfma_f32_16x16x32_bf16 v[12:15], v[76:79], a[60:63], v[12:15]
    ds_read_b64_tr_b16 v[70:71], v160 offset:4608
    s_waitcnt lgkmcnt(9)
    v_mfma_f32_16x16x32_bf16 v[16:19], v[80:83], a[48:51], v[16:19]
    ds_read_b64_tr_b16 v[72:73], v161 offset:0
    v_and_b32 v143, 0xffff0000, v195
    v_mfma_f32_16x16x32_bf16 v[16:19], v[84:87], a[56:59], v[16:19]
    ds_read_b64_tr_b16 v[74:75], v161 offset:512
    v_mfma_f32_16x16x32_bf16 v[20:23], v[80:83], a[52:55], v[20:23]
    ds_read_b64_tr_b16 v[76:77], v161 offset:4096
    v_mfma_f32_16x16x32_bf16 v[20:23], v[84:87], a[60:63], v[20:23]
    ds_read_b64_tr_b16 v[78:79], v161 offset:4608
    s_waitcnt lgkmcnt(0)
    s_cmp_ge_u32 s96, 16
    s_cbranch_scc1 L_pk16
    s_mov_b32 s97, 0
L_poll17:
    s_load_dword s96, s[98:99], 24 glc
    s_add_u32 s97, s97, 1
    s_cmp_gt_u32 s97, 200000
    s_cbranch_scc1 L_pout17
    s_waitcnt lgkmcnt(0)
    s_cmp_lt_u32 s96, 16
    s_cbranch_scc1 L_poll17
L_pout17:
    s_waitcnt lgkmcnt(0)
L_pk16:
    v_mfma_f32_16x16x32_bf16 v[24:27], v[88:91], a[48:51], v[24:27]
    ds_read_b64_tr_b16 v[80:81], v160 offset:256
    v_mfma_f32_16x16x32_bf16 v[24:27], v[92:95], a[56:59], v[24:27]
    ds_read_b64_tr_b16 v[82:83], v160 offset:768
    ds_write_b128 v123, a[172:175] offset:6144
    s_mul_i32 s72, s70, 43008
    s_add_u32 s72, s72, 4096
    v_mfma_f32_16x16x32_bf16 v[28:31], v[88:91], a[52:55], v[28:31]
    ds_read_b64_tr_b16 v[84:85], v160 offset:4352
    buffer_load_dwordx4 a[24:27], v249, s[56:59], s72 offen offset:0 sc1
    v_mfma_f32_16x16x32_bf16 v[28:31], v[92:95], a[60:63], v[28:31]
    ds_read_b64_tr_b16 v[86:87], v160 offset:4864
    s_waitcnt vmcnt(11)
    v_mfma_f32_16x16x32_bf16 v[0:3], v[64:67], a[64:67], v[0:3]
    ds_read_b64_tr_b16 v[88:89], v161 offset:256
    v_mfma_f32_16x16x32_bf16 v[0:3], v[68:71], a[72:75], v[0:3]
    ds_read_b64_tr_b16 v[90:91], v161 offset:768
    v_mfma_f32_16x16x32_bf16 v[4:7], v[64:67], a[68:71], v[4:7]
    ds_read_b64_tr_b16 v[92:93], v161 offset:4352
    buffer_load_dwordx4 a[28:31], v249, s[56:59], s72 offen offset:256 sc1
    v_mfma_f32_16x16x32_bf16 v[4:7], v[68:71], a[76:79], v[4:7]
    ds_read_b64_tr_b16 v[94:95], v161 offset:4864
    v_mfma_f32_16x16x32_bf16 v[8:11], v[72:75], a[64:67], v[8:11]
    ds_read_b64_tr_b16 v[64:65], v160 offset:8192
    s_add_u32 s72, s72, 6144
    v_mfma_f32_16x16x32_bf16 v[8:11], v[76:79], a[72:75], v[8:11]
    ds_read_b64_tr_b16 v[66:67], v160 offset:8704
    v_mfma_f32_16x16x32_bf16 v[12:15], v[72:75], a[68:71], v[12:15]
    ds_read_b64_tr_b16 v[68:69], v160 offset:12288
    buffer_load_dwordx4 a[32:35], v249, s[56:59], s72 offen offset:0 sc1
    v_mfma_f32_16x16x32_bf16 v[12:15], v[76:79], a[76:79], v[12:15]
    ds_read_b64_tr_b16 v[70:71], v160 offset:12800
    s_waitcnt lgkmcnt(8)
    v_mfma_f32_16x16x32_bf16 v[16:19], v[80:83], a[64:67], v[16:19]
    ds_read_b64_tr_b16 v[72:73], v161 offset:8192
    v_mfma_f32_16x16x32_bf16 v[16:19], v[84:87], a[72:75], v[16:19]
    ds_read_b64_tr_b16 v[74:75], v161 offset:8704
    v_mfma_f32_16x16x32_bf16 v[20:23], v[80:83], a[68:71], v[20:23]
    ds_read_b64_tr_b16 v[76:77], v161 offset:12288
    buffer_load_dwordx4 a[36:39], v249, s[56:59], s72 offen offset:256 sc1
    v_mfma_f32_16x16x32_bf16 v[20:23], v[84:87], a[76:79], v[20:23]
    ds_read_b64_tr_b16 v[78:79], v161 offset:12800
    s_waitcnt lgkmcnt(8)
    v_mfma_f32_16x16x32_bf16 v[24:27], v[88:91], a[64:67], v[24:27]
    ds_read_b64_tr_b16 v[80:81], v160 offset:8448
    s_add_u32 s72, s72, 6144
    v_mfma_f32_16x16x32_bf16 v[24:27], v[92:95], a[72:75], v[24:27]
    ds_read_b64_tr_b16 v[82:83], v160 offset:8960
    v_mfma_f32_16x16x32_bf16 v[28:31], v[88:91], a[68:71], v[28:31]
    ds_read_b64_tr_b16 v[84:85], v160 offset:12544
    buffer_load_dwordx4 a[40:43], v249, s[56:59], s72 offen offset:0 sc1
    v_mfma_f32_16x16x32_bf16 v[28:31], v[92:95], a[76:79], v[28:31]
    ds_read_b64_tr_b16 v[86:87], v160 offset:13056
    s_waitcnt vmcnt(11) lgkmcnt(8)
    v_mfma_f32_16x16x32_bf16 v[0:3], v[64:67], a[80:83], v[0:3]
    ds_read_b64_tr_b16 v[88:89], v161 offset:8448
    v_mfma_f32_16x16x32_bf16 v[0:3], v[68:71], a[88:91], v[0:3]
    ds_read_b64_tr_b16 v[90:91], v161 offset:8960
    v_mfma_f32_16x16x32_bf16 v[4:7], v[64:67], a[84:87], v[4:7]
    ds_read_b64_tr_b16 v[92:93], v161 offset:12544
    buffer_load_dwordx4 a[44:47], v249, s[56:59], s72 offen offset:256 sc1
    v_mfma_f32_16x16x32_bf16 v[4:7], v[68:71], a[92:95], v[4:7]
    ds_read_b64_tr_b16 v[94:95], v161 offset:13056
    s_waitcnt lgkmcnt(8)
    v_mfma_f32_16x16x32_bf16 v[8:11], v[72:75], a[80:83], v[8:11]
    ds_read_b64_tr_b16 v[64:65], v160 offset:16384
    s_add_u32 s72, s72, 6144
    v_mfma_f32_16x16x32_bf16 v[8:11], v[76:79], a[88:91], v[8:11]
    ds_read_b64_tr_b16 v[66:67], v160 offset:16896
    v_mfma_f32_16x16x32_bf16 v[12:15], v[72:75], a[84:87], v[12:15]
    ds_read_b64_tr_b16 v[68:69], v160 offset:20480
    buffer_load_dwordx4 a[48:51], v249, s[56:59], s72 offen offset:0 sc1
    v_mfma_f32_16x16x32_bf16 v[12:15], v[76:79], a[92:95], v[12:15]
    ds_read_b64_tr_b16 v[70:71], v160 offset:20992
    s_waitcnt lgkmcnt(8)
    v_mfma_f32_16x16x32_bf16 v[16:19], v[80:83], a[80:83], v[16:19]
    ds_read_b64_tr_b16 v[72:73], v161 offset:16384
    v_mfma_f32_16x16x32_bf16 v[16:19], v[84:87], a[88:91], v[16:19]
    ds_read_b64_tr_b16 v[74:75], v161 offset:16896
    v_mfma_f32_16x16x32_bf16 v[20:23], v[80:83], a[84:87], v[20:23]
    ds_read_b64_tr_b16 v[76:77], v161 offset:20480
    buffer_load_dwordx4 a[52:55], v249, s[56:59], s72 offen offset:256 sc1
    v_mfma_f32_16x16x32_bf16 v[20:23], v[84:87], a[92:95], v[20:23]
    ds_read_b64_tr_b16 v[78:79], v161 offset:20992
    s_waitcnt lgkmcnt(8)
    v_mfma_f32_16x16x32_bf16 v[24:27], v[88:91], a[80:83], v[24:27]
    ds_read_b64_tr_b16 v[80:81], v160 offset:16640
    s_add_u32 s72, s72, 6144
    v_mfma_f32_16x16x32_bf16 v[24:27], v[92:95], a[88:91], v[24:27]
    ds_read_b64_tr_b16 v[82:83], v160 offset:17152
    v_mfma_f32_16x16x32_bf16 v[28:31], v[88:91], a[84:87], v[28:31]
    ds_read_b64_tr_b16 v[84:85], v160 offset:20736
    buffer_load_dwordx4 a[56:59], v249, s[56:59], s72 offen offset:0 sc1
    v_mfma_f32_16x16x32_bf16 v[28:31], v[92:95], a[92:95], v[28:31]
    ds_read_b64_tr_b16 v[86:87], v160 offset:21248
    s_waitcnt vmcnt(11) lgkmcnt(8)
    v_mfma_f32_16x16x32_bf16 v[0:3], v[64:67], a[0:3], v[0:3]
    ds_read_b64_tr_b16 v[88:89], v161 offset:16640
    v_mfma_f32_16x16x32_bf16 v[0:3], v[68:71], a[8:11], v[0:3]
    ds_read_b64_tr_b16 v[90:91], v161 offset:17152
    v_mfma_f32_16x16x32_bf16 v[4:7], v[64:67], a[4:7], v[4:7]
    ds_read_b64_tr_b16 v[92:93], v161 offset:20736
    buffer_load_dwordx4 a[60:63], v249, s[56:59], s72 offen offset:256 sc1
    v_mfma_f32_16x16x32_bf16 v[4:7], v[68:71], a[12:15], v[4:7]
    ds_read_b64_tr_b16 v[94:95], v161 offset:21248
    s_waitcnt lgkmcnt(8)
    v_mfma_f32_16x16x32_bf16 v[8:11], v[72:75], a[0:3], v[8:11]
    ds_read_b64_tr_b16 v[64:65], v160 offset:24576
    s_add_u32 s72, s72, 6144
    v_mfma_f32_16x16x32_bf16 v[8:11], v[76:79], a[8:11], v[8:11]
    ds_read_b64_tr_b16 v[66:67], v160 offset:25088
    v_mfma_f32_16x16x32_bf16 v[12:15], v[72:75], a[4:7], v[12:15]
    ds_read_b64_tr_b16 v[68:69], v160 offset:28672
    buffer_load_dwordx4 a[64:67], v249, s[56:59], s72 offen offset:0 sc1
    v_mfma_f32_16x16x32_bf16 v[12:15], v[76:79], a[12:15], v[12:15]
    ds_read_b64_tr_b16 v[70:71], v160 offset:29184
    s_waitcnt lgkmcnt(8)
    v_mfma_f32_16x16x32_bf16 v[16:19], v[80:83], a[0:3], v[16:19]
    ds_read_b64_tr_b16 v[72:73], v161 offset:24576
    v_mfma_f32_16x16x32_bf16 v[16:19], v[84:87], a[8:11], v[16:19]
    ds_read_b64_tr_b16 v[74:75], v161 offset:25088
    v_mfma_f32_16x16x32_bf16 v[20:23], v[80:83], a[4:7], v[20:23]
    ds_read_b64_tr_b16 v[76:77], v161 offset:28672
    buffer_load_dwordx4 a[68:71], v249, s[56:59], s72 offen offset:256 sc1
    v_mfma_f32_16x16x32_bf16 v[20:23], v[84:87], a[12:15], v[20:23]
    ds_read_b64_tr_b16 v[78:79], v161 offset:29184
    s_waitcnt lgkmcnt(8)
    v_mfma_f32_16x16x32_bf16 v[24:27], v[88:91], a[0:3], v[24:27]
    ds_read_b64_tr_b16 v[80:81], v160 offset:24832
    s_add_u32 s72, s72, 6144
    v_mfma_f32_16x16x32_bf16 v[24:27], v[92:95], a[8:11], v[24:27]
    ds_read_b64_tr_b16 v[82:83], v160 offset:25344
    v_mfma_f32_16x16x32_bf16 v[28:31], v[88:91], a[4:7], v[28:31]
    ds_read_b64_tr_b16 v[84:85], v160 offset:28928
    buffer_load_dwordx4 a[72:75], v249, s[56:59], s72 offen offset:0 sc1
    v_mfma_f32_16x16x32_bf16 v[28:31], v[92:95], a[12:15], v[28:31]
    ds_read_b64_tr_b16 v[86:87], v160 offset:29440
    s_waitcnt vmcnt(11) lgkmcnt(8)
    v_mfma_f32_16x16x32_bf16 v[0:3], v[64:67], a[16:19], v[0:3]
    ds_read_b64_tr_b16 v[88:89], v161 offset:24832
    v_mfma_f32_16x16x32_bf16 v[0:3], v[68:71], a[24:27], v[0:3]
    ds_read_b64_tr_b16 v[90:91], v161 offset:25344
    s_barrier
    v_mfma_f32_16x16x32_bf16 v[4:7], v[64:67], a[20:23], v[4:7]
    ds_read_b64_tr_b16 v[92:93], v161 offset:28928
    buffer_load_dwordx4 a[76:79], v249, s[56:59], s72 offen offset:256 sc1
    v_mfma_f32_16x16x32_bf16 v[4:7], v[68:71], a[28:31], v[4:7]
    ds_read_b64_tr_b16 v[94:95], v161 offset:29440
    s_waitcnt lgkmcnt(8)
    v_mfma_f32_16x16x32_bf16 v[8:11], v[72:75], a[16:19], v[8:11]
    ds_read_b64_tr_b16 v[64:65], v164 offset:0
    v_mfma_f32_16x16x32_bf16 v[8:11], v[76:79], a[24:27], v[8:11]
    ds_read_b64_tr_b16 v[66:67], v164 offset:512
    v_mfma_f32_16x16x32_bf16 v[12:15], v[72:75], a[20:23], v[12:15]
    ds_read_b64_tr_b16 v[68:69], v164 offset:4096
    buffer_load_dwordx4 v[104:107], v167, s[40:43], s74 offen offset:0 sc1
    v_mfma_f32_16x16x32_bf16 v[12:15], v[76:79], a[28:31], v[12:15]
    ds_read_b64_tr_b16 v[70:71], v164 offset:4608
    s_waitcnt lgkmcnt(8)
    v_mfma_f32_16x16x32_bf16 v[16:19], v[80:83], a[16:19], v[16:19]
    ds_read_b64_tr_b16 v[72:73], v165 offset:0
    v_mfma_f32_16x16x32_bf16 v[16:19], v[84:87], a[24:27], v[16:19]
    ds_read_b64_tr_b16 v[74:75], v165 offset:512
    v_mfma_f32_16x16x32_bf16 v[20:23], v[80:83], a[20:23], v[20:23]
    ds_read_b64_tr_b16 v[76:77], v165 offset:4096
    buffer_load_dwordx4 v[108:111], v167, s[40:43], s74 offen offset:128 sc1
    v_mfma_f32_16x16x32_bf16 v[20:23], v[84:87], a[28:31], v[20:23]
    ds_read_b64_tr_b16 v[78:79], v165 offset:4608
    s_waitcnt lgkmcnt(8)
    v_mfma_f32_16x16x32_bf16 v[24:27], v[88:91], a[16:19], v[24:27]
    ds_read_b64_tr_b16 v[80:81], v164 offset:256
    v_mfma_f32_16x16x32_bf16 v[24:27], v[92:95], a[24:27], v[24:27]
    ds_read_b64_tr_b16 v[82:83], v164 offset:768
    v_mfma_f32_16x16x32_bf16 v[28:31], v[88:91], a[20:23], v[28:31]
    ds_read_b64_tr_b16 v[84:85], v164 offset:4352
    v_mfma_f32_16x16x32_bf16 v[28:31], v[92:95], a[28:31], v[28:31]
    ds_read_b64_tr_b16 v[86:87], v164 offset:4864
    s_waitcnt vmcnt(10) lgkmcnt(8)
    v_mfma_f32_16x16x32_bf16 v[0:3], v[64:67], a[32:35], v[0:3]
    ds_read_b64_tr_b16 v[88:89], v165 offset:256
    v_mfma_f32_16x16x32_bf16 v[0:3], v[68:71], a[40:43], v[0:3]
    ds_read_b64_tr_b16 v[90:91], v165 offset:768
    v_mfma_f32_16x16x32_bf16 v[4:7], v[64:67], a[36:39], v[4:7]
    ds_read_b64_tr_b16 v[92:93], v165 offset:4352
    v_mfma_f32_16x16x32_bf16 v[4:7], v[68:71], a[44:47], v[4:7]
    ds_read_b64_tr_b16 v[94:95], v165 offset:4864
    s_waitcnt lgkmcnt(8)
    v_mfma_f32_16x16x32_bf16 v[8:11], v[72:75], a[32:35], v[8:11]
    ds_read_b64_tr_b16 v[64:65], v164 offset:8192
    v_mfma_f32_16x16x32_bf16 v[8:11], v[76:79], a[40:43], v[8:11]
    ds_read_b64_tr_b16 v[66:67], v164 offset:8704
    v_mfma_f32_16x16x32_bf16 v[12:15], v[72:75], a[36:39], v[12:15]
    ds_read_b64_tr_b16 v[68:69], v164 offset:12288
    v_mfma_f32_16x16x32_bf16 v[12:15], v[76:79], a[44:47], v[12:15]
    ds_read_b64_tr_b16 v[70:71], v164 offset:12800
    s_waitcnt lgkmcnt(8)
    v_mfma_f32_16x16x32_bf16 v[16:19], v[80:83], a[32:35], v[16:19]
    ds_read_b64_tr_b16 v[72:73], v165 offset:8192
    v_mfma_f32_16x16x32_bf16 v[16:19], v[84:87], a[40:43], v[16:19]
    ds_read_b64_tr_b16 v[74:75], v165 offset:8704
    v_mfma_f32_16x16x32_bf16 v[20:23], v[80:83], a[36:39], v[20:23]
    ds_read_b64_tr_b16 v[76:77], v165 offset:12288
    v_mfma_f32_16x16x32_bf16 v[20:23], v[84:87], a[44:47], v[20:23]
    ds_read_b64_tr_b16 v[78:79], v165 offset:12800
    s_waitcnt lgkmcnt(8)
    v_mfma_f32_16x16x32_bf16 v[24:27], v[88:91], a[32:35], v[24:27]
    ds_read_b64_tr_b16 v[80:81], v164 offset:8448
    v_mfma_f32_16x16x32_bf16 v[24:27], v[92:95], a[40:43], v[24:27]
    ds_read_b64_tr_b16 v[82:83], v164 offset:8960
    v_mfma_f32_16x16x32_bf16 v[28:31], v[88:91], a[36:39], v[28:31]
    ds_read_b64_tr_b16 v[84:85], v164 offset:12544
    v_mfma_f32_16x16x32_bf16 v[28:31], v[92:95], a[44:47], v[28:31]
    ds_read_b64_tr_b16 v[86:87], v164 offset:13056
    s_waitcnt vmcnt(6) lgkmcnt(8)
    v_mfma_f32_16x16x32_bf16 v[0:3], v[64:67], a[48:51], v[0:3]
    ds_read_b64_tr_b16 v[88:89], v165 offset:8448
    v_mfma_f32_16x16x32_bf16 v[0:3], v[68:71], a[56:59], v[0:3]
    ds_read_b64_tr_b16 v[90:91], v165 offset:8960
    v_mfma_f32_16x16x32_bf16 v[4:7], v[64:67], a[52:55], v[4:7]
    ds_read_b64_tr_b16 v[92:93], v165 offset:12544
    v_mfma_f32_16x16x32_bf16 v[4:7], v[68:71], a[60:63], v[4:7]
    ds_read_b64_tr_b16 v[94:95], v165 offset:13056
    s_waitcnt lgkmcnt(8)
    v_mfma_f32_16x16x32_bf16 v[8:11], v[72:75], a[48:51], v[8:11]
    ds_read_b64_tr_b16 v[64:65], v162 offset:0
    v_mfma_f32_16x16x32_bf16 v[8:11], v[76:79], a[56:59], v[8:11]
    ds_read_b64_tr_b16 v[66:67], v162 offset:512
    v_mfma_f32_16x16x32_bf16 v[12:15], v[72:75], a[52:55], v[12:15]
    ds_read_b64_tr_b16 v[68:69], v162 offset:4096
    v_mfma_f32_16x16x32_bf16 v[12:15], v[76:79], a[60:63], v[12:15]
    ds_read_b64_tr_b16 v[70:71], v162 offset:4608
    s_waitcnt lgkmcnt(8)
    v_mfma_f32_16x16x32_bf16 v[16:19], v[80:83], a[48:51], v[16:19]
    ds_read_b64_tr_b16 v[72:73], v163 offset:0
    v_mfma_f32_16x16x32_bf16 v[16:19], v[84:87], a[56:59], v[16:19]
    ds_read_b64_tr_b16 v[74:75], v163 offset:512
    s_waitcnt vmcnt(0)
    v_lshlrev_b32 v48, 16, v104
    v_mfma_f32_16x16x32_bf16 v[20:23], v[80:83], a[52:55], v[20:23]
    ds_read_b64_tr_b16 v[76:77], v163 offset:4096
    v_and_b32 v49, 0xffff0000, v104
    v_mfma_f32_16x16x32_bf16 v[20:23], v[84:87], a[60:63], v[20:23]
    ds_read_b64_tr_b16 v[78:79], v163 offset:4608
    s_waitcnt lgkmcnt(8)
    v_mfma_f32_16x16x32_bf16 v[24:27], v[88:91], a[48:51], v[24:27]
    ds_read_b64_tr_b16 v[80:81], v162 offset:256
    v_lshlrev_b32 v50, 16, v105
    v_mfma_f32_16x16x32_bf16 v[24:27], v[92:95], a[56:59], v[24:27]
    ds_read_b64_tr_b16 v[82:83], v162 offset:768
    v_and_b32 v51, 0xffff0000, v105
    v_mfma_f32_16x16x32_bf16 v[28:31], v[88:91], a[52:55], v[28:31]
    ds_read_b64_tr_b16 v[84:85], v162 offset:4352
    v_lshlrev_b32 v52, 16, v106
    v_mfma_f32_16x16x32_bf16 v[28:31], v[92:95], a[60:63], v[28:31]
    ds_read_b64_tr_b16 v[86:87], v162 offset:4864
    s_waitcnt lgkmcnt(8)
    v_mfma_f32_16x16x32_bf16 v[0:3], v[64:67], a[64:67], v[0:3]
    ds_read_b64_tr_b16 v[88:89], v163 offset:256
    v_and_b32 v53, 0xffff0000, v106
    v_mfma_f32_16x16x32_bf16 v[0:3], v[68:71], a[72:75], v[0:3]
    ds_read_b64_tr_b16 v[90:91], v163 offset:768
    v_lshlrev_b32 v54, 16, v107
    v_mfma_f32_16x16x32_bf16 v[4:7], v[64:67], a[68:71], v[4:7]
    ds_read_b64_tr_b16 v[92:93], v163 offset:4352
    v_and_b32 v55, 0xffff0000, v107
    v_mfma_f32_16x16x32_bf16 v[4:7], v[68:71], a[76:79], v[4:7]
    ds_read_b64_tr_b16 v[94:95], v163 offset:4864
    s_waitcnt lgkmcnt(8)
    v_mfma_f32_16x16x32_bf16 v[8:11], v[72:75], a[64:67], v[8:11]
    v_lshlrev_b32 v56, 16, v108
    v_and_b32 v57, 0xffff0000, v108
    v_mfma_f32_16x16x32_bf16 v[8:11], v[76:79], a[72:75], v[8:11]
    v_lshlrev_b32 v58, 16, v109
    v_and_b32 v59, 0xffff0000, v109
    v_mfma_f32_16x16x32_bf16 v[12:15], v[72:75], a[68:71], v[12:15]
    v_lshlrev_b32 v60, 16, v110
    v_and_b32 v61, 0xffff0000, v110
    v_mfma_f32_16x16x32_bf16 v[12:15], v[76:79], a[76:79], v[12:15]
    v_lshlrev_b32 v62, 16, v111
    s_waitcnt lgkmcnt(4)
    v_mfma_f32_16x16x32_bf16 v[16:19], v[80:83], a[64:67], v[16:19]
    v_and_b32 v63, 0xffff0000, v111
    v_mfma_f32_16x16x32_bf16 v[16:19], v[84:87], a[72:75], v[16:19]
    v_mfma_f32_16x16x32_bf16 v[20:23], v[80:83], a[68:71], v[20:23]
    v_mfma_f32_16x16x32_bf16 v[20:23], v[84:87], a[76:79], v[20:23]
    s_waitcnt lgkmcnt(0)
    v_mfma_f32_16x16x32_bf16 v[24:27], v[88:91], a[64:67], v[24:27]
    v_mfma_f32_16x16x32_bf16 v[24:27], v[92:95], a[72:75], v[24:27]
    v_mfma_f32_16x16x32_bf16 v[28:31], v[88:91], a[68:71], v[28:31]
    v_mfma_f32_16x16x32_bf16 v[28:31], v[92:95], a[76:79], v[28:31]
    ds_write_b128 v168, v[0:3] offset:0
    ds_write_b128 v168, v[4:7] offset:4352
    ds_write_b128 v168, v[8:11] offset:64
    ds_write_b128 v168, v[12:15] offset:4416
    ds_write_b128 v168, v[16:19] offset:128
    ds_write_b128 v168, v[20:23] offset:4480
    v_pk_fma_f32 v[48:49], v[136:137], v[128:129], v[48:49]
    v_pk_fma_f32 v[50:51], v[138:139], v[130:131], v[50:51]
    v_pk_fma_f32 v[52:53], v[140:141], v[132:133], v[52:53]
    v_pk_fma_f32 v[54:55], v[142:143], v[134:135], v[54:55]
    v_pk_fma_f32 v[56:57], v[136:137], v[128:129], v[56:57]
    v_pk_fma_f32 v[58:59], v[138:139], v[130:131], v[58:59]
    v_pk_fma_f32 v[60:61], v[140:141], v[132:133], v[60:61]
    v_pk_fma_f32 v[62:63], v[142:143], v[134:135], v[62:63]
    ds_write_b128 v168, v[24:27] offset:192
    ds_write_b128 v168, v[28:31] offset:4544
    s_waitcnt lgkmcnt(0)
    s_barrier
    ds_read_b128 v[0:3], v169 offset:0
    ds_read_b128 v[4:7], v169 offset:16
    ds_read_b128 v[8:11], v169 offset:32768
    ds_read_b128 v[12:15], v169 offset:32784
    ds_read_b128 v[16:19], v169 offset:2176
    ds_read_b128 v[20:23], v169 offset:2192
    ds_read_b128 v[24:27], v169 offset:34944
    ds_read_b128 v[28:31], v169 offset:34960
    s_waitcnt lgkmcnt(4)
    v_pk_add_f32 v[0:1], v[0:1], v[8:9]
    v_pk_add_f32 v[2:3], v[2:3], v[10:11]
    v_pk_add_f32 v[4:5], v[4:5], v[12:13]
    v_pk_add_f32 v[6:7], v[6:7], v[14:15]
    v_pk_fma_f32 v[0:1], v[0:1], v[128:129], v[48:49]
    v_pk_fma_f32 v[2:3], v[2:3], v[130:131], v[50:51]
    v_pk_fma_f32 v[4:5], v[4:5], v[132:133], v[52:53]
    v_pk_fma_f32 v[6:7], v[6:7], v[134:135], v[54:55]
    v_cvt_pk_bf16_f32 v144, v0, v1
    v_cvt_pk_bf16_f32 v145, v2, v3
    v_cvt_pk_bf16_f32 v146, v4, v5
    v_cvt_pk_bf16_f32 v147, v6, v7
    buffer_store_dwordx4 v[144:147], v166, s[52:55], s76 offen sc1 nt
    s_waitcnt lgkmcnt(0)
    v_pk_add_f32 v[16:17], v[16:17], v[24:25]
    v_pk_add_f32 v[18:19], v[18:19], v[26:27]
    v_pk_add_f32 v[20:21], v[20:21], v[28:29]
    v_pk_add_f32 v[22:23], v[22:23], v[30:31]
    v_pk_fma_f32 v[16:17], v[16:17], v[128:129], v[56:57]
    v_pk_fma_f32 v[18:19], v[18:19], v[130:131], v[58:59]
    v_pk_fma_f32 v[20:21], v[20:21], v[132:133], v[60:61]
    v_pk_fma_f32 v[22:23], v[22:23], v[134:135], v[62:63]
    v_cvt_pk_bf16_f32 v148, v16, v17
    v_cvt_pk_bf16_f32 v149, v18, v19
    v_cvt_pk_bf16_f32 v150, v20, v21
    v_cvt_pk_bf16_f32 v151, v22, v23
    buffer_store_dwordx4 v[148:151], v166, s[52:55], s77 offen sc1 nt
L_end:
    s_endpgm
L1_fallback:
    s_mov_b32 s73, 1
    s_mov_b32 s70, 0
    s_waitcnt vmcnt(0) lgkmcnt(0)
    v_mov_b32 v240, v243
    v_mov_b32 v241, v244
    v_xor_b32 v249, 32, v244
    s_nop 15
    s_mov_b32 s71, 131072
    s_lshl_b32 s68, s34, 15
    s_and_b32 s69, s37, 1
    s_xor_b32 s69, s69, s34
    s_lshl_b32 s69, s69, 15
    s_sub_u32 s69, s69, 131072
    v_add_u32 v251, 7168, v255
    v_add_u32 v252, 14336, v255
    v_add_u32 v253, 21504, v255
    s_mul_i32 s72, s34, 44032
    s_or_b32 s15, s14, s72
    s_mov_b64 s[52:53], s[26:27]
    s_mov_b32 s54, 0x300000
    s_lshl_b32 s96, s38, 7
    s_add_u32 s96, s96, 2048
    s_movk_i32 s97, 4096
    v_mov_b32 v168, 0xff800000
    v_mov_b32 v169, 0xff800000
    v_mov_b32 v170, 0xff800000
    v_mov_b32 v171, 0xff800000
L1_maxloop:
    s_barrier
    s_add_u32 m0, s3, 0
    s_nop 0
    buffer_load_dwordx4 v245, s[44:47], s70 offen offset:0 lds
    s_addk_i32 m0, 16
    s_nop 0
    buffer_load_dwordx4 v245, s[44:47], s70 offen offset:1024 lds
    s_addk_i32 m0, 16
    s_nop 0
    buffer_load_dwordx4 v245, s[44:47], s70 offen offset:2048 lds
    s_addk_i32 m0, 16
    s_nop 0
    buffer_load_dwordx4 v245, s[44:47], s70 offen offset:3072 lds
    s_waitcnt vmcnt(0)
    s_barrier
    ds_read_b128 a[64:67], v240 offset:0
    ds_read_b128 a[68:71], v240 offset:256
    ds_read_b128 a[72:75], v240 offset:512
    ds_read_b128 a[76:79], v240 offset:768
    ds_read_b128 a[80:83], v240 offset:4160
    ds_read_b128 a[84:87], v240 offset:4416
    ds_read_b128 a[88:91], v240 offset:4672
    ds_read_b128 a[92:95], v240 offset:4928
    s_waitcnt lgkmcnt(0)
    v_mfma_f32_16x16x32_bf16 v[0:3], a[64:67], a[0:3], 0
    v_mfma_f32_16x16x32_bf16 v[0:3], a[68:71], a[4:7], v[0:3]
    v_mfma_f32_16x16x32_bf16 v[0:3], a[72:75], a[8:11], v[0:3]
    v_mfma_f32_16x16x32_bf16 v[0:3], a[76:79], a[12:15], v[0:3]
    v_mfma_f32_16x16x32_bf16 v[4:7], a[64:67], a[16:19], 0
    v_mfma_f32_16x16x32_bf16 v[4:7], a[68:71], a[20:23], v[4:7]
    v_mfma_f32_16x16x32_bf16 v[4:7], a[72:75], a[24:27], v[4:7]
    v_mfma_f32_16x16x32_bf16 v[4:7], a[76:79], a[28:31], v[4:7]
    v_mfma_f32_16x16x32_bf16 v[8:11], a[64:67], a[32:35], 0
    v_mfma_f32_16x16x32_bf16 v[8:11], a[68:71], a[36:39], v[8:11]
    v_mfma_f32_16x16x32_bf16 v[8:11], a[72:75], a[40:43], v[8:11]
    v_mfma_f32_16x16x32_bf16 v[8:11], a[76:79], a[44:47], v[8:11]
    v_mfma_f32_16x16x32_bf16 v[12:15], a[64:67], a[48:51], 0
    v_mfma_f32_16x16x32_bf16 v[12:15], a[68:71], a[52:55], v[12:15]
    v_mfma_f32_16x16x32_bf16 v[12:15], a[72:75], a[56:59], v[12:15]
    v_mfma_f32_16x16x32_bf16 v[12:15], a[76:79], a[60:63], v[12:15]
    v_mfma_f32_16x16x32_bf16 v[16:19], a[80:83], a[0:3], 0
    v_mfma_f32_16x16x32_bf16 v[16:19], a[84:87], a[4:7], v[16:19]
    v_mfma_f32_16x16x32_bf16 v[16:19], a[88:91], a[8:11], v[16:19]
    v_mfma_f32_16x16x32_bf16 v[16:19], a[92:95], a[12:15], v[16:19]
    v_mfma_f32_16x16x32_bf16 v[20:23], a[80:83], a[16:19], 0
    v_mfma_f32_16x16x32_bf16 v[20:23], a[84:87], a[20:23], v[20:23]
    v_mfma_f32_16x16x32_bf16 v[20:23], a[88:91], a[24:27], v[20:23]
    v_mfma_f32_16x16x32_bf16 v[20:23], a[92:95], a[28:31], v[20:23]
    v_mfma_f32_16x16x32_bf16 v[24:27], a[80:83], a[32:35], 0
    v_mfma_f32_16x16x32_bf16 v[24:27], a[84:87], a[36:39], v[24:27]
    v_mfma_f32_16x16x32_bf16 v[24:27], a[88:91], a[40:43], v[24:27]
    v_mfma_f32_16x16x32_bf16 v[24:27], a[92:95], a[44:47], v[24:27]
    v_mfma_f32_16x16x32_bf16 v[28:31], a[80:83], a[48:51], 0
    v_mfma_f32_16x16x32_bf16 v[28:31], a[84:87], a[52:55], v[28:31]
    v_mfma_f32_16x16x32_bf16 v[28:31], a[88:91], a[56:59], v[28:31]
    v_mfma_f32_16x16x32_bf16 v[28:31], a[92:95], a[60:63], v[28:31]
    s_nop 15
    v_max3_f32 v168, v168, v0, v1
    v_max3_f32 v168, v168, v2, v3
    v_max3_f32 v169, v169, v4, v5
    v_max3_f32 v169, v169, v6, v7
    v_max3_f32 v170, v170, v8, v9
    v_max3_f32 v170, v170, v10, v11
    v_max3_f32 v171, v171, v12, v13
    v_max3_f32 v171, v171, v14, v15
    v_max3_f32 v168, v168, v16, v17
    v_max3_f32 v168, v168, v18, v19
    v_max3_f32 v169, v169, v20, v21
    v_max3_f32 v169, v169, v22, v23
    v_max3_f32 v170, v170, v24, v25
    v_max3_f32 v170, v170, v26, v27
    v_max3_f32 v171, v171, v28, v29
    v_max3_f32 v171, v171, v30, v31
    ds_read_b128 a[64:67], v240 offset:8320
    ds_read_b128 a[68:71], v240 offset:8576
    ds_read_b128 a[72:75], v240 offset:8832
    ds_read_b128 a[76:79], v240 offset:9088
    ds_read_b128 a[80:83], v240 offset:12480
    ds_read_b128 a[84:87], v240 offset:12736
    ds_read_b128 a[88:91], v240 offset:12992
    ds_read_b128 a[92:95], v240 offset:13248
    s_waitcnt lgkmcnt(0)
    v_mfma_f32_16x16x32_bf16 v[0:3], a[64:67], a[0:3], 0
    v_mfma_f32_16x16x32_bf16 v[0:3], a[68:71], a[4:7], v[0:3]
    v_mfma_f32_16x16x32_bf16 v[0:3], a[72:75], a[8:11], v[0:3]
    v_mfma_f32_16x16x32_bf16 v[0:3], a[76:79], a[12:15], v[0:3]
    v_mfma_f32_16x16x32_bf16 v[4:7], a[64:67], a[16:19], 0
    v_mfma_f32_16x16x32_bf16 v[4:7], a[68:71], a[20:23], v[4:7]
    v_mfma_f32_16x16x32_bf16 v[4:7], a[72:75], a[24:27], v[4:7]
    v_mfma_f32_16x16x32_bf16 v[4:7], a[76:79], a[28:31], v[4:7]
    v_mfma_f32_16x16x32_bf16 v[8:11], a[64:67], a[32:35], 0
    v_mfma_f32_16x16x32_bf16 v[8:11], a[68:71], a[36:39], v[8:11]
    v_mfma_f32_16x16x32_bf16 v[8:11], a[72:75], a[40:43], v[8:11]
    v_mfma_f32_16x16x32_bf16 v[8:11], a[76:79], a[44:47], v[8:11]
    v_mfma_f32_16x16x32_bf16 v[12:15], a[64:67], a[48:51], 0
    v_mfma_f32_16x16x32_bf16 v[12:15], a[68:71], a[52:55], v[12:15]
    v_mfma_f32_16x16x32_bf16 v[12:15], a[72:75], a[56:59], v[12:15]
    v_mfma_f32_16x16x32_bf16 v[12:15], a[76:79], a[60:63], v[12:15]
    v_mfma_f32_16x16x32_bf16 v[16:19], a[80:83], a[0:3], 0
    v_mfma_f32_16x16x32_bf16 v[16:19], a[84:87], a[4:7], v[16:19]
    v_mfma_f32_16x16x32_bf16 v[16:19], a[88:91], a[8:11], v[16:19]
    v_mfma_f32_16x16x32_bf16 v[16:19], a[92:95], a[12:15], v[16:19]
    v_mfma_f32_16x16x32_bf16 v[20:23], a[80:83], a[16:19], 0
    v_mfma_f32_16x16x32_bf16 v[20:23], a[84:87], a[20:23], v[20:23]
    v_mfma_f32_16x16x32_bf16 v[20:23], a[88:91], a[24:27], v[20:23]
    v_mfma_f32_16x16x32_bf16 v[20:23], a[92:95], a[28:31], v[20:23]
    v_mfma_f32_16x16x32_bf16 v[24:27], a[80:83], a[32:35], 0
    v_mfma_f32_16x16x32_bf16 v[24:27], a[84:87], a[36:39], v[24:27]
    v_mfma_f32_16x16x32_bf16 v[24:27], a[88:91], a[40:43], v[24:27]
    v_mfma_f32_16x16x32_bf16 v[24:27], a[92:95], a[44:47], v[24:27]
    v_mfma_f32_16x16x32_bf16 v[28:31], a[80:83], a[48:51], 0
    v_mfma_f32_16x16x32_bf16 v[28:31], a[84:87], a[52:55], v[28:31]
    v_mfma_f32_16x16x32_bf16 v[28:31], a[88:91], a[56:59], v[28:31]
    v_mfma_f32_16x16x32_bf16 v[28:31], a[92:95], a[60:63], v[28:31]
    s_nop 15
    v_max3_f32 v168, v168, v0, v1
    v_max3_f32 v168, v168, v2, v3
    v_max3_f32 v169, v169, v4, v5
    v_max3_f32 v169, v169, v6, v7
    v_max3_f32 v170, v170, v8, v9
    v_max3_f32 v170, v170, v10, v11
    v_max3_f32 v171, v171, v12, v13
    v_max3_f32 v171, v171, v14, v15
    v_max3_f32 v168, v168, v16, v17
    v_max3_f32 v168, v168, v18, v19
    v_max3_f32 v169, v169, v20, v21
    v_max3_f32 v169, v169, v22, v23
    v_max3_f32 v170, v170, v24, v25
    v_max3_f32 v170, v170, v26, v27
    v_max3_f32 v171, v171, v28, v29
    v_max3_f32 v171, v171, v30, v31
    s_addk_i32 s70, 16384
    s_cmp_lt_u32 s70, 0x20000
    s_cbranch_scc1 L1_maxloop
    v_mov_b32 v172, v168
    v_mov_b32 v173, v169
    v_mov_b32 v174, v170
    v_mov_b32 v175, v171
    s_nop 1
    v_permlane32_swap_b32 v168, v172
    v_permlane32_swap_b32 v169, v173
    v_permlane32_swap_b32 v170, v174
    v_permlane32_swap_b32 v171, v175
    v_max_f32 v168, v168, v172
    v_max_f32 v169, v169, v173
    v_max_f32 v170, v170, v174
    v_max_f32 v171, v171, v175
    v_mov_b32 v172, v168
    v_mov_b32 v173, v169
    v_mov_b32 v174, v170
    v_mov_b32 v175, v171
    s_nop 1
    v_permlane16_swap_b32 v168, v172
    v_permlane16_swap_b32 v169, v173
    v_permlane16_swap_b32 v170, v174
    v_permlane16_swap_b32 v171, v175
    v_max_f32 v168, v168, v172
    v_max_f32 v169, v169, v173
    v_max_f32 v170, v170, v174
    v_max_f32 v171, v171, v175
    v_sub_f32 v224, 0, v168
    v_sub_f32 v225, 0, v168
    v_sub_f32 v226, 0, v168
    v_sub_f32 v227, 0, v168
    v_sub_f32 v228, 0, v169
    v_sub_f32 v229, 0, v169
    v_sub_f32 v230, 0, v169
    v_sub_f32 v231, 0, v169
    v_sub_f32 v232, 0, v170
    v_sub_f32 v233, 0, v170
    v_sub_f32 v234, 0, v170
    v_sub_f32 v235, 0, v170
    v_sub_f32 v236, 0, v171
    v_sub_f32 v237, 0, v171
    v_sub_f32 v238, 0, v171
    v_sub_f32 v239, 0, v171
    s_mov_b32 s70, 0
    s_barrier
    s_add_u32 m0, s3, 0
    s_nop 0
    buffer_load_dwordx4 v245, s[44:47], s70 offen offset:0 lds
    s_addk_i32 m0, 16
    s_nop 0
    buffer_load_dwordx4 v245, s[44:47], s70 offen offset:1024 lds
    s_addk_i32 m0, 16
    s_nop 0
    buffer_load_dwordx4 v245, s[44:47], s70 offen offset:2048 lds
    s_addk_i32 m0, 16
    s_nop 0
    buffer_load_dwordx4 v245, s[44:47], s70 offen offset:3072 lds
    s_add_u32 m0, s39, 0
    s_nop 0
    buffer_load_dwordx4 v245, s[48:51], s70 offen offset:0 lds
    buffer_load_dwordx4 v250, s[48:51], s70 offen offset:1024 lds
    buffer_load_dwordx4 v245, s[48:51], s70 offen offset:2048 lds
    buffer_load_dwordx4 v250, s[48:51], s70 offen offset:3072 lds
    s_addk_i32 s70, 16384
    s_add_u32 m0, s3, 33280
    s_nop 0
    buffer_load_dwordx4 v245, s[44:47], s70 offen offset:0 lds
    s_addk_i32 m0, 16
    s_nop 0
    buffer_load_dwordx4 v245, s[44:47], s70 offen offset:1024 lds
    s_addk_i32 m0, 16
    s_nop 0
    buffer_load_dwordx4 v245, s[44:47], s70 offen offset:2048 lds
    s_addk_i32 m0, 16
    s_nop 0
    buffer_load_dwordx4 v245, s[44:47], s70 offen offset:3072 lds
    s_add_u32 m0, s39, 33280
    s_nop 0
    buffer_load_dwordx4 v245, s[48:51], s70 offen offset:0 lds
    buffer_load_dwordx4 v250, s[48:51], s70 offen offset:1024 lds
    buffer_load_dwordx4 v245, s[48:51], s70 offen offset:2048 lds
    buffer_load_dwordx4 v250, s[48:51], s70 offen offset:3072 lds
    s_addk_i32 s70, 16384
    s_add_u32 m0, s3, 66560
    s_nop 0
    buffer_load_dwordx4 v245, s[44:47], s70 offen offset:0 lds
    s_addk_i32 m0, 16
    s_nop 0
    buffer_load_dwordx4 v245, s[44:47], s70 offen offset:1024 lds
    s_addk_i32 m0, 16
    s_nop 0
    buffer_load_dwordx4 v245, s[44:47], s70 offen offset:2048 lds
    s_addk_i32 m0, 16
    s_nop 0
    buffer_load_dwordx4 v245, s[44:47], s70 offen offset:3072 lds
    s_add_u32 m0, s39, 66560
    s_nop 0
    buffer_load_dwordx4 v245, s[48:51], s70 offen offset:0 lds
    buffer_load_dwordx4 v250, s[48:51], s70 offen offset:1024 lds
    buffer_load_dwordx4 v245, s[48:51], s70 offen offset:2048 lds
    buffer_load_dwordx4 v250, s[48:51], s70 offen offset:3072 lds
    s_addk_i32 s70, 16384
    s_waitcnt vmcnt(0)
    s_barrier
    ds_read_b128 a[64:67], v240 offset:0
    ds_read_b128 a[68:71], v240 offset:256
    ds_read_b128 a[72:75], v240 offset:512
    ds_read_b128 a[76:79], v240 offset:768
    ds_read_b128 a[80:83], v240 offset:4160
    ds_read_b128 a[84:87], v240 offset:4416
    ds_read_b128 a[88:91], v240 offset:4672
    ds_read_b128 a[92:95], v240 offset:4928
    s_waitcnt lgkmcnt(0)
    v_mfma_f32_16x16x32_bf16 v[0:3], a[64:67], a[0:3], v[224:227]
    v_mfma_f32_16x16x32_bf16 v[0:3], a[68:71], a[4:7], v[0:3]
    v_mfma_f32_16x16x32_bf16 v[0:3], a[72:75], a[8:11], v[0:3]
    v_mfma_f32_16x16x32_bf16 v[0:3], a[76:79], a[12:15], v[0:3]
    v_mfma_f32_16x16x32_bf16 v[4:7], a[64:67], a[16:19], v[228:231]
    v_mfma_f32_16x16x32_bf16 v[4:7], a[68:71], a[20:23], v[4:7]
    v_mfma_f32_16x16x32_bf16 v[4:7], a[72:75], a[24:27], v[4:7]
    v_mfma_f32_16x16x32_bf16 v[4:7], a[76:79], a[28:31], v[4:7]
    v_mfma_f32_16x16x32_bf16 v[8:11], a[64:67], a[32:35], v[232:235]
    v_mfma_f32_16x16x32_bf16 v[8:11], a[68:71], a[36:39], v[8:11]
    v_mfma_f32_16x16x32_bf16 v[8:11], a[72:75], a[40:43], v[8:11]
    v_mfma_f32_16x16x32_bf16 v[8:11], a[76:79], a[44:47], v[8:11]
    v_mfma_f32_16x16x32_bf16 v[12:15], a[64:67], a[48:51], v[236:239]
    v_mfma_f32_16x16x32_bf16 v[12:15], a[68:71], a[52:55], v[12:15]
    v_mfma_f32_16x16x32_bf16 v[12:15], a[72:75], a[56:59], v[12:15]
    v_mfma_f32_16x16x32_bf16 v[12:15], a[76:79], a[60:63], v[12:15]
    v_mfma_f32_16x16x32_bf16 v[16:19], a[80:83], a[0:3], v[224:227]
    v_mfma_f32_16x16x32_bf16 v[16:19], a[84:87], a[4:7], v[16:19]
    v_mfma_f32_16x16x32_bf16 v[16:19], a[88:91], a[8:11], v[16:19]
    v_mfma_f32_16x16x32_bf16 v[16:19], a[92:95], a[12:15], v[16:19]
    v_mfma_f32_16x16x32_bf16 v[20:23], a[80:83], a[16:19], v[228:231]
    v_mfma_f32_16x16x32_bf16 v[20:23], a[84:87], a[20:23], v[20:23]
    v_mfma_f32_16x16x32_bf16 v[20:23], a[88:91], a[24:27], v[20:23]
    v_mfma_f32_16x16x32_bf16 v[20:23], a[92:95], a[28:31], v[20:23]
    v_mfma_f32_16x16x32_bf16 v[24:27], a[80:83], a[32:35], v[232:235]
    v_mfma_f32_16x16x32_bf16 v[24:27], a[84:87], a[36:39], v[24:27]
    v_mfma_f32_16x16x32_bf16 v[24:27], a[88:91], a[40:43], v[24:27]
    v_mfma_f32_16x16x32_bf16 v[24:27], a[92:95], a[44:47], v[24:27]
    v_mfma_f32_16x16x32_bf16 v[28:31], a[80:83], a[48:51], v[236:239]
    v_mfma_f32_16x16x32_bf16 v[28:31], a[84:87], a[52:55], v[28:31]
    v_mfma_f32_16x16x32_bf16 v[28:31], a[88:91], a[56:59], v[28:31]
    v_mfma_f32_16x16x32_bf16 v[28:31], a[92:95], a[60:63], v[28:31]
    s_nop 15
    ds_read_b128 a[64:67], v240 offset:8320
    ds_read_b128 a[68:71], v240 offset:8576
    ds_read_b128 a[72:75], v240 offset:8832
    ds_read_b128 a[76:79], v240 offset:9088
    s_waitcnt lgkmcnt(0)
    s_branch L1_qk1
L_last:
    s_endpgm
.section .rodata,"a"
.p2align 6
.amdhsa_kernel adaLN_cond__sliding_block_cached__dense_activation_gelu__prompt_kernel
  .amdhsa_next_free_vgpr 512
  .amdhsa_next_free_sgpr 102
  .amdhsa_accum_offset 256
  .amdhsa_group_segment_fixed_size 0
  .amdhsa_kernarg_size 120
  .amdhsa_user_sgpr_count 2
  .amdhsa_user_sgpr_kernarg_segment_ptr 1
  .amdhsa_system_sgpr_workgroup_id_x 1
.end_amdhsa_kernel
```
